```python
import torch

def _softmax(x, axis=-1):
    return torch.softmax(x, dim=axis)
def _gelu(x):
    return torch.nn.functional.gelu(x, approximate="tanh")
def _silu(x):
    return torch.nn.functional.silu(x)
def _sigmoid(x):
    return torch.sigmoid(x)
def _layernorm(x, axis=-1, eps=1e-5):
    m = x.mean(dim=axis, keepdim=True)
    v = x.var(dim=axis, keepdim=True, unbiased=False)
    return (x - m) / torch.sqrt(v + eps)
def _scatter_add(tgt, idx, src, axis=0):
    return tgt.clone().index_add_(axis, idx, src)
def _segment_sum(src, seg, n):
    out = torch.zeros((n,) + src.shape[1:], dtype=src.dtype)
    return out.index_add_(0, seg, src)
def _pad(x, pw):
    flat = tuple(v for pair in reversed(pw) for v in pair)
    return torch.nn.functional.pad(x, flat)

kernel_name = 'interleave_layers__sliding_block__dense_activation_silu__prompt'

def setup_inputs():

    _w = (lambda a: (lambda t: t.to(torch.bfloat16) if t.is_floating_point() else t)(torch.as_tensor(a)))
    def _A_setup():
        B, S, D = 1, 2048, 1024
        return {
            "x": _w((lambda *s: torch.randn(*s, dtype=torch.bfloat16) * 0.05)(B, S, D)),
            "wqkv": _w((lambda *s: torch.randn(*s, dtype=torch.bfloat16) * 0.05)(D, 3 * D)),
            "wo": _w((lambda *s: torch.randn(*s, dtype=torch.bfloat16) * 0.05)(D, D)),
        }
    _A_in = _A_setup()

    def _B_setup():
        B, S, D, F = 1, 2048, 1024, 3584
        return {
            "x": _w((lambda *s: torch.randn(*s, dtype=torch.bfloat16) * 0.05)(B, S, D)),
            "w1": _w((lambda *s: torch.randn(*s, dtype=torch.bfloat16) * 1.6)(D, F) * (D ** -0.5)),
            "w2": _w((lambda *s: torch.randn(*s, dtype=torch.bfloat16) * 1.6)(F, D) * (F ** -0.5)),
        }
    _B_in = _B_setup()

    return {
        "A_x": _A_in["x"],
        "A_wqkv": _A_in["wqkv"],
        "A_wo": _A_in["wo"],
        "B_x": _B_in["x"],
        "B_w1": _B_in["w1"],
        "B_w2": _B_in["w2"],
    }

def reference(A_x, A_wqkv, A_wo, B_x, B_w1, B_w2):
    def _A_ref(x, wqkv, wo):
        B, S, D = x.shape
        H = 32; Dh = D // H; W = 256
        qkv = (lambda x, *d: x.permute(*d))((x @ wqkv).reshape(B, S, 3, H, Dh), 2, 0, 3, 1, 4)
        q, k, v = qkv[0], qkv[1], qkv[2]
        scores = torch.einsum("bhqd,bhkd->bhqk", q, k) * (Dh ** -0.5)
        idx = torch.arange(S)
        mask = (idx[:, None] - idx[None, :] >= 0) & (idx[:, None] - idx[None, :] < W)
        scores = torch.where(mask[None, None], scores, -1e9)
        p = _softmax(scores, axis=-1)
        o = torch.einsum("bhqk,bhkd->bhqd", p, v)
        return (lambda x, *d: x.permute(*d))(o, 0, 2, 1, 3).reshape(B, S, D) @ wo

    def _B_ref(x, w1, w2):
        h = torch.einsum("bsd,df->bsf", x, w1)
        h = _silu(h)
        out = torch.einsum("bsf,fd->bsd", h, w2)
        return out

    x = A_x
    x = x + _A_ref(_layernorm(x, axis=-1), A_wqkv, A_wo)
    x = x + _B_ref(_layernorm(x, axis=-1), B_w1, B_w2)
    x = x + _A_ref(_layernorm(x, axis=-1), A_wqkv, A_wo)
    x = x + _B_ref(_layernorm(x, axis=-1), B_w1, B_w2)
    return x
```

```asm
; @launch grid=(256,1,1) block=(512,1,1) lds=163840
.amdgcn_target "amdgcn-amd-amdhsa--gfx950"
.text
.globl interleave_layers__sliding_block__dense_activation_silu__prompt_kernel
.p2align 8
.type interleave_layers__sliding_block__dense_activation_silu__prompt_kernel,@function
interleave_layers__sliding_block__dense_activation_silu__prompt_kernel:
  s_cmp_ge_u32 s2, 256
  s_cbranch_scc0 L_go
  s_endpgm
L_go:
  s_load_dwordx16 s[4:19], s[0:1], 0
  s_load_dwordx2 s[20:21], s[0:1], 64
  s_add_u32 s22, s2, 0
  s_and_b32 s22, s22, 7
  s_lshr_b32 s23, s2, 3
  s_lshr_b32 s24, s23, 3
  s_lshr_b32 s25, s22, 1
  s_lshl_b32 s25, s25, 2
  s_add_u32 s24, s24, s25
  s_and_b32 s25, s22, 1
  s_lshl_b32 s25, s25, 3
  s_and_b32 s26, s23, 7
  s_add_u32 s25, s25, s26
  v_lshrrev_b32 v2, 6, v0
  v_and_b32 v1, 63, v0
  v_readfirstlane_b32 s26, v2
  s_mov_b32 s22, 0
  s_mov_b32 s23, 0
  s_mov_b32 s30, 0x10000000
  s_mov_b32 s31, 0x20000
  s_mov_b32 s35, 0x20000
  s_mov_b32 s67, 0x20000
  s_mov_b32 s71, 0
  s_mov_b32 s75, 0x1000000
  s_cmp_lg_u32 s26, 0
  s_cbranch_scc1 Lpr1
  s_and_b32 s40, s24, 7
  s_lshl_b32 s40, s40, 4
  s_add_u32 s40, s40, s25
  s_lshl_b32 s40, s40, 15
  s_lshr_b32 s42, s24, 3
  s_lshl_b32 s39, s42, 10
  s_add_u32 s40, s40, s39
  s_and_b32 s43, s25, 1
  s_lshl_b32 s39, s43, 13
  s_add_u32 s40, s40, s39
  s_xor_b32 s41, s40, 8192
  v_mov_b32 v12, 0
  s_mov_b64 exec, 1
.p2align 6
  s_waitcnt lgkmcnt(0)
  s_mov_b32 s28, s20
  s_mov_b32 s29, s21
  buffer_store_dword v12, v12, s[28:31], s40 offen sc1
  buffer_store_dword v12, v12, s[28:31], s41 offen sc1
  s_waitcnt vmcnt(1)
  s_mov_b64 exec, -1
  s_nop 7
  s_getreg_b32 s86, hwreg(HW_REG_IB_STS, 0, 4)
  s_cmp_lg_u32 s86, 0
  s_cselect_b32 s39, 1, 0
  s_xor_b32 s43, s43, s42
  s_xor_b32 s43, s43, 0
  s_bfe_u32 s42, s24, 0x10002
  s_lshl_b32 s42, s42, 1
  s_add_u32 s42, s42, s43
  s_mul_i32 s42, s42, 6
  s_lshl_b32 s39, s39, s42
  s_add_u32 s75, s75, s39
Lpr1:
  s_cmp_ge_u32 s26, 4
  s_cbranch_scc1 L_loader
  s_getpc_b64 s[94:95]
Lpc2:
  s_bfe_u32 s39, s2, 0x50003
  s_lshl_b32 s39, s39, 2
  s_add_u32 s39, s39, s26
  s_mul_i32 s70, s22, 13
  s_add_u32 s39, s39, s70
  s_add_u32 s39, s39, 0
  s_and_b32 s39, s39, 127
  s_mul_i32 s39, s39, 512
  s_min_u32 s39, s39, ((L_end - interleave_layers__sliding_block__dense_activation_silu__prompt_kernel) & 0xffffff80) - 512
  s_sub_u32 s94, s94, Lpc2 - interleave_layers__sliding_block__dense_activation_silu__prompt_kernel
  s_subb_u32 s95, s95, 0
  s_add_u32 s94, s94, s39
  s_addc_u32 s95, s95, 0
  s_load_dwordx2 s[92:93], s[94:95], 60
  s_load_dwordx2 s[92:93], s[94:95], 188
  s_load_dwordx2 s[92:93], s[94:95], 316
  s_load_dwordx2 s[92:93], s[94:95], 444
  s_branch L_compute
L_loader:
  s_sub_u32 s27, s26, 4
  s_lshl_b32 s53, s27, 12
  s_lshr_b32 s36, s27, 1
  s_and_b32 s37, s27, 1
  s_sub_u32 s26, 3, s36
  s_cmp_eq_u32 s37, 0
  s_cselect_b32 s26, s36, s26
  s_add_u32 s93, s24, s25
  s_and_b32 s57, s93, 3
  s_and_b32 s93, s93, 15
  s_mul_i32 s58, s93, 6
  s_lshr_b32 s58, s58, 4
  s_max_u32 s58, s58, 1
  s_mov_b32 s34, 6295552
  s_mov_b32 s35, 0x20000
  v_lshrrev_b32 v3, 3, v1
  v_and_b32 v4, 7, v1
  v_and_b32 v5, 6, v3
  v_xor_b32 v4, v4, v5
  v_lshlrev_b32 v4, 4, v4
  v_and_b32 v5, 4, v3
  v_add_u32 v3, v3, v5
  s_lshl_b32 s43, s36, 5
  s_lshl_b32 s48, s37, 2
  s_add_u32 s43, s43, s48
  v_mul_u32_u24 v6, 6144, v3
  v_add_u32 v6, v6, v4
  s_mul_i32 s43, s43, 6144
  s_mov_b32 s63, s93
  s_mul_i32 s48, s25, 128
  s_add_u32 s43, s43, s48
  s_mov_b32 s50, s43
  v_add_u32 v6, s50, v6
  v_add_u32 v11, 4096, v6
  v_add_u32 v12, 5120, v6
  v_add_u32 v13, 6144, v6
  v_add_u32 v14, 99328, v6
  v_add_u32 v15, 104448, v6
  v_add_u32 v16, 105472, v6
  v_cmp_lt_u32 vcc, s58, v1
  v_mov_b32 v7, 1
  v_subrev_u32 v8, s58, v1
  v_cndmask_b32 v3, 0, v7, vcc
  v_sub_u32 v3, v1, v3
  v_subrev_u32 v4, s57, v3
  v_and_b32 v4, 3, v4
  v_cmp_eq_u32 vcc, 0, v4
  v_cmp_eq_u32 s[48:49], 1, v4
  s_nop 0
  v_addc_co_u32 v3, vcc, 0, v3, vcc
  v_subb_co_u32 v3, vcc, v3, 0, s[48:49]
  v_med3_i32 v3, v3, 0, 14
  v_cmp_le_u32 vcc, s63, v3
  v_add_u32 v5, s63, v8
  v_cmp_gt_u32 s[48:49], 1, v8
  v_cndmask_b32 v4, 0, v7, vcc
  v_add_u32 v3, v3, v4
  v_cndmask_b32 v3, v3, v5, s[48:49]
  s_mov_b32 s48, 393216
  v_mul_lo_u32 v29, v3, s48
  s_lshl_b32 s48, s24, 18
  v_lshl_add_u32 v28, v3, 7, s48
  s_mov_b32 s66, 4194304
  v_lshrrev_b32 v3, 3, v1
  v_and_b32 v4, 7, v1
  v_lshrrev_b32 v5, 1, v3
  v_xor_b32 v4, v4, v5
  s_lshl_b32 s43, s26, 16
  v_lshl_add_u32 v3, v3, 11, s43
  v_xor_b32 v5, 0, v4
  v_lshl_add_u32 v5, v5, 4, v3
  v_add_u32 v20, 0, v5
  v_xor_b32 v5, 4, v4
  v_lshl_add_u32 v5, v5, 4, v3
  v_add_u32 v21, 15360, v5
  v_xor_b32 v5, 0, v4
  v_lshl_add_u32 v5, v5, 4, v3
  v_add_u32 v22, 30720, v5
  v_xor_b32 v5, 4, v4
  v_lshl_add_u32 v5, v5, 4, v3
  v_add_u32 v23, 46080, v5
  v_readlane_b32 s51, v29, 0
  s_mul_i32 s54, s27, 6144
  s_add_u32 s54, s54, 131072
  s_add_i32 s61, s54, -73728
  s_add_i32 s56, s54, 0
  s_mov_b32 s47, 0
  v_readlane_b32 s44, v28, 0
  s_add_u32 s60, s53, 49152
  s_add_u32 s45, s53, 0
  s_mov_b32 s46, 0
  s_nop 0
  s_waitcnt lgkmcnt(0)
  s_mov_b32 s28, s20
  s_mov_b32 s29, s21
  s_sub_u32 s32, s6, 4096
  s_subb_u32 s33, s7, 0
  s_mov_b32 s64, s4
  s_mov_b32 s65, s5
  s_mov_b32 m0, s45
  s_nop 0
  buffer_load_dwordx4 v20, s[64:67], s44 offen offset:0 sc1 lds
  s_add_u32 s46, s46, 1
  s_add_u32 s45, s45, 16384
  s_cmp_ge_u32 s45, s60
  s_cselect_b32 s45, s53, s45
  buffer_load_dwordx4 v21, s[64:67], s44 offen offset:1024 sc1 lds
  v_readlane_b32 s4, v28, s46
  buffer_load_dwordx4 v22, s[64:67], s44 offen offset:2048 sc1 lds
  buffer_load_dwordx4 v23, s[64:67], s44 offen offset:3072 sc1 lds
  s_mov_b32 s44, s4
  s_mov_b32 m0, s56
  s_add_u32 s47, s47, 1
  buffer_load_dwordx4 v11, s[32:35], s51 offen offset:0  lds
  v_readlane_b32 s5, v29, s47
  s_sub_u32 s56, s56, 24576
  s_cmp_eq_u32 s56, s61
  s_cselect_b32 s56, s54, s56
  buffer_load_dwordx4 v12, s[32:35], s51 offen offset:1024  lds
  buffer_load_dwordx4 v13, s[32:35], s51 offen offset:2048  lds
  buffer_load_dwordx4 v14, s[32:35], s51 offen offset:3072  lds
  s_add_u32 m0, m0, 4096
  s_nop 0
  buffer_load_dwordx4 v15, s[32:35], s51 offen offset:0  lds
  buffer_load_dwordx4 v16, s[32:35], s51 offen offset:1024  lds
  s_mov_b32 s51, s5
  s_mov_b32 m0, s45
  s_nop 0
  buffer_load_dwordx4 v20, s[64:67], s44 offen offset:0 sc1 lds
  s_add_u32 s46, s46, 1
  s_add_u32 s45, s45, 16384
  s_cmp_ge_u32 s45, s60
  s_cselect_b32 s45, s53, s45
  buffer_load_dwordx4 v21, s[64:67], s44 offen offset:1024 sc1 lds
  v_readlane_b32 s4, v28, s46
  s_mov_b32 s77, 0
  s_mov_b32 s70, 0
  s_mov_b32 s72, s18
  s_mov_b32 s73, s19
  s_mov_b32 s74, 256
  s_mov_b32 s75, 0x20000
  s_mul_i32 s43, s24, 14
  s_add_u32 s43, s43, s25
  s_add_u32 s42, s25, 4
  s_lshr_b32 s42, s42, 3
  s_sub_u32 s43, s43, s42
  s_lshl_b32 s92, s43, 2
  s_add_u32 s92, s92, s27
  s_mul_i32 s38, s93, 3
  s_lshr_b32 s38, s38, 3
  s_add_u32 s38, s38, 9
  s_and_b32 s59, s93, 7
  buffer_load_dwordx4 v22, s[64:67], s44 offen offset:2048 sc1 lds
  s_mul_i32 s59, s59, 7
  s_lshr_b32 s59, s59, 3
  s_add_u32 s59, s59, 8
  s_and_b32 s42, s25, 7
  s_cmp_eq_u32 s42, 3
  s_cselect_b32 s59, 64, s59
  s_cselect_b32 s38, 64, s38
  s_and_b32 s79, s25, 1
  s_lshl_b32 s79, s79, 12
  s_and_b32 s43, s25, 2
  s_lshl_b32 s43, s43, 13
  s_add_u32 s79, s79, s43
  s_and_b32 s43, s25, 12
  s_lshl_b32 s43, s43, 6
  s_add_u32 s79, s79, s43
  s_add_u32 s79, s79, 92274688
  s_mov_b32 s3, 0xf0
  v_mov_b32 v17, 0
  v_mov_b32 v18, 1
  buffer_load_dwordx4 v23, s[64:67], s44 offen offset:3072 sc1 lds
  v_lshlrev_b32 v19, 4, v1
  s_lshl_b32 s43, s36, 13
  s_add_u32 s43, s43, s53
  v_add_u32 v30, s43, v19
  v_lshlrev_b32 v31, 13, v1
  s_lshr_b32 s55, s24, 2
  s_lshl_b32 s55, s55, 1
  s_lshr_b32 s39, s25, 3
  s_add_u32 s55, s55, s39
  s_lshr_b32 s55, s3, s55
  s_and_b32 s55, s55, 1
  s_lshl_b32 s55, s55, 13
  s_and_b32 s39, s24, 7
  s_lshl_b32 s39, s39, 19
  s_add_u32 s55, s55, s39
  s_lshl_b32 s39, s25, 15
  s_add_u32 s55, s55, s39
  s_mov_b32 s44, s4
  s_mov_b32 m0, s56
  s_add_u32 s47, s47, 1
  buffer_load_dwordx4 v11, s[32:35], s51 offen offset:0  lds
  v_readlane_b32 s5, v29, s47
  s_sub_u32 s56, s56, 24576
  s_cmp_eq_u32 s56, s61
  s_cselect_b32 s56, s54, s56
  s_lshr_b32 s0, s24, 2
  s_lshl_b32 s0, s0, 1
  s_lshr_b32 s39, 0, 3
  s_add_u32 s0, s0, s39
  s_lshr_b32 s0, s3, s0
  s_and_b32 s0, s0, 1
  s_lshl_b32 s0, s0, 13
  s_and_b32 s39, s24, 7
  s_lshl_b32 s39, s39, 19
  s_add_u32 s0, s0, s39
  s_lshl_b32 s39, 0, 15
  s_add_u32 s0, s0, s39
  s_lshr_b32 s1, s24, 2
  s_lshl_b32 s1, s1, 1
  s_lshr_b32 s39, 8, 3
  s_add_u32 s1, s1, s39
  s_lshr_b32 s1, s3, s1
  buffer_load_dwordx4 v12, s[32:35], s51 offen offset:1024  lds
  s_and_b32 s1, s1, 1
  s_lshl_b32 s1, s1, 13
  s_and_b32 s39, s24, 7
  s_lshl_b32 s39, s39, 19
  s_add_u32 s1, s1, s39
  s_lshl_b32 s39, 8, 15
  s_add_u32 s1, s1, s39
  s_mov_b32 s69, s0
  s_cmp_lt_u32 s25, 8
  s_cselect_b32 s78, s0, s1
  s_cselect_b32 s68, s1, s0
  s_and_b32 s42, s24, 1
  s_lshl_b32 s42, s42, 12
  s_and_b32 s43, s24, 2
  s_lshl_b32 s43, s43, 13
  s_add_u32 s42, s42, s43
  s_add_u32 s42, s42, 92276736
  s_add_u32 s69, s69, s42
  s_add_u32 s42, s42, 256
  buffer_load_dwordx4 v13, s[32:35], s51 offen offset:2048  lds
  s_add_u32 s78, s78, s42
  s_add_u32 s68, s68, s42
  s_add_u32 s76, s55, s79
  v_mov_b32 v120, -1
  v_mov_b32 v121, -1
  v_mov_b32 v122, -1
  v_mov_b32 v123, -1
  s_add_u32 s43, s69, 512
  s_cmp_eq_u32 s27, 3
  s_cselect_b32 s42, s43, s78
  s_cmp_eq_u32 s27, 1
  s_cselect_b32 s42, s69, s42
  s_cmp_eq_u32 s27, 0
  s_cselect_b32 s42, s76, s42
  s_andn2_b32 s71, s42, 0x2000
  s_mul_i32 s42, s58, 0x5556
  s_lshr_b32 s42, s42, 16
  s_mul_i32 s42, s42, 3
  s_sub_u32 s42, s58, s42
  v_bfe_u32 v3, v1, 2, 3
  buffer_load_dwordx4 v14, s[32:35], s51 offen offset:3072  lds
  v_lshrrev_b32 v4, 5, v1
  v_mul_u32_u24 v4, 3072, v4
  v_lshl_add_u32 v4, v3, 7, v4
  v_and_b32 v5, 3, v1
  v_lshl_add_u32 v4, v5, 3, v4
  v_lshrrev_b32 v3, 1, v3
  s_min_u32 s43, s27, 2
  s_lshl_b32 s43, s43, 10
  s_mul_i32 s48, s42, 24576
  s_sub_u32 s43, s43, s48
  s_add_u32 s43, s43, 131072
  v_add_u32 v4, s43, v4
  v_lshl_add_u32 v124, v3, 5, v4
  v_xor_b32 v125, 32, v124
  v_xor_b32 v126, 64, v124
  v_xor_b32 v127, 0x60, v124
  v_and_b32 v3, 15, v1
  s_add_u32 m0, m0, 4096
  s_nop 0
  buffer_load_dwordx4 v15, s[32:35], s51 offen offset:0  lds
  v_lshrrev_b32 v4, 1, v3
  v_lshrrev_b32 v5, 4, v1
  v_xor_b32 v4, v4, v5
  s_lshl_b32 s43, s37, 2
  v_xor_b32 v4, s43, v4
  v_lshlrev_b32 v4, 4, v4
  v_lshl_add_u32 v4, v3, 7, v4
  s_lshl_b32 s42, s42, 14
  s_lshl_b32 s43, s36, 13
  s_add_u32 s42, s42, s43
  v_add_u32 v25, s42, v4
  s_add_u32 s58, s58, 2
  s_mov_b32 s93, 64
  buffer_load_dwordx4 v16, s[32:35], s51 offen offset:1024  lds
  s_mov_b32 s51, s5
  s_mov_b64 exec, 3
  buffer_store_dword v17, v31, s[28:31], s71 offen sc1
  s_mov_b64 exec, -1
  s_waitcnt vmcnt(11)
  s_barrier
  s_mov_b32 m0, s45
  s_nop 0
  buffer_load_dwordx4 v20, s[64:67], s44 offen offset:0 sc1 lds
  s_add_u32 s46, s46, 1
  s_add_u32 s45, s45, 16384
  s_cmp_ge_u32 s45, s60
  s_cselect_b32 s45, s53, s45
  buffer_load_dwordx4 v21, s[64:67], s44 offen offset:1024 sc1 lds
  v_readlane_b32 s4, v28, s46
  s_sub_u32 s80, s8, 4096
  s_subb_u32 s81, s9, 0
  s_mov_b32 s82, 2101248
  s_mov_b32 s83, 0x20000
  v_lshrrev_b32 v3, 3, v1
  v_and_b32 v4, 7, v1
  v_and_b32 v5, 6, v3
  v_xor_b32 v4, v4, v5
  v_lshlrev_b32 v4, 4, v4
  s_lshl_b32 s43, s27, 4
  v_mul_u32_u24 v6, 2048, v3
  buffer_load_dwordx4 v22, s[64:67], s44 offen offset:2048 sc1 lds
  v_add_u32 v6, v6, v4
  s_mul_i32 s43, s43, 2048
  s_mov_b32 s63, s25
  s_mul_i32 s48, s25, 128
  s_add_u32 s43, s43, s48
  s_mov_b32 s50, s43
  v_add_u32 v6, s50, v6
  v_add_u32 v147, 4096, v6
  v_add_u32 v148, 19456, v6
  s_and_b32 s63, s25, 7
  buffer_load_dwordx4 v23, s[64:67], s44 offen offset:3072 sc1 lds
  s_and_b32 s50, s25, 8
  v_cmp_lt_u32 vcc, 0, v1
  v_mov_b32 v7, 1
  v_subrev_u32 v8, 0, v1
  v_cndmask_b32 v3, 0, v7, vcc
  v_sub_u32 v3, v1, v3
  v_cmp_lt_u32 vcc, 7, v1
  v_mov_b32 v9, 14
  s_and_b32 s62, s63, 7
  v_cndmask_b32 v6, 0, 7, vcc
  s_mov_b32 s44, s4
  s_barrier
  s_mov_b32 m0, s56
  s_add_u32 s47, s47, 1
  buffer_load_dwordx4 v11, s[32:35], s51 offen offset:0  lds
  v_readlane_b32 s5, v29, s47
  s_sub_u32 s56, s56, 24576
  s_cmp_eq_u32 s56, s61
  s_cselect_b32 s56, s54, s56
  v_cndmask_b32 v9, 6, v9, vcc
  v_subrev_u32 v4, s57, v3
  v_and_b32 v4, 3, v4
  v_sub_u32 v5, v3, v4
  v_cmp_ge_i32 vcc, v5, v6
  v_add_u32 v5, 2, v5
  v_cmp_le_i32 s[48:49], v5, v9
  v_lshlrev_b32 v4, 2, v4
  s_and_b64 vcc, vcc, s[48:49]
  s_mov_b32 s48, 0x0ff2
  buffer_load_dwordx4 v12, s[32:35], s51 offen offset:1024  lds
  v_bfe_i32 v4, s48, v4, 4
  v_cndmask_b32 v4, 0, v4, vcc
  v_add_u32 v3, v3, v4
  v_med3_i32 v3, v3, v6, v9
  v_cmp_le_u32 vcc, s62, v3
  v_add_u32 v5, s63, v8
  v_cmp_gt_u32 s[48:49], 1, v8
  v_cndmask_b32 v4, 0, v7, vcc
  v_add_u32 v3, v3, v4
  v_cndmask_b32 v3, v3, v5, s[48:49]
  buffer_load_dwordx4 v13, s[32:35], s51 offen offset:2048  lds
  v_xor_b32 v3, s50, v3
  s_mov_b32 s48, 131072
  v_mul_lo_u32 v154, v3, s48
  s_and_b32 s48, s24, 7
  s_mul_i32 s48, s48, 524288
  v_lshl_add_u32 v153, v3, 15, s48
  s_sub_u32 s84, s12, 4096
  s_subb_u32 s85, s13, 0
  s_mov_b32 s86, 7344128
  s_mov_b32 s87, 0x20000
  s_sub_u32 s88, s14, 4096
  s_subb_u32 s89, s15, 0
  buffer_load_dwordx4 v14, s[32:35], s51 offen offset:3072  lds
  s_mov_b32 s90, 7344128
  s_mov_b32 s91, 0x20000
  s_sub_u32 s16, s14, 4096
  s_subb_u32 s17, s15, 0
  s_mov_b32 s18, 7344128
  s_mov_b32 s19, 0x20000
  v_mov_b32 v140, 0x1000
  v_mov_b32 v141, 0x1000
  v_mov_b32 v142, 0x1000
  v_mov_b32 v143, 0x1000
  v_mov_b32 v144, 0x1000
  s_add_u32 m0, m0, 4096
  s_nop 0
  buffer_load_dwordx4 v15, s[32:35], s51 offen offset:0  lds
  v_mov_b32 v145, 0x1000
  v_mov_b32 v146, 0x1000
  v_mov_b32 v149, 0x1000
  v_mov_b32 v150, 0x1000
  v_mov_b32 v151, 0x1000
  v_mov_b32 v152, 0x1000
  v_mov_b32 v128, 0
  v_mov_b32 v101, 0
  v_add_u32 v129, 0x750000, v19
  buffer_load_dwordx4 v16, s[32:35], s51 offen offset:1024  lds
  s_mov_b32 s51, s5
  s_waitcnt vmcnt(10)
  s_mov_b32 s52, 3
Ll_layer:
  s_setprio 0
Ll3:
  s_mov_b32 m0, s45
  s_sub_u32 s50, s52, s58
  s_cmp_eq_u32 s50, 0
  s_cbranch_scc1 Le5
  s_cmp_eq_u32 s50, 1
  s_cbranch_scc1 Le6
  s_cmp_eq_u32 s52, s38
  s_cbranch_scc1 Le7
  s_cmp_eq_u32 s52, s93
  s_cbranch_scc1 Le8
  s_barrier
  buffer_load_dwordx4 v20, s[64:67], s44 offen offset:0 sc1 lds
  s_add_u32 s46, s46, 1
  s_add_u32 s45, s45, 16384
  s_cmp_ge_u32 s45, s60
  s_cselect_b32 s45, s53, s45
  buffer_load_dwordx4 v21, s[64:67], s44 offen offset:1024 sc1 lds
  v_readlane_b32 s4, v28, s46
  buffer_load_dwordx4 v22, s[64:67], s44 offen offset:2048 sc1 lds
  buffer_load_dwordx4 v23, s[64:67], s44 offen offset:3072 sc1 lds
  s_mov_b32 s44, s4
  s_mov_b32 m0, s56
  s_add_u32 s47, s47, 1
  buffer_load_dwordx4 v11, s[32:35], s51 offen offset:0  lds
  v_readlane_b32 s5, v29, s47
  s_sub_u32 s56, s56, 24576
  s_cmp_eq_u32 s56, s61
  s_cselect_b32 s56, s54, s56
  buffer_load_dwordx4 v12, s[32:35], s51 offen offset:1024  lds
  v_readlane_b32 s70, v128, s47
  buffer_load_dwordx4 v13, s[32:35], s51 offen offset:2048  lds
  s_load_dwordx2 s[10:11], s[8:9], s70 offset:60
  s_load_dwordx2 s[10:11], s[8:9], s70 offset:2108
  buffer_load_dwordx4 v14, s[32:35], s51 offen offset:3072  lds
  s_add_u32 m0, m0, 4096
  s_nop 0
  buffer_load_dwordx4 v15, s[32:35], s51 offen offset:0  lds
  buffer_load_dwordx4 v16, s[32:35], s51 offen offset:1024  lds
  s_mov_b32 s51, s5
  s_add_u32 s52, s52, 1
  s_cmp_lt_u32 s52, 15
  s_waitcnt vmcnt(10)
Lw4:
  s_cbranch_scc1 Ll3
  s_barrier
  s_xor_b32 s50, s27, 1
  s_or_b32 s50, s50, s22
  s_cmp_lg_u32 s50, 0
  s_cbranch_scc1 Lt13
  v_and_b32 v3, 1, v1
  v_lshlrev_b32 v3, 7, v3
  s_brev_b32 s71, 1
  buffer_load_dword v4, v3, s[72:75], 0 offen sc1
Lt13:
  s_cmp_lg_u32 s27, 2
  s_cbranch_scc1 Lt13b
  s_lshr_b32 s71, s2, 16
  s_add_u32 s42, s69, 512
  buffer_load_dword v4, v17, s[28:31], s42 offen sc1
Lt13b:
  s_mov_b32 m0, s45
  s_nop 0
  buffer_load_dwordx4 v20, s[64:67], s44 offen offset:0 sc1 lds
  s_add_u32 s46, s46, 1
  s_add_u32 s45, s45, 16384
  s_cmp_ge_u32 s45, s60
  s_cselect_b32 s45, s53, s45
  buffer_load_dwordx4 v21, s[64:67], s44 offen offset:1024 sc1 lds
  v_readlane_b32 s4, v28, s46
  buffer_load_dwordx4 v22, s[64:67], s44 offen offset:2048 sc1 lds
  buffer_load_dwordx4 v23, s[64:67], s44 offen offset:3072 sc1 lds
  s_mov_b32 s44, s4
  s_mov_b32 m0, s56
  s_add_u32 s47, s47, 1
  buffer_load_dwordx4 v11, s[32:35], s51 offen offset:0  lds
  v_readlane_b32 s5, v29, s47
  s_sub_u32 s56, s56, 24576
  s_cmp_eq_u32 s56, s61
  s_cselect_b32 s56, s54, s56
  buffer_load_dwordx4 v12, s[32:35], s51 offen offset:1024  lds
  buffer_load_dwordx4 v13, s[32:35], s51 offen offset:2048  lds
  buffer_load_dwordx4 v14, s[32:35], s51 offen offset:3072  lds
  s_add_u32 m0, m0, 4096
  s_nop 0
  buffer_load_dwordx4 v15, s[32:35], s51 offen offset:0  lds
  buffer_load_dwordx4 v16, s[32:35], s51 offen offset:1024  lds
  s_mov_b32 s51, s5
  s_waitcnt vmcnt(10)
  s_cmp_lg_u32 s27, 2
  s_cbranch_scc1 Lt13c
  v_cmp_gt_u32 vcc, s71, v4
  s_nop 4
  s_cbranch_vccz Lt12
  s_mov_b64 exec, 1
  s_mov_b32 s70, 0
Lp14:
  s_sleep 8
  buffer_load_dword v4, v17, s[28:31], s42 offen sc1
  s_add_u32 s70, s70, 1
  s_waitcnt vmcnt(0)
  v_cmp_gt_u32 vcc, s71, v4
  s_cmp_gt_u32 s70, 2097152
  s_cbranch_scc1 Lq15
  s_nop 2
  s_cbranch_vccnz Lp14
Lq15:
  s_mov_b64 exec, -1
Lt13c:
  s_cmp_lg_u32 s50, 0
  s_cbranch_scc1 Lt12
  v_cmp_gt_u32 vcc, s71, v4
  s_nop 4
  s_cbranch_vccz Lt12p
  s_mov_b64 exec, 3
  s_mov_b32 s70, 0
Lp16:
  s_sleep 24
  buffer_load_dword v4, v3, s[72:75], 0 offen sc1
  s_add_u32 s70, s70, 1
  s_waitcnt vmcnt(0)
  v_cmp_gt_u32 vcc, s71, v4
  s_cmp_gt_u32 s70, 2097152
  s_cbranch_scc1 Lq17
  s_nop 2
  s_cbranch_vccnz Lp16
Lq17:
  s_mov_b64 exec, -1
Lt12p:
  v_lshrrev_b32 v3, 5, v3
  v_add_u32 v3, 158720, v3
  s_mov_b64 exec, 3
  ds_write_b32 v3, v4
  s_mov_b64 exec, -1
  s_waitcnt lgkmcnt(0)
Lt12:
  s_barrier
  s_setprio 3
  v_lshrrev_b32 v6, 4, v1
  v_and_b32 v5, 15, v1
  v_lshlrev_b32 v4, 10, v6
  v_lshl_add_u32 v4, v5, 4, v4
  v_lshrrev_b32 v7, 1, v6
  v_mul_u32_u24 v7, 34816, v7
  v_add_u32 v7, v4, v7
  s_lshl_b32 s43, s26, 8
  s_add_u32 s39, s43, s23
  s_lshl_b32 s43, s27, 8
  s_add_u32 s39, s39, 41945088
  s_add_u32 s40, s0, s39
  s_add_u32 s41, s1, s39
  s_cmp_eq_u32 s22, 0
  s_cbranch_scc1 Lt20
  s_add_u32 s50, s40, 0
  buffer_load_dwordx4 v[32:35], v7, s[28:31], s50 offen sc1
  s_add_u32 s50, s40, 81920
  buffer_load_dwordx4 v[36:39], v7, s[28:31], s50 offen sc1
  s_add_u32 s50, s40, 131072
  buffer_load_dwordx4 v[40:43], v7, s[28:31], s50 offen sc1
  s_add_u32 s50, s40, 212992
  buffer_load_dwordx4 v[44:47], v7, s[28:31], s50 offen sc1
  s_add_u32 s50, s41, 0
  buffer_load_dwordx4 v[48:51], v7, s[28:31], s50 offen sc1
  s_add_u32 s50, s41, 81920
  buffer_load_dwordx4 v[52:55], v7, s[28:31], s50 offen sc1
  s_add_u32 s50, s41, 131072
  buffer_load_dwordx4 v[56:59], v7, s[28:31], s50 offen sc1
  s_add_u32 s50, s41, 212992
  buffer_load_dwordx4 v[60:63], v7, s[28:31], s50 offen sc1
  v_readlane_b32 s51, v154, 1
  s_mul_i32 s54, s27, 2048
  s_add_u32 s54, s54, 65536
  s_add_i32 s61, s54, 90112
  s_add_i32 s56, s54, 40960
  s_mov_b32 s47, 1
  s_mov_b32 m0, s56
  s_add_u32 s47, s47, 1
  buffer_load_dwordx4 v147, s[80:83], s51 offen offset:0  lds
  v_readlane_b32 s5, v154, s47
  s_add_u32 s56, s56, 8192
  s_cmp_eq_u32 s56, s61
  s_cselect_b32 s56, s54, s56
  buffer_load_dwordx4 v148, s[80:83], s51 offen offset:1024  lds
  s_mov_b32 s51, s5
  s_mov_b32 m0, s56
  s_add_u32 s47, s47, 1
  buffer_load_dwordx4 v147, s[80:83], s51 offen offset:0  lds
  v_readlane_b32 s5, v154, s47
  s_add_u32 s56, s56, 8192
  s_cmp_eq_u32 s56, s61
  s_cselect_b32 s56, s54, s56
  buffer_load_dwordx4 v148, s[80:83], s51 offen offset:1024  lds
  s_mov_b32 s51, s5
  s_waitcnt vmcnt(12)
  s_barrier
  s_waitcnt vmcnt(4)
  v_add_f32 v32, v32, v48
  v_add_f32 v33, v33, v49
  v_add_f32 v34, v34, v50
  v_add_f32 v35, v35, v51
  v_add_f32 v36, v36, v52
  v_add_f32 v37, v37, v53
  v_add_f32 v38, v38, v54
  v_add_f32 v39, v39, v55
  v_add_f32 v40, v40, v56
  v_add_f32 v41, v41, v57
  v_add_f32 v42, v42, v58
  v_add_f32 v43, v43, v59
  v_add_f32 v44, v44, v60
  v_add_f32 v45, v45, v61
  v_add_f32 v46, v46, v62
  v_add_f32 v47, v47, v63
  v_add_f32 v32, v32, v40
  v_add_f32 v33, v33, v41
  v_add_f32 v34, v34, v42
  v_add_f32 v35, v35, v43
  v_add_f32 v36, v36, v44
  v_add_f32 v37, v37, v45
  v_add_f32 v38, v38, v46
  v_add_f32 v39, v39, v47
  v_add_f32 v32, v32, v36
  v_add_f32 v33, v33, v37
  v_add_f32 v34, v34, v38
  v_add_f32 v35, v35, v39
  v_and_b32 v7, 1, v6
  v_cmp_eq_u32 vcc, 1, v7
  v_permlane32_swap_b32 v32, v34
  v_permlane32_swap_b32 v33, v35
  v_lshlrev_b32 v4, 9, v7
  v_add_f32 v32, v32, v34
  v_add_f32 v33, v33, v35
  v_mov_b32 v34, v32
  v_mov_b32 v35, v33
  v_lshrrev_b32 v7, 1, v6
  v_permlane16_swap_b32 v32, v34
  v_permlane16_swap_b32 v33, v35
  v_lshl_add_u32 v4, v7, 2, v4
  v_add_f32 v32, v32, v34
  v_add_f32 v33, v33, v35
  v_mul_f32 v32, 0xba800000, v32
  v_mul_f32 v33, 0x3a800000, v33
  v_fma_f32 v33, -v32, v32, v33
  v_max_f32 v33, 0, v33
  v_add_f32 v33, 0x3727c5ac, v33
  v_rsq_f32 v33, v33
  v_lshl_add_u32 v4, v5, 3, v4
  v_cndmask_b32 v32, v32, v33, vcc
  s_lshl_b32 s43, s27, 7
  s_add_u32 s43, s43, 155648
  v_add_u32 v4, s43, v4
  ds_write_b32 v4, v32
  s_branch Lt19
Lt20:
  s_lshl_b32 s71, s25, 14
  s_add_u32 s71, s71, s43
  s_add_u32 s71, s71, 96468992
  buffer_load_dwordx4 v[64:67], v4, s[28:31], s71 offen sc1
  s_add_u32 s71, s71, 4096
  v_mov_b32 v3, 158720
  ds_read_b64 v[8:9], v3
  s_mov_b32 s64, s20
  s_mov_b32 s65, s21
  s_mov_b32 s66, 0x10000000
  s_mov_b32 s3, 0
  s_cmp_eq_u32 s27, 1
  s_cselect_b32 s93, 7, 64
  s_waitcnt lgkmcnt(0)
  buffer_load_dwordx4 v[68:71], v4, s[28:31], s71 offen sc1
  s_add_u32 s71, s71, 4096
  v_readfirstlane_b32 s42, v8
  v_readfirstlane_b32 s43, v9
  s_nop 0
  s_bfe_u32 s39, s42, 393216
  s_bfe_u32 s62, s42, 393222
  s_cmp_gt_u32 s62, s39
  s_cselect_b32 s39, 1, 16
  s_or_b32 s3, s3, s39
  s_bfe_u32 s39, s43, 393216
  buffer_load_dwordx4 v[72:75], v4, s[28:31], s71 offen sc1
  s_add_u32 s71, s71, 4096
  s_bfe_u32 s62, s43, 393222
  s_cmp_gt_u32 s62, s39
  s_cselect_b32 s39, 2, 32
  s_or_b32 s3, s3, s39
  s_bfe_u32 s39, s42, 393228
  s_bfe_u32 s62, s42, 393234
  s_cmp_gt_u32 s62, s39
  s_cselect_b32 s39, 4, 64
  s_or_b32 s3, s3, s39
  s_bfe_u32 s39, s43, 393228
  buffer_load_dwordx4 v[76:79], v4, s[28:31], s71 offen sc1
  s_add_u32 s71, s71, 4096
  s_bfe_u32 s62, s43, 393234
  s_cmp_gt_u32 s62, s39
  s_cselect_b32 s39, 8, 128
  s_or_b32 s3, s3, s39
  s_lshr_b32 s55, s24, 2
  s_lshl_b32 s55, s55, 1
  s_lshr_b32 s39, s25, 3
  s_add_u32 s55, s55, s39
  s_lshr_b32 s55, s3, s55
  s_add_u32 s50, s40, 0
  buffer_load_dwordx4 v[32:35], v7, s[28:31], s50 offen sc1
  s_and_b32 s55, s55, 1
  s_lshl_b32 s55, s55, 13
  s_and_b32 s39, s24, 7
  s_lshl_b32 s39, s39, 19
  s_add_u32 s55, s55, s39
  s_lshl_b32 s39, s25, 15
  s_add_u32 s55, s55, s39
  s_lshr_b32 s0, s24, 2
  s_add_u32 s50, s40, 81920
  buffer_load_dwordx4 v[36:39], v7, s[28:31], s50 offen sc1
  s_lshl_b32 s0, s0, 1
  s_lshr_b32 s39, 0, 3
  s_add_u32 s0, s0, s39
  s_lshr_b32 s0, s3, s0
  s_and_b32 s0, s0, 1
  s_lshl_b32 s0, s0, 13
  s_and_b32 s39, s24, 7
  s_lshl_b32 s39, s39, 19
  s_add_u32 s50, s40, 131072
  buffer_load_dwordx4 v[40:43], v7, s[28:31], s50 offen sc1
  s_add_u32 s0, s0, s39
  s_lshl_b32 s39, 0, 15
  s_add_u32 s0, s0, s39
  s_lshr_b32 s1, s24, 2
  s_lshl_b32 s1, s1, 1
  s_lshr_b32 s39, 8, 3
  s_add_u32 s1, s1, s39
  s_lshr_b32 s1, s3, s1
  s_add_u32 s50, s40, 212992
  buffer_load_dwordx4 v[44:47], v7, s[28:31], s50 offen sc1
  s_and_b32 s1, s1, 1
  s_lshl_b32 s1, s1, 13
  s_and_b32 s39, s24, 7
  s_lshl_b32 s39, s39, 19
  s_add_u32 s1, s1, s39
  s_lshl_b32 s39, 8, 15
  s_add_u32 s1, s1, s39
  s_mov_b32 s69, s0
  s_add_u32 s50, s41, 0
  buffer_load_dwordx4 v[48:51], v7, s[28:31], s50 offen sc1
  s_cmp_lt_u32 s25, 8
  s_cselect_b32 s78, s0, s1
  s_cselect_b32 s68, s1, s0
  s_and_b32 s42, s24, 1
  s_lshl_b32 s42, s42, 12
  s_and_b32 s43, s24, 2
  s_lshl_b32 s43, s43, 13
  s_add_u32 s42, s42, s43
  s_add_u32 s42, s42, 92276736
  s_add_u32 s69, s69, s42
  s_add_u32 s50, s41, 81920
  buffer_load_dwordx4 v[52:55], v7, s[28:31], s50 offen sc1
  s_add_u32 s42, s42, 256
  s_add_u32 s78, s78, s42
  s_add_u32 s68, s68, s42
  s_add_u32 s76, s55, s79
  v_mov_b32 v8, s55
  v_mov_b32 v9, s3
  ds_write_b64 v3, v[8:9] offset:8
  s_lshr_b32 s42, s24, 2
  s_add_u32 s50, s41, 131072
  buffer_load_dwordx4 v[56:59], v7, s[28:31], s50 offen sc1
  s_lshl_b32 s43, s42, 1
  s_lshr_b32 s62, s3, s43
  v_bfe_u32 v3, v153, 18, 1
  v_lshrrev_b32 v3, v3, s62
  v_and_b32 v3, 1, v3
  v_lshl_add_u32 v153, v3, 13, v153
  v_add_u32 v153, 4194304, v153
  s_add_u32 s50, s41, 212992
  buffer_load_dwordx4 v[60:63], v7, s[28:31], s50 offen sc1
  s_waitcnt vmcnt(12)
  s_barrier
  s_waitcnt vmcnt(0)
  v_readlane_b32 s51, v154, 1
  s_mul_i32 s54, s27, 2048
  s_add_u32 s54, s54, 65536
  s_add_i32 s61, s54, 90112
  s_add_i32 s56, s54, 40960
  s_mov_b32 s47, 1
  s_mov_b32 m0, s56
  s_add_u32 s47, s47, 1
  buffer_load_dwordx4 v147, s[80:83], s51 offen offset:0  lds
  v_readlane_b32 s5, v154, s47
  s_add_u32 s56, s56, 8192
  s_cmp_eq_u32 s56, s61
  s_cselect_b32 s56, s54, s56
  v_add_f32 v64, v64, v72
  v_add_f32 v65, v65, v73
  v_add_f32 v66, v66, v74
  v_add_f32 v67, v67, v75
  v_add_f32 v68, v68, v76
  v_add_f32 v69, v69, v77
  v_add_f32 v70, v70, v78
  v_add_f32 v71, v71, v79
  v_add_f32 v64, v64, v68
  v_add_f32 v65, v65, v69
  v_add_f32 v66, v66, v70
  v_add_f32 v67, v67, v71
  s_nop 2
  v_permlane32_swap_b32 v64, v66
  v_permlane32_swap_b32 v65, v67
  s_nop 0
  v_add_f32 v64, v64, v66
  v_add_f32 v65, v65, v67
  s_nop 1
  v_permlane16_swap_b32 v64, v65
  s_nop 0
  v_add_f32 v64, v64, v65
  v_lshlrev_b32 v3, 2, v6
  v_lshl_add_u32 v3, v5, 4, v3
  s_lshl_b32 s43, s27, 8
  s_add_u32 s43, s43, 156672
  v_add_u32 v3, s43, v3
  ds_write_b32 v3, v64
  buffer_load_dwordx4 v148, s[80:83], s51 offen offset:1024  lds
  s_mov_b32 s51, s5
  v_add_f32 v32, v32, v48
  v_add_f32 v33, v33, v49
  v_add_f32 v34, v34, v50
  v_add_f32 v35, v35, v51
  v_add_f32 v36, v36, v52
  v_add_f32 v37, v37, v53
  v_add_f32 v38, v38, v54
  v_add_f32 v39, v39, v55
  v_add_f32 v40, v40, v56
  v_add_f32 v41, v41, v57
  v_add_f32 v42, v42, v58
  v_add_f32 v43, v43, v59
  v_add_f32 v44, v44, v60
  v_add_f32 v45, v45, v61
  v_add_f32 v46, v46, v62
  v_add_f32 v47, v47, v63
  v_add_f32 v32, v32, v40
  v_add_f32 v33, v33, v41
  v_add_f32 v34, v34, v42
  v_add_f32 v35, v35, v43
  v_add_f32 v36, v36, v44
  v_add_f32 v37, v37, v45
  v_add_f32 v38, v38, v46
  v_add_f32 v39, v39, v47
  v_add_f32 v32, v32, v36
  v_add_f32 v33, v33, v37
  v_add_f32 v34, v34, v38
  v_add_f32 v35, v35, v39
  s_mov_b32 m0, s56
  s_add_u32 s47, s47, 1
  buffer_load_dwordx4 v147, s[80:83], s51 offen offset:0  lds
  v_readlane_b32 s5, v154, s47
  s_add_u32 s56, s56, 8192
  s_cmp_eq_u32 s56, s61
  s_cselect_b32 s56, s54, s56
  v_and_b32 v7, 1, v6
  v_cmp_eq_u32 vcc, 1, v7
  v_permlane32_swap_b32 v32, v34
  v_permlane32_swap_b32 v33, v35
  v_lshlrev_b32 v4, 9, v7
  v_add_f32 v32, v32, v34
  v_add_f32 v33, v33, v35
  v_mov_b32 v34, v32
  v_mov_b32 v35, v33
  v_lshrrev_b32 v7, 1, v6
  v_permlane16_swap_b32 v32, v34
  v_permlane16_swap_b32 v33, v35
  v_lshl_add_u32 v4, v7, 2, v4
  v_add_f32 v32, v32, v34
  v_add_f32 v33, v33, v35
  v_mul_f32 v32, 0xba800000, v32
  v_mul_f32 v33, 0x3a800000, v33
  v_fma_f32 v33, -v32, v32, v33
  v_max_f32 v33, 0, v33
  v_add_f32 v33, 0x3727c5ac, v33
  v_rsq_f32 v33, v33
  v_lshl_add_u32 v4, v5, 3, v4
  v_cndmask_b32 v32, v32, v33, vcc
  s_lshl_b32 s43, s27, 7
  s_add_u32 s43, s43, 155648
  v_add_u32 v4, s43, v4
  ds_write_b32 v4, v32
  buffer_load_dwordx4 v148, s[80:83], s51 offen offset:1024  lds
  s_mov_b32 s51, s5
Lt19:
  s_waitcnt lgkmcnt(0)
  s_barrier
  s_setprio 3
  v_readlane_b32 s51, v154, 0
  s_mul_i32 s54, s27, 2048
  s_add_u32 s54, s54, 65536
  s_add_i32 s61, s54, 90112
  s_add_i32 s56, s54, 32768
  s_mov_b32 s47, 0
  s_mov_b32 m0, s56
  s_add_u32 s47, s47, 1
  buffer_load_dwordx4 v147, s[80:83], s51 offen offset:0  lds
  v_readlane_b32 s5, v154, s47
  s_add_u32 s56, s56, 8192
  s_cmp_eq_u32 s56, s61
  s_cselect_b32 s56, s54, s56
  buffer_load_dwordx4 v148, s[80:83], s51 offen offset:1024  lds
  s_mov_b32 s51, s5
  v_readlane_b32 s51, v154, 3
  s_mul_i32 s54, s27, 2048
  s_add_u32 s54, s54, 65536
  s_add_i32 s61, s54, 90112
  s_add_i32 s56, s54, 57344
  s_mov_b32 s47, 3
  v_readlane_b32 s44, v153, 1
  s_add_u32 s60, s53, 65536
  s_add_u32 s45, s53, 0
  s_mov_b32 s46, 1
  s_nop 0
  s_barrier
  s_add_u32 s71, s22, 1
  v_mov_b32 v4, s71
  s_cmp_lg_u32 s27, 3
  s_barrier
  s_cbranch_scc1 Lk21
  s_mov_b64 exec, 1
  buffer_store_dword v4, v17, s[28:31], s76 offen sc1
  s_mov_b64 exec, -1
Lk21:
  s_cmp_eq_u32 s24, 0
  s_cbranch_scc1 Lk22
  s_sub_u32 s42, s24, 1
  s_max_i32 s42, s42, 0
  s_lshr_b32 s40, s42, 2
  s_lshl_b32 s40, s40, 1
  s_lshr_b32 s39, s25, 3
  s_add_u32 s40, s40, s39
  s_lshr_b32 s40, s3, s40
  s_and_b32 s40, s40, 1
  s_lshl_b32 s40, s40, 13
  s_and_b32 s39, s42, 7
  s_lshl_b32 s39, s39, 19
  s_add_u32 s40, s40, s39
  s_lshl_b32 s39, s25, 15
  s_add_u32 s40, s40, s39
  s_sub_u32 s42, s24, 2
  s_max_i32 s42, s42, 0
  s_lshr_b32 s41, s42, 2
  s_lshl_b32 s41, s41, 1
  s_lshr_b32 s39, s25, 3
  s_add_u32 s41, s41, s39
  s_lshr_b32 s41, s3, s41
  s_and_b32 s41, s41, 1
  s_lshl_b32 s41, s41, 13
  s_and_b32 s39, s42, 7
  s_lshl_b32 s39, s39, 19
  s_add_u32 s41, s41, s39
  s_lshl_b32 s39, s25, 15
  s_add_u32 s41, s41, s39
  v_mov_b32 v6, s40
  v_mov_b32 v7, s41
  s_mul_i32 s49, s37, 4194304
  s_lshl_b32 s50, s36, 14
  s_add_u32 s49, s49, s50
  s_add_u32 s49, s49, s23
  s_add_u32 s49, s49, 16777216
  s_add_u32 s40, s40, s49
  s_add_u32 s41, s41, s49
  s_mul_i32 s38, s37, 49152
  s_mul_i32 s49, s36, 24576
  s_add_u32 s38, s38, s49
  s_mov_b64 exec, 1
  s_mov_b32 s70, 0
Lp23:
  buffer_load_dword v5, v6, s[28:31], s79 offen sc1
  s_add_u32 s70, s70, 1
  s_waitcnt vmcnt(0)
  v_cmp_gt_u32 vcc, s71, v5
  s_cmp_gt_u32 s70, 2097152
  s_cbranch_scc1 Lq24
  s_nop 2
  s_cbranch_vccnz Lp23
Lq24:
  s_mov_b64 exec, -1
  s_add_u32 m0, s38, 12288
  s_add_u32 s49, s40, 4096
  buffer_load_dwordx4 v19, s[28:31], s49 offen offset:0 sc1 lds
  buffer_load_dwordx4 v19, s[28:31], s49 offen offset:1024 sc1 lds
  buffer_load_dwordx4 v19, s[28:31], s49 offen offset:2048 sc1 lds
  buffer_load_dwordx4 v19, s[28:31], s49 offen offset:3072 sc1 lds
  s_add_u32 m0, s38, 8192
  s_add_u32 s49, s40, 0
  buffer_load_dwordx4 v19, s[28:31], s49 offen offset:0 sc1 lds
  buffer_load_dwordx4 v19, s[28:31], s49 offen offset:1024 sc1 lds
  buffer_load_dwordx4 v19, s[28:31], s49 offen offset:2048 sc1 lds
  buffer_load_dwordx4 v19, s[28:31], s49 offen offset:3072 sc1 lds
  buffer_load_dword v5, v7, s[28:31], s79 offen sc1
  s_waitcnt vmcnt(5)
  s_barrier
  s_waitcnt vmcnt(0)
  v_cmp_gt_u32 vcc, s71, v5
  s_nop 4
  s_cbranch_vccz Lk22c
  s_barrier
  s_mov_b64 exec, 1
  s_mov_b32 s70, 0
Lp25:
  buffer_load_dword v5, v7, s[28:31], s79 offen sc1
  s_add_u32 s70, s70, 1
  s_waitcnt vmcnt(0)
  v_cmp_gt_u32 vcc, s71, v5
  s_cmp_gt_u32 s70, 2097152
  s_cbranch_scc1 Lq26
  s_nop 2
  s_cbranch_vccnz Lp25
Lq26:
  s_mov_b64 exec, -1
  s_add_u32 m0, s38, 4096
  s_add_u32 s49, s41, 4096
  buffer_load_dwordx4 v19, s[28:31], s49 offen offset:0 sc1 lds
  buffer_load_dwordx4 v19, s[28:31], s49 offen offset:1024 sc1 lds
  buffer_load_dwordx4 v19, s[28:31], s49 offen offset:2048 sc1 lds
  buffer_load_dwordx4 v19, s[28:31], s49 offen offset:3072 sc1 lds
  s_branch Lk22d
Lk22c:
  s_add_u32 m0, s38, 4096
  s_add_u32 s49, s41, 4096
  buffer_load_dwordx4 v19, s[28:31], s49 offen offset:0 sc1 lds
  buffer_load_dwordx4 v19, s[28:31], s49 offen offset:1024 sc1 lds
  buffer_load_dwordx4 v19, s[28:31], s49 offen offset:2048 sc1 lds
  buffer_load_dwordx4 v19, s[28:31], s49 offen offset:3072 sc1 lds
  s_barrier
Lk22d:
  s_add_u32 m0, s38, 0
  s_add_u32 s49, s41, 0
  buffer_load_dwordx4 v19, s[28:31], s49 offen offset:0 sc1 lds
  buffer_load_dwordx4 v19, s[28:31], s49 offen offset:1024 sc1 lds
  buffer_load_dwordx4 v19, s[28:31], s49 offen offset:2048 sc1 lds
  buffer_load_dwordx4 v19, s[28:31], s49 offen offset:3072 sc1 lds
  s_branch Lk22b
Lk22:
  s_barrier
  s_barrier
Lk22b:
  s_mov_b32 m0, s56
  s_add_u32 s47, s47, 1
  buffer_load_dwordx4 v147, s[80:83], s51 offen offset:0  lds
  v_readlane_b32 s5, v154, s47
  s_add_u32 s56, s56, 8192
  s_cmp_eq_u32 s56, s61
  s_cselect_b32 s56, s54, s56
  buffer_load_dwordx4 v148, s[80:83], s51 offen offset:1024  lds
  s_mov_b32 s51, s5
  s_mov_b32 m0, s56
  s_add_u32 s47, s47, 1
  buffer_load_dwordx4 v147, s[80:83], s51 offen offset:0  lds
  v_readlane_b32 s5, v154, s47
  s_add_u32 s56, s56, 8192
  s_cmp_eq_u32 s56, s61
  s_cselect_b32 s56, s54, s56
  buffer_load_dwordx4 v148, s[80:83], s51 offen offset:1024  lds
  s_mov_b32 s51, s5
  s_waitcnt vmcnt(4)
  s_barrier
  s_cmp_lg_u32 s22, 0
  s_cbranch_scc1 Lpf27
  v_lshrrev_b32 v5, 3, v1
  v_mul_u32_u24 v5, 7168, v5
  v_and_b32 v6, 7, v1
  v_lshl_add_u32 v5, v6, 4, v5
  s_mul_i32 s42, s24, 458752
  s_mul_i32 s43, s25, 448
  s_add_u32 s42, s42, s43
  s_lshl_b32 s43, s27, 7
  s_add_u32 s42, s42, s43
  s_add_u32 s42, s42, 4096
  buffer_load_dwordx4 v[64:67], v5, s[84:87], s42 offen
  s_add_u32 s42, s42, 57344
  buffer_load_dwordx4 v[68:71], v5, s[84:87], s42 offen
  s_add_u32 s42, s42, 57344
  buffer_load_dwordx4 v[72:75], v5, s[84:87], s42 offen
  s_add_u32 s42, s42, 57344
  buffer_load_dwordx4 v[76:79], v5, s[84:87], s42 offen
  s_add_u32 s42, s42, 57344
  buffer_load_dwordx4 v[80:83], v5, s[84:87], s42 offen
  s_add_u32 s42, s42, 57344
  buffer_load_dwordx4 v[84:87], v5, s[84:87], s42 offen
  s_add_u32 s42, s42, 57344
  buffer_load_dwordx4 v[88:91], v5, s[84:87], s42 offen
  s_add_u32 s42, s42, 57344
  buffer_load_dwordx4 v[92:95], v5, s[84:87], s42 offen
  s_add_u32 s42, s42, 57344
Lpf27:
  s_mov_b32 m0, s56
  s_add_u32 s47, s47, 1
  buffer_load_dwordx4 v147, s[80:83], s51 offen offset:0  lds
  v_readlane_b32 s5, v154, s47
  s_add_u32 s56, s56, 8192
  s_cmp_eq_u32 s56, s61
  s_cselect_b32 s56, s54, s56
  buffer_load_dwordx4 v148, s[80:83], s51 offen offset:1024  lds
  s_mov_b32 s51, s5
  s_mov_b32 m0, s56
  s_add_u32 s47, s47, 1
  buffer_load_dwordx4 v147, s[80:83], s51 offen offset:0  lds
  v_readlane_b32 s5, v154, s47
  s_add_u32 s56, s56, 8192
  s_cmp_eq_u32 s56, s61
  s_cselect_b32 s56, s54, s56
  buffer_load_dwordx4 v148, s[80:83], s51 offen offset:1024  lds
  s_mov_b32 s51, s5
  s_add_u32 s42, s55, s23
  s_add_u32 s42, s42, 12582912
  buffer_store_dwordx4 v[120:123], v30, s[28:31], s42 offen offset:0 sc1
  buffer_store_dwordx4 v[120:123], v30, s[28:31], s42 offen offset:1024 sc1
  buffer_store_dwordx4 v[120:123], v30, s[28:31], s42 offen offset:2048 sc1
  buffer_store_dwordx4 v[120:123], v30, s[28:31], s42 offen offset:3072 sc1
  s_waitcnt vmcnt(0)
  s_barrier
  s_cmp_eq_u32 s22, 0
  s_cbranch_scc1 Lf28
  s_mov_b32 m0, s56
  s_add_u32 s47, s47, 1
  buffer_load_dwordx4 v147, s[80:83], s51 offen offset:0  lds
  v_readlane_b32 s5, v154, s47
  s_add_u32 s56, s56, 8192
  s_cmp_eq_u32 s56, s61
  s_cselect_b32 s56, s54, s56
  buffer_load_dwordx4 v148, s[80:83], s51 offen offset:1024  lds
  s_mov_b32 s51, s5
  s_mov_b32 m0, s56
  s_add_u32 s47, s47, 1
  buffer_load_dwordx4 v147, s[80:83], s51 offen offset:0  lds
  v_readlane_b32 s5, v154, s47
  s_add_u32 s56, s56, 8192
  s_cmp_eq_u32 s56, s61
  s_cselect_b32 s56, s54, s56
  buffer_load_dwordx4 v148, s[80:83], s51 offen offset:1024  lds
  s_mov_b32 s51, s5
  s_mov_b32 m0, s56
  s_add_u32 s47, s47, 1
  buffer_load_dwordx4 v147, s[80:83], s51 offen offset:0  lds
  v_readlane_b32 s5, v154, s47
  s_add_u32 s56, s56, 8192
  s_cmp_eq_u32 s56, s61
  s_cselect_b32 s56, s54, s56
  buffer_load_dwordx4 v148, s[80:83], s51 offen offset:1024  lds
  s_mov_b32 s51, s5
  s_mov_b32 m0, s56
  s_add_u32 s47, s47, 1
  buffer_load_dwordx4 v147, s[80:83], s51 offen offset:0  lds
  v_readlane_b32 s5, v154, s47
  s_add_u32 s56, s56, 8192
  s_cmp_eq_u32 s56, s61
  s_cselect_b32 s56, s54, s56
  buffer_load_dwordx4 v148, s[80:83], s51 offen offset:1024  lds
  s_mov_b32 s51, s5
  s_branch Lf29
Lf28:
  s_mov_b32 m0, s56
  s_add_u32 s47, s47, 1
  buffer_load_dwordx4 v147, s[80:83], s51 offen offset:0  lds
  v_readlane_b32 s5, v154, s47
  s_add_u32 s56, s56, 8192
  s_cmp_eq_u32 s56, s61
  s_cselect_b32 s56, s54, s56
  s_sub_u32 s84, s12, 4096
  s_subb_u32 s85, s13, 0
  s_mov_b32 s86, 7344128
  s_mov_b32 s87, 0x20000
  v_lshrrev_b32 v3, 3, v1
  v_and_b32 v4, 7, v1
  v_and_b32 v5, 6, v3
  v_xor_b32 v4, v4, v5
  v_lshlrev_b32 v4, 4, v4
  s_lshl_b32 s43, s27, 4
  v_mul_u32_u24 v6, 7168, v3
  v_add_u32 v6, v6, v4
  buffer_load_dwordx4 v148, s[80:83], s51 offen offset:1024  lds
  s_mov_b32 s51, s5
  s_mul_i32 s43, s43, 7168
  s_mov_b32 s63, s25
  s_mul_i32 s48, s25, 448
  s_add_u32 s43, s43, s48
  s_and_b32 s48, s25, 1
  s_lshl_b32 s50, s48, 6
  s_add_u32 s50, s43, s50
  s_mul_i32 s48, s48, 384
  s_sub_u32 s48, s43, s48
  s_add_u32 s48, s48, 384
  v_add_u32 v6, s50, v6
  s_mov_b32 m0, s56
  s_add_u32 s47, s47, 1
  buffer_load_dwordx4 v147, s[80:83], s51 offen offset:0  lds
  v_readlane_b32 s5, v154, s47
  s_add_u32 s56, s56, 8192
  s_cmp_eq_u32 s56, s61
  s_cselect_b32 s56, s54, s56
  v_add_u32 v140, 4096, v6
  v_add_u32 v141, 3200, v6
  v_add_u32 v142, 2304, v6
  v_add_u32 v143, 58368, v6
  v_add_u32 v144, 61568, v6
  v_add_u32 v145, 60672, v6
  v_lshrrev_b32 v7, 2, v1
  v_mul_u32_u24 v7, 7168, v7
  v_bfe_u32 v8, v1, 4, 1
  v_lshlrev_b32 v8, 1, v8
  v_and_b32 v9, 3, v1
  buffer_load_dwordx4 v148, s[80:83], s51 offen offset:1024  lds
  s_mov_b32 s51, s5
  v_xor_b32 v8, v8, v9
  v_lshl_add_u32 v7, v8, 4, v7
  v_add_u32 v7, s48, v7
  v_add_u32 v146, 2048, v7
  s_and_b32 s63, s25, 7
  s_and_b32 s50, s25, 8
  v_cmp_lt_u32 vcc, 0, v1
  v_mov_b32 v7, 1
  v_subrev_u32 v8, 0, v1
  v_cndmask_b32 v3, 0, v7, vcc
  v_sub_u32 v3, v1, v3
  s_mov_b32 m0, s56
  s_add_u32 s47, s47, 1
  buffer_load_dwordx4 v147, s[80:83], s51 offen offset:0  lds
  v_readlane_b32 s5, v154, s47
  s_add_u32 s56, s56, 8192
  s_cmp_eq_u32 s56, s61
  s_cselect_b32 s56, s54, s56
  v_cmp_lt_u32 vcc, 7, v1
  v_mov_b32 v9, 14
  s_and_b32 s62, s63, 7
  v_cndmask_b32 v6, 0, 7, vcc
  v_cndmask_b32 v9, 6, v9, vcc
  v_subrev_u32 v4, s57, v3
  v_and_b32 v4, 3, v4
  v_sub_u32 v5, v3, v4
  v_cmp_ge_i32 vcc, v5, v6
  v_add_u32 v5, 2, v5
  v_cmp_le_i32 s[48:49], v5, v9
  buffer_load_dwordx4 v148, s[80:83], s51 offen offset:1024  lds
  s_mov_b32 s51, s5
  v_lshlrev_b32 v4, 2, v4
  s_and_b64 vcc, vcc, s[48:49]
  s_mov_b32 s48, 0x0ff2
  v_bfe_i32 v4, s48, v4, 4
  v_cndmask_b32 v4, 0, v4, vcc
  v_add_u32 v3, v3, v4
  v_med3_i32 v3, v3, v6, v9
  v_cmp_le_u32 vcc, s62, v3
  v_add_u32 v5, s63, v8
  v_cmp_gt_u32 s[48:49], 1, v8
  v_cndmask_b32 v4, 0, v7, vcc
  s_mov_b32 m0, s56
  s_add_u32 s47, s47, 1
  buffer_load_dwordx4 v147, s[80:83], s51 offen offset:0  lds
  v_readlane_b32 s5, v154, s47
  s_add_u32 s56, s56, 8192
  s_cmp_eq_u32 s56, s61
  s_cselect_b32 s56, s54, s56
  v_add_u32 v3, v3, v4
  v_cndmask_b32 v3, v3, v5, s[48:49]
  v_xor_b32 v3, s50, v3
  s_mov_b32 s48, 458752
  v_mul_lo_u32 v156, v3, s48
  s_and_b32 s48, s24, 7
  s_mul_i32 s48, s48, 524288
  v_lshl_add_u32 v155, v3, 15, s48
  s_lshr_b32 s42, s24, 2
  s_lshl_b32 s43, s42, 1
  s_lshr_b32 s62, s3, s43
  buffer_load_dwordx4 v148, s[80:83], s51 offen offset:1024  lds
  s_mov_b32 s51, s5
  v_bfe_u32 v3, v155, 18, 1
  v_lshrrev_b32 v3, v3, s62
  v_and_b32 v3, 1, v3
  v_lshl_add_u32 v155, v3, 13, v155
  v_add_u32 v155, 8388608, v155
Lf29:
  s_add_u32 s77, s77, 8
  v_mov_b32 v10, 1
  s_cmp_lg_u32 s27, 1
  s_barrier
  s_cbranch_scc1 Ls30
  s_mov_b64 exec, 1
  buffer_atomic_add v10, v17, s[28:31], s78 offen sc0 sc1
  s_mov_b64 exec, -1
Ls30:
  s_cmp_lg_u32 s22, 0
  s_cbranch_scc1 Lpf32
  v_lshlrev_b32 v100, 16, v64
  v_and_b32 v101, 0xffff0000, v64
  v_lshlrev_b32 v102, 16, v65
  v_and_b32 v103, 0xffff0000, v65
  v_lshlrev_b32 v104, 16, v66
  v_and_b32 v105, 0xffff0000, v66
  v_lshlrev_b32 v106, 16, v67
  v_and_b32 v107, 0xffff0000, v67
  v_lshlrev_b32 v108, 16, v68
  v_and_b32 v109, 0xffff0000, v68
  v_lshlrev_b32 v110, 16, v69
  v_and_b32 v111, 0xffff0000, v69
  v_lshlrev_b32 v112, 16, v70
  v_and_b32 v113, 0xffff0000, v70
  v_lshlrev_b32 v114, 16, v71
  v_and_b32 v115, 0xffff0000, v71
  v_add_f32 v100, v100, v108
  v_add_f32 v101, v101, v109
  v_add_f32 v102, v102, v110
  v_add_f32 v103, v103, v111
  v_add_f32 v104, v104, v112
  v_add_f32 v105, v105, v113
  v_add_f32 v106, v106, v114
  v_add_f32 v107, v107, v115
  v_lshlrev_b32 v108, 16, v72
  v_and_b32 v109, 0xffff0000, v72
  v_lshlrev_b32 v110, 16, v73
  v_and_b32 v111, 0xffff0000, v73
  v_lshlrev_b32 v112, 16, v74
  v_and_b32 v113, 0xffff0000, v74
  v_lshlrev_b32 v114, 16, v75
  v_and_b32 v115, 0xffff0000, v75
  v_add_f32 v100, v100, v108
  v_add_f32 v101, v101, v109
  v_add_f32 v102, v102, v110
  v_add_f32 v103, v103, v111
  v_add_f32 v104, v104, v112
  v_add_f32 v105, v105, v113
  v_add_f32 v106, v106, v114
  v_add_f32 v107, v107, v115
  v_lshlrev_b32 v108, 16, v76
  v_and_b32 v109, 0xffff0000, v76
  v_lshlrev_b32 v110, 16, v77
  v_and_b32 v111, 0xffff0000, v77
  v_lshlrev_b32 v112, 16, v78
  v_and_b32 v113, 0xffff0000, v78
  v_lshlrev_b32 v114, 16, v79
  v_and_b32 v115, 0xffff0000, v79
  v_add_f32 v100, v100, v108
  v_add_f32 v101, v101, v109
  v_add_f32 v102, v102, v110
  v_add_f32 v103, v103, v111
  v_add_f32 v104, v104, v112
  v_add_f32 v105, v105, v113
  v_add_f32 v106, v106, v114
  v_add_f32 v107, v107, v115
  v_lshlrev_b32 v108, 16, v80
  v_and_b32 v109, 0xffff0000, v80
  v_lshlrev_b32 v110, 16, v81
  v_and_b32 v111, 0xffff0000, v81
  v_lshlrev_b32 v112, 16, v82
  v_and_b32 v113, 0xffff0000, v82
  v_lshlrev_b32 v114, 16, v83
  v_and_b32 v115, 0xffff0000, v83
  v_add_f32 v100, v100, v108
  v_add_f32 v101, v101, v109
  v_add_f32 v102, v102, v110
  v_add_f32 v103, v103, v111
  v_add_f32 v104, v104, v112
  v_add_f32 v105, v105, v113
  v_add_f32 v106, v106, v114
  v_add_f32 v107, v107, v115
  v_lshlrev_b32 v108, 16, v84
  v_and_b32 v109, 0xffff0000, v84
  v_lshlrev_b32 v110, 16, v85
  v_and_b32 v111, 0xffff0000, v85
  v_lshlrev_b32 v112, 16, v86
  v_and_b32 v113, 0xffff0000, v86
  v_lshlrev_b32 v114, 16, v87
  v_and_b32 v115, 0xffff0000, v87
  v_add_f32 v100, v100, v108
  v_add_f32 v101, v101, v109
  v_add_f32 v102, v102, v110
  v_add_f32 v103, v103, v111
  v_add_f32 v104, v104, v112
  v_add_f32 v105, v105, v113
  v_add_f32 v106, v106, v114
  v_add_f32 v107, v107, v115
  v_lshlrev_b32 v108, 16, v88
  v_and_b32 v109, 0xffff0000, v88
  v_lshlrev_b32 v110, 16, v89
  v_and_b32 v111, 0xffff0000, v89
  v_lshlrev_b32 v112, 16, v90
  v_and_b32 v113, 0xffff0000, v90
  v_lshlrev_b32 v114, 16, v91
  v_and_b32 v115, 0xffff0000, v91
  v_add_f32 v100, v100, v108
  v_add_f32 v101, v101, v109
  v_add_f32 v102, v102, v110
  v_add_f32 v103, v103, v111
Lpf32:
  s_cmp_lg_u32 s27, 1
  s_cbranch_scc1 Ls31
  s_waitcnt vmcnt(0)
  v_readfirstlane_b32 s70, v10
  s_nop 0
  s_add_u32 s70, s70, 1
  s_cmp_ge_u32 s70, s77
  s_cbranch_scc1 Ls31
  s_mov_b64 exec, 1
  s_mov_b32 s70, 0
Lp33:
  buffer_load_dword v5, v17, s[28:31], s78 offen sc1
  s_add_u32 s70, s70, 1
  s_waitcnt vmcnt(0)
  v_cmp_gt_u32 vcc, s77, v5
  s_cmp_gt_u32 s70, 2097152
  s_cbranch_scc1 Lq34
  s_nop 2
  s_cbranch_vccnz Lp33
Lq34:
  s_mov_b64 exec, -1
Ls31:
  s_barrier
  s_mov_b32 m0, s45
  s_nop 0
  buffer_load_dwordx4 v30, s[64:67], s44 offen offset:0 sc1 lds
  s_add_u32 s46, s46, 1
  s_add_u32 s45, s45, 16384
  s_cmp_ge_u32 s45, s60
  s_cselect_b32 s45, s53, s45
  buffer_load_dwordx4 v30, s[64:67], s44 offen offset:1024 sc1 lds
  v_readlane_b32 s4, v153, s46
  buffer_load_dwordx4 v30, s[64:67], s44 offen offset:2048 sc1 lds
  buffer_load_dwordx4 v30, s[64:67], s44 offen offset:3072 sc1 lds
  s_mov_b32 s44, s4
  s_mov_b32 m0, s45
  s_nop 0
  buffer_load_dwordx4 v30, s[64:67], s44 offen offset:0 sc1 lds
  s_add_u32 s46, s46, 1
  s_add_u32 s45, s45, 16384
  s_cmp_ge_u32 s45, s60
  s_cselect_b32 s45, s53, s45
  buffer_load_dwordx4 v30, s[64:67], s44 offen offset:1024 sc1 lds
  v_readlane_b32 s4, v153, s46
  buffer_load_dwordx4 v30, s[64:67], s44 offen offset:2048 sc1 lds
  buffer_load_dwordx4 v30, s[64:67], s44 offen offset:3072 sc1 lds
  s_mov_b32 s44, s4
  s_mov_b32 m0, s45
  s_nop 0
  buffer_load_dwordx4 v30, s[64:67], s44 offen offset:0 sc1 lds
  s_add_u32 s46, s46, 1
  s_add_u32 s45, s45, 16384
  s_cmp_ge_u32 s45, s60
  s_cselect_b32 s45, s53, s45
  buffer_load_dwordx4 v30, s[64:67], s44 offen offset:1024 sc1 lds
  v_readlane_b32 s4, v153, s46
  buffer_load_dwordx4 v30, s[64:67], s44 offen offset:2048 sc1 lds
  buffer_load_dwordx4 v30, s[64:67], s44 offen offset:3072 sc1 lds
  s_mov_b32 s44, s4
  s_mov_b32 m0, s45
  s_waitcnt vmcnt(8) lgkmcnt(0)
  s_barrier
  buffer_load_dwordx4 v30, s[64:67], s44 offen offset:0 sc1 lds
  s_add_u32 s46, s46, 1
  s_add_u32 s45, s45, 16384
  s_cmp_ge_u32 s45, s60
  s_cselect_b32 s45, s53, s45
  buffer_load_dwordx4 v30, s[64:67], s44 offen offset:1024 sc1 lds
  v_readlane_b32 s4, v153, s46
  buffer_load_dwordx4 v30, s[64:67], s44 offen offset:2048 sc1 lds
  buffer_load_dwordx4 v30, s[64:67], s44 offen offset:3072 sc1 lds
  s_mov_b32 s44, s4
  s_mov_b32 m0, s45
  s_waitcnt vmcnt(8) lgkmcnt(0)
  s_barrier
  buffer_load_dwordx4 v30, s[64:67], s44 offen offset:0 sc1 lds
  s_add_u32 s46, s46, 1
  s_add_u32 s45, s45, 16384
  s_cmp_ge_u32 s45, s60
  s_cselect_b32 s45, s53, s45
  buffer_load_dwordx4 v30, s[64:67], s44 offen offset:1024 sc1 lds
  v_readlane_b32 s4, v153, s46
  buffer_load_dwordx4 v30, s[64:67], s44 offen offset:2048 sc1 lds
  buffer_load_dwordx4 v30, s[64:67], s44 offen offset:3072 sc1 lds
  s_mov_b32 s44, s4
  s_mov_b32 m0, s56
  s_add_u32 s47, s47, 1
  buffer_load_dwordx4 v147, s[80:83], s51 offen lds
  v_readlane_b32 s5, v154, s47
  s_mov_b32 m0, s45
  s_waitcnt vmcnt(9) lgkmcnt(0)
  s_cmp_lg_u32 s27, 1
  s_barrier
  s_cbranch_scc1 Lo37
  buffer_load_dword v4, v17, s[28:31], s68 offen sc1
Lo37:
  buffer_load_dwordx4 v30, s[64:67], s44 offen offset:0 sc1 lds
  s_add_u32 s46, s46, 1
  s_add_u32 s45, s45, 16384
  s_cmp_ge_u32 s45, s60
  s_cselect_b32 s45, s53, s45
  buffer_load_dwordx4 v30, s[64:67], s44 offen offset:1024 sc1 lds
  v_readlane_b32 s4, v153, s46
  buffer_load_dwordx4 v30, s[64:67], s44 offen offset:2048 sc1 lds
  buffer_load_dwordx4 v30, s[64:67], s44 offen offset:3072 sc1 lds
  s_mov_b32 s44, s4
  s_mov_b32 m0, s56
  s_add_u32 s56, s56, 8192
  buffer_load_dwordx4 v148, s[80:83], s51 offen offset:1024 lds
  s_mov_b32 s51, s5
  s_mov_b32 m0, s45
  s_waitcnt vmcnt(10) lgkmcnt(0)
  s_barrier
  buffer_load_dwordx4 v30, s[64:67], s44 offen offset:0 sc1 lds
  s_add_u32 s46, s46, 1
  s_add_u32 s45, s45, 16384
  s_cmp_ge_u32 s45, s60
  s_cselect_b32 s45, s53, s45
  buffer_load_dwordx4 v30, s[64:67], s44 offen offset:1024 sc1 lds
  v_readlane_b32 s4, v153, s46
  buffer_load_dwordx4 v30, s[64:67], s44 offen offset:2048 sc1 lds
  buffer_load_dwordx4 v30, s[64:67], s44 offen offset:3072 sc1 lds
  s_mov_b32 s44, s4
  s_mov_b32 m0, s56
  s_add_u32 s47, s47, 1
  buffer_load_dwordx4 v147, s[80:83], s51 offen lds
  v_readlane_b32 s5, v154, s47
  s_mov_b32 m0, s45
  s_waitcnt vmcnt(11) lgkmcnt(0)
  s_cmp_lg_u32 s27, 1
  s_cbranch_scc1 Lo39
  s_waitcnt vmcnt(10)
  v_cmp_gt_u32 vcc, s77, v4
  s_nop 4
  s_cbranch_vccz Lo39
  s_mov_b64 exec, 1
  s_mov_b32 s70, 0
Lp40:
  buffer_load_dword v4, v17, s[28:31], s68 offen sc1
  s_add_u32 s70, s70, 1
  s_waitcnt vmcnt(0)
  v_cmp_gt_u32 vcc, s77, v4
  s_cmp_gt_u32 s70, 2097152
  s_cbranch_scc1 Lq41
  s_nop 2
  s_cbranch_vccnz Lp40
Lq41:
  s_mov_b64 exec, -1
Lo39:
  s_barrier
  buffer_load_dwordx4 v30, s[64:67], s44 offen offset:0 sc1 lds
  s_add_u32 s46, s46, 1
  s_add_u32 s45, s45, 16384
  s_cmp_ge_u32 s45, s60
  s_cselect_b32 s45, s53, s45
  buffer_load_dwordx4 v30, s[64:67], s44 offen offset:1024 sc1 lds
  v_readlane_b32 s4, v153, s46
  buffer_load_dwordx4 v30, s[64:67], s44 offen offset:2048 sc1 lds
  buffer_load_dwordx4 v30, s[64:67], s44 offen offset:3072 sc1 lds
  s_mov_b32 s44, s4
  s_mov_b32 m0, s56
  s_add_u32 s56, s56, 8192
  buffer_load_dwordx4 v148, s[80:83], s51 offen offset:1024 lds
  s_mov_b32 s51, s5
  s_mov_b32 m0, s45
  s_waitcnt vmcnt(11) lgkmcnt(0)
  s_barrier
  buffer_load_dwordx4 v30, s[64:67], s44 offen offset:0 sc1 lds
  s_add_u32 s46, s46, 1
  s_add_u32 s45, s45, 16384
  s_cmp_ge_u32 s45, s60
  s_cselect_b32 s45, s53, s45
  buffer_load_dwordx4 v30, s[64:67], s44 offen offset:1024 sc1 lds
  v_readlane_b32 s4, v153, s46
  buffer_load_dwordx4 v30, s[64:67], s44 offen offset:2048 sc1 lds
  buffer_load_dwordx4 v30, s[64:67], s44 offen offset:3072 sc1 lds
  s_mov_b32 s44, s4
  s_mov_b32 m0, s56
  s_add_u32 s47, s47, 1
  buffer_load_dwordx4 v147, s[80:83], s51 offen lds
  v_readlane_b32 s5, v154, s47
  s_mov_b32 m0, s45
  s_waitcnt vmcnt(11) lgkmcnt(0)
  s_barrier
  buffer_load_dwordx4 v30, s[64:67], s44 offen offset:0 sc1 lds
  s_add_u32 s46, s46, 1
  s_add_u32 s45, s45, 16384
  s_cmp_ge_u32 s45, s60
  s_cselect_b32 s45, s53, s45
  buffer_load_dwordx4 v30, s[64:67], s44 offen offset:1024 sc1 lds
  v_readlane_b32 s4, v153, s46
  buffer_load_dwordx4 v30, s[64:67], s44 offen offset:2048 sc1 lds
  buffer_load_dwordx4 v30, s[64:67], s44 offen offset:3072 sc1 lds
  s_mov_b32 s44, s4
  s_mov_b32 m0, s56
  s_add_u32 s56, s56, 8192
  buffer_load_dwordx4 v148, s[80:83], s51 offen offset:1024 lds
  s_mov_b32 s51, s5
  s_mov_b32 m0, s45
  s_waitcnt vmcnt(11) lgkmcnt(0)
  s_barrier
  buffer_load_dwordx4 v30, s[64:67], s44 offen offset:0 sc1 lds
  s_add_u32 s46, s46, 1
  s_add_u32 s45, s45, 16384
  s_cmp_ge_u32 s45, s60
  s_cselect_b32 s45, s53, s45
  buffer_load_dwordx4 v30, s[64:67], s44 offen offset:1024 sc1 lds
  v_readlane_b32 s4, v153, s46
  buffer_load_dwordx4 v30, s[64:67], s44 offen offset:2048 sc1 lds
  buffer_load_dwordx4 v30, s[64:67], s44 offen offset:3072 sc1 lds
  s_mov_b32 s44, s4
  s_mov_b32 m0, s56
  s_add_u32 s47, s47, 1
  buffer_load_dwordx4 v147, s[80:83], s51 offen lds
  v_readlane_b32 s5, v154, s47
  s_mov_b32 m0, s45
  s_waitcnt vmcnt(11) lgkmcnt(0)
  s_barrier
  buffer_load_dwordx4 v30, s[64:67], s44 offen offset:0 sc1 lds
  s_add_u32 s46, s46, 1
  s_add_u32 s45, s45, 16384
  s_cmp_ge_u32 s45, s60
  s_cselect_b32 s45, s53, s45
  buffer_load_dwordx4 v30, s[64:67], s44 offen offset:1024 sc1 lds
  v_readlane_b32 s4, v153, s46
  buffer_load_dwordx4 v30, s[64:67], s44 offen offset:2048 sc1 lds
  buffer_load_dwordx4 v30, s[64:67], s44 offen offset:3072 sc1 lds
  s_mov_b32 s44, s4
  s_mov_b32 m0, s56
  s_add_u32 s56, s56, 8192
  buffer_load_dwordx4 v148, s[80:83], s51 offen offset:1024 lds
  s_mov_b32 s51, s5
  s_mov_b32 m0, s45
  s_waitcnt vmcnt(11) lgkmcnt(0)
  s_barrier
  buffer_load_dwordx4 v30, s[64:67], s44 offen offset:0 sc1 lds
  s_add_u32 s46, s46, 1
  s_add_u32 s45, s45, 16384
  s_cmp_ge_u32 s45, s60
  s_cselect_b32 s45, s53, s45
  buffer_load_dwordx4 v30, s[64:67], s44 offen offset:1024 sc1 lds
  v_readlane_b32 s4, v153, s46
  buffer_load_dwordx4 v30, s[64:67], s44 offen offset:2048 sc1 lds
  buffer_load_dwordx4 v30, s[64:67], s44 offen offset:3072 sc1 lds
  s_mov_b32 s44, s4
  s_mov_b32 m0, s56
  s_add_u32 s47, s47, 1
  buffer_load_dwordx4 v147, s[80:83], s51 offen lds
  v_readlane_b32 s5, v154, s47
  s_mov_b32 m0, s45
  s_waitcnt vmcnt(11) lgkmcnt(0)
  s_barrier
  buffer_load_dwordx4 v30, s[64:67], s44 offen offset:0 sc1 lds
  s_add_u32 s46, s46, 1
  s_add_u32 s45, s45, 16384
  s_cmp_ge_u32 s45, s60
  s_cselect_b32 s45, s53, s45
  buffer_load_dwordx4 v30, s[64:67], s44 offen offset:1024 sc1 lds
  v_readlane_b32 s4, v153, s46
  buffer_load_dwordx4 v30, s[64:67], s44 offen offset:2048 sc1 lds
  buffer_load_dwordx4 v30, s[64:67], s44 offen offset:3072 sc1 lds
  s_mov_b32 s44, s4
  s_mov_b32 m0, s56
  s_add_u32 s56, s56, 8192
  buffer_load_dwordx4 v148, s[80:83], s51 offen offset:1024 lds
  s_mov_b32 s51, s5
  s_mov_b32 m0, s45
  s_waitcnt vmcnt(11) lgkmcnt(0)
  s_barrier
  buffer_load_dwordx4 v30, s[64:67], s44 offen offset:0 sc1 lds
  s_add_u32 s46, s46, 1
  s_add_u32 s45, s45, 16384
  s_cmp_ge_u32 s45, s60
  s_cselect_b32 s45, s53, s45
  buffer_load_dwordx4 v30, s[64:67], s44 offen offset:1024 sc1 lds
  v_readlane_b32 s4, v153, s46
  buffer_load_dwordx4 v30, s[64:67], s44 offen offset:2048 sc1 lds
  buffer_load_dwordx4 v30, s[64:67], s44 offen offset:3072 sc1 lds
  s_mov_b32 s44, s4
  v_readlane_b32 s51, v156, 1
  s_mul_i32 s54, s27, 7168
  s_add_u32 s54, s54, 49152
  s_add_i32 s61, s54, 86016
  s_add_i32 s56, s54, 28672
  s_mov_b32 s47, 1
  s_waitcnt vmcnt(10)
  s_barrier
  s_mov_b32 m0, s56
  s_add_u32 s47, s47, 1
  buffer_load_dwordx4 v140, s[84:87], s51 offen offset:0  lds
  v_readlane_b32 s5, v156, s47
  s_add_u32 s56, s56, 28672
  s_cmp_eq_u32 s56, s61
  s_cselect_b32 s56, s54, s56
  buffer_load_dwordx4 v141, s[84:87], s51 offen offset:1024  lds
  buffer_load_dwordx4 v142, s[84:87], s51 offen offset:2048  lds
  buffer_load_dwordx4 v143, s[84:87], s51 offen offset:3072  lds
  s_add_u32 m0, m0, 4096
  s_nop 0
  buffer_load_dwordx4 v144, s[84:87], s51 offen offset:0  lds
  buffer_load_dwordx4 v145, s[84:87], s51 offen offset:1024  lds
  s_waitcnt vmcnt(11)
  s_barrier
  buffer_load_dwordx4 v146, s[84:87], s51 offen offset:2048  lds
  s_mov_b32 s51, s5
  v_readlane_b32 s51, v156, 0
  s_mul_i32 s54, s27, 7168
  s_add_u32 s54, s54, 49152
  s_add_i32 s61, s54, 86016
  s_add_i32 s56, s54, 0
  s_mov_b32 s47, 0
  s_mov_b32 m0, s56
  s_add_u32 s47, s47, 1
  buffer_load_dwordx4 v140, s[84:87], s51 offen offset:0  lds
  v_readlane_b32 s5, v156, s47
  s_add_u32 s56, s56, 28672
  s_cmp_eq_u32 s56, s61
  s_cselect_b32 s56, s54, s56
  buffer_load_dwordx4 v141, s[84:87], s51 offen offset:1024  lds
  buffer_load_dwordx4 v142, s[84:87], s51 offen offset:2048  lds
  buffer_load_dwordx4 v143, s[84:87], s51 offen offset:3072  lds
  s_add_u32 m0, m0, 4096
  s_nop 0
  buffer_load_dwordx4 v144, s[84:87], s51 offen offset:0  lds
  s_waitcnt vmcnt(12)
  s_barrier
  buffer_load_dwordx4 v145, s[84:87], s51 offen offset:1024  lds
  buffer_load_dwordx4 v146, s[84:87], s51 offen offset:2048  lds
  s_mov_b32 s51, s5
  v_readlane_b32 s51, v156, 2
  s_mul_i32 s54, s27, 7168
  s_add_u32 s54, s54, 49152
  s_add_i32 s61, s54, 86016
  s_add_i32 s56, s54, 57344
  s_mov_b32 s47, 2
  s_barrier
  s_mov_b32 m0, s56
  s_add_u32 s47, s47, 1
  buffer_load_dwordx4 v140, s[84:87], s51 offen offset:0  lds
  v_readlane_b32 s5, v156, s47
  s_add_u32 s56, s56, 28672
  s_cmp_eq_u32 s56, s61
  s_cselect_b32 s56, s54, s56
  buffer_load_dwordx4 v141, s[84:87], s51 offen offset:1024  lds
  buffer_load_dwordx4 v142, s[84:87], s51 offen offset:2048  lds
  buffer_load_dwordx4 v143, s[84:87], s51 offen offset:3072  lds
  s_add_u32 m0, m0, 4096
  s_nop 0
  buffer_load_dwordx4 v144, s[84:87], s51 offen offset:0  lds
  buffer_load_dwordx4 v145, s[84:87], s51 offen offset:1024  lds
  buffer_load_dwordx4 v146, s[84:87], s51 offen offset:2048  lds
  s_mov_b32 s51, s5
  s_cmp_lg_u32 s22, 0
  s_cbranch_scc1 Lpf49
  v_add_f32 v104, v104, v112
  v_add_f32 v105, v105, v113
  v_add_f32 v106, v106, v114
  v_add_f32 v107, v107, v115
  v_lshlrev_b32 v108, 16, v92
  v_and_b32 v109, 0xffff0000, v92
  v_lshlrev_b32 v110, 16, v93
  v_and_b32 v111, 0xffff0000, v93
  v_lshlrev_b32 v112, 16, v94
  v_and_b32 v113, 0xffff0000, v94
  v_lshlrev_b32 v114, 16, v95
  v_and_b32 v115, 0xffff0000, v95
  v_add_f32 v100, v100, v108
  v_add_f32 v101, v101, v109
  v_add_f32 v102, v102, v110
  v_add_f32 v103, v103, v111
  v_add_f32 v104, v104, v112
  v_add_f32 v105, v105, v113
  v_add_f32 v106, v106, v114
  v_add_f32 v107, v107, v115
  s_nop 1
  v_permlane32_swap_b32 v100, v104
  v_permlane32_swap_b32 v101, v105
  v_permlane32_swap_b32 v102, v106
  v_permlane32_swap_b32 v103, v107
  v_add_f32 v100, v100, v104
  v_add_f32 v101, v101, v105
  v_add_f32 v102, v102, v106
  v_add_f32 v103, v103, v107
  s_nop 1
  v_permlane16_swap_b32 v100, v102
  v_permlane16_swap_b32 v101, v103
  s_nop 0
  v_add_f32 v100, v100, v102
  v_add_f32 v101, v101, v103
  v_and_b32 v104, 8, v1
  v_cmp_ne_u32 vcc, 0, v104
  v_add_f32_dpp v102, v100, v100 row_ror:8 row_mask:0xf bank_mask:0xf
  v_add_f32_dpp v103, v101, v101 row_ror:8 row_mask:0xf bank_mask:0xf
  v_and_b32 v101, 7, v1
  v_cndmask_b32 v100, v102, v103, vcc
  v_lshrrev_b32 v104, 3, v1
  v_lshl_add_u32 v101, v101, 3, v104
  v_lshlrev_b32 v101, 2, v101
Lpf49:
  v_readlane_b32 s51, v156, 3
  s_mul_i32 s54, s27, 7168
  s_add_u32 s54, s54, 49152
  s_add_i32 s61, s54, 86016
  s_add_i32 s56, s54, 0
  s_mov_b32 s47, 3
  v_readlane_b32 s44, v155, 1
  s_add_u32 s60, s53, 49152
  s_add_u32 s45, s53, 16384
  s_mov_b32 s46, 1
  s_nop 0
  s_waitcnt vmcnt(7)
  s_add_u32 s77, s77, 8
  v_mov_b32 v10, 1
  s_cmp_lg_u32 s27, 1
  s_barrier
  s_cbranch_scc1 Ls50
  s_mov_b64 exec, 1
  buffer_atomic_add v10, v17, s[28:31], s78 offen sc0 sc1
  s_mov_b64 exec, -1
Ls50:
  s_cmp_lg_u32 s22, 0
  s_cbranch_scc1 Lpf52
  s_sub_u32 s88, s14, 4096
  s_subb_u32 s89, s15, 0
  s_mov_b32 s90, 7344128
  s_mov_b32 s91, 0x20000
  v_lshrrev_b32 v3, 3, v1
  v_and_b32 v4, 7, v1
  v_and_b32 v5, 6, v3
  v_xor_b32 v4, v4, v5
  v_lshlrev_b32 v4, 4, v4
  s_lshl_b32 s43, s27, 4
  v_mul_u32_u24 v6, 2048, v3
  v_add_u32 v6, v6, v4
  s_mul_i32 s43, s43, 2048
  s_mov_b32 s63, s25
  s_add_u32 s49, s25, 1
  s_and_b32 s49, s49, 7
  s_add_u32 s49, s49, 8
  s_sub_u32 s48, s25, 9
  s_and_b32 s48, s48, 7
  s_cmp_lt_u32 s25, 8
  s_cselect_b32 s49, s49, s48
  s_add_u32 s40, s20, 100659328
  s_addc_u32 s41, s21, 0
  s_and_b32 s48, s25, 7
  s_cmp_eq_u32 s48, 3
  s_cselect_b32 s16, s40, s88
  s_cselect_b32 s17, s41, s89
  s_mov_b32 s18, 7344128
  s_mov_b32 s19, 0x20000
  s_and_b32 s48, s49, 7
  s_cmp_eq_u32 s48, 3
  s_cselect_b32 s88, s40, s88
  s_cselect_b32 s89, s41, s89
  s_lshr_b32 s48, s25, 3
  s_mul_i32 s48, s48, 3670016
  s_add_u32 s43, s43, s48
  s_lshl_b32 s49, s49, 7
  s_lshl_b32 s50, s25, 7
  s_add_u32 s49, s49, s43
  s_add_u32 s50, s50, s43
  v_add_u32 v7, s50, v6
  v_add_u32 v6, s49, v6
  s_and_b32 s63, s25, 7
  s_mul_i32 s63, s63, 7
  s_add_u32 s63, s63, 1
  s_lshr_b32 s63, s63, 1
  v_add_u32 v149, 4096, v6
  v_add_u32 v150, 3072, v7
  v_add_u32 v151, 18432, v6
  v_add_u32 v152, 17408, v7
  v_mul_u32_u24 v3, 37, v1
  v_lshrrev_b32 v3, 8, v3
  v_mul_u32_u24 v3, 7, v3
  v_sub_u32 v3, v1, v3
  v_and_b32 v3, 5, v3
  v_subrev_u32 v8, s63, v1
  v_cmp_eq_u32 s[48:49], 0, v3
  v_cmp_le_u32 s[42:43], 3, v8
  s_nop 0
  s_and_b32 s42, s42, 0xfffffff
  s_and_b32 s48, s48, s42
  s_andn2_b32 s43, s42, s48
  s_mov_b32 s49, 0
  s_bcnt1_i32_b32 s50, s48
  v_mbcnt_lo_u32_b32 v4, s48, 0
  v_mbcnt_lo_u32_b32 v5, s43, 0
  s_sub_u32 s43, 24, s50
  v_cndmask_b32 v3, v5, v4, s[48:49]
  v_mov_b32 v6, s43
  s_sub_u32 s43, s50, 1
  v_mov_b32 v7, s43
  v_cndmask_b32 v6, v6, v7, s[48:49]
  s_add_u32 s50, s50, 3
  v_mov_b32 v7, s50
  v_cndmask_b32 v7, v7, 3, s[48:49]
  v_add_u32 v4, v3, v7
  v_subrev_u32 v4, s57, v4
  v_and_b32 v4, 3, v4
  v_cmp_eq_u32 vcc, 0, v4
  v_cmp_eq_u32 s[48:49], 1, v4
  s_mov_b32 s43, 0
  v_sub_u32 v5, v3, v4
  v_cmp_le_i32 vcc, 0, v5
  v_add_u32 v5, 2, v5
  v_cmp_le_i32 s[48:49], v5, v6
  v_lshlrev_b32 v4, 2, v4
  s_and_b64 vcc, vcc, s[48:49]
  s_mov_b32 s48, 0x0e11
  v_bfe_i32 v4, s48, v4, 4
  v_cndmask_b32 v4, 0, v4, vcc
  v_add_u32 v3, v3, v4
  v_med3_i32 v3, v3, 0, v6
  v_add_u32 v3, v3, v7
  v_cmp_gt_u32 vcc, 28, v1
  v_cndmask_b32 v3, v8, v3, s[42:43]
  s_nop 0
  v_cndmask_b32 v3, v1, v3, vcc
  v_lshlrev_b32 v3, 2, v3
  ds_permute_b32 v3, v3, v1
  s_mov_b32 s48, 131072
  s_waitcnt lgkmcnt(0)
  v_min_u32 v3, 27, v3
  v_mul_lo_u32 v158, v3, s48
  s_and_b32 s48, s24, 7
  s_mul_i32 s48, s48, 1835008
  s_lshr_b32 s49, s25, 3
  s_mul_i32 s49, s49, 917504
  s_add_u32 s48, s48, s49
  v_lshl_add_u32 v157, v3, 15, s48
  s_lshr_b32 s42, s24, 2
  s_lshl_b32 s43, s42, 1
  s_lshr_b32 s62, s3, s43
  s_lshr_b32 s63, s55, 13
  s_xor_b32 s63, s63, s42
  v_lshrrev_b32 v3, 21, v157
  v_xor_b32 v3, s63, v3
  v_and_b32 v3, 1, v3
  v_lshl_add_u32 v157, v3, 13, v157
  v_add_u32 v157, 25165824, v157
Lpf52:
  s_cmp_lg_u32 s27, 1
  s_cbranch_scc1 Ls51
  s_waitcnt vmcnt(0)
  v_readfirstlane_b32 s70, v10
  s_nop 0
  s_add_u32 s70, s70, 1
  s_cmp_ge_u32 s70, s77
  s_cbranch_scc1 Ls51
  s_mov_b64 exec, 1
  s_mov_b32 s70, 0
Lp53:
  buffer_load_dword v5, v17, s[28:31], s78 offen sc1
  s_add_u32 s70, s70, 1
  s_waitcnt vmcnt(0)
  v_cmp_gt_u32 vcc, s77, v5
  s_cmp_gt_u32 s70, 2097152
  s_cbranch_scc1 Lq54
  s_nop 2
  s_cbranch_vccnz Lp53
Lq54:
  s_mov_b64 exec, -1
Ls51:
  s_barrier
  s_mov_b32 m0, s45
  s_nop 0
  buffer_load_dwordx4 v30, s[64:67], s44 offen offset:0 sc1 lds
  s_add_u32 s46, s46, 1
  s_add_u32 s45, s45, 16384
  s_cmp_ge_u32 s45, s60
  s_cselect_b32 s45, s53, s45
  buffer_load_dwordx4 v30, s[64:67], s44 offen offset:1024 sc1 lds
  v_readlane_b32 s4, v155, s46
  buffer_load_dwordx4 v30, s[64:67], s44 offen offset:2048 sc1 lds
  buffer_load_dwordx4 v30, s[64:67], s44 offen offset:3072 sc1 lds
  s_mov_b32 s44, s4
  s_mov_b32 m0, s45
  s_nop 0
  buffer_load_dwordx4 v30, s[64:67], s44 offen offset:0 sc1 lds
  s_add_u32 s46, s46, 1
  s_add_u32 s45, s45, 16384
  s_cmp_ge_u32 s45, s60
  s_cselect_b32 s45, s53, s45
  buffer_load_dwordx4 v30, s[64:67], s44 offen offset:1024 sc1 lds
  v_readlane_b32 s4, v155, s46
  buffer_load_dwordx4 v30, s[64:67], s44 offen offset:2048 sc1 lds
  buffer_load_dwordx4 v30, s[64:67], s44 offen offset:3072 sc1 lds
  s_mov_b32 s44, s4
  s_add_u32 s2, s2, 0x100000
  s_waitcnt vmcnt(4)
  s_cmp_lg_u32 s27, 2
  s_cbranch_scc1 Ls55
  s_mov_b64 exec, 1
  buffer_atomic_add v18, v17, s[28:31], s69 offen offset:512 sc1
  s_mov_b64 exec, -1
Ls55:
  s_mov_b32 s52, 3
  s_cmp_lg_u32 s22, 0
  s_cbranch_scc1 Lpf56
  s_lshl_b32 s39, s25, 14
  s_lshl_b32 s42, s24, 10
  s_add_u32 s39, s39, s42
  s_lshl_b32 s42, s27, 8
  s_add_u32 s42, s42, s39
  s_add_u32 s42, s42, 96731136
  buffer_store_dword v100, v101, s[28:31], s42 offen sc1
  s_mov_b32 s43, 100663808
  buffer_store_dwordx4 v[132:135], v129, s[28:31], s43 offen sc1
Lpf56:
  s_setprio 0
Ll57:
  s_mov_b32 m0, s45
  s_cmp_eq_u32 s52, s59
  s_cbranch_scc1 Le59
  s_cmp_eq_u32 s52, s93
  s_cbranch_scc1 Le60
  s_barrier
  buffer_load_dwordx4 v30, s[64:67], s44 offen offset:0 sc1 lds
  s_add_u32 s46, s46, 1
  s_add_u32 s45, s45, 16384
  s_cmp_ge_u32 s45, s60
  s_cselect_b32 s45, s53, s45
  buffer_load_dwordx4 v30, s[64:67], s44 offen offset:1024 sc1 lds
  v_readlane_b32 s4, v155, s46
  buffer_load_dwordx4 v30, s[64:67], s44 offen offset:2048 sc1 lds
  buffer_load_dwordx4 v30, s[64:67], s44 offen offset:3072 sc1 lds
  s_mov_b32 s44, s4
  s_mov_b32 m0, s56
  s_add_u32 s47, s47, 1
  buffer_load_dwordx4 v140, s[84:87], s51 offen offset:0  lds
  v_readlane_b32 s5, v156, s47
  s_add_u32 s56, s56, 28672
  s_cmp_eq_u32 s56, s61
  s_cselect_b32 s56, s54, s56
  buffer_load_dwordx4 v141, s[84:87], s51 offen offset:1024  lds
  buffer_load_dwordx4 v142, s[84:87], s51 offen offset:2048  lds
  buffer_load_dwordx4 v143, s[84:87], s51 offen offset:3072  lds
  s_add_u32 m0, m0, 4096
  s_nop 0
  buffer_load_dwordx4 v144, s[84:87], s51 offen offset:0  lds
  buffer_load_dwordx4 v145, s[84:87], s51 offen offset:1024  lds
  buffer_load_dwordx4 v146, s[84:87], s51 offen offset:2048  lds
  s_mov_b32 s51, s5
  s_add_u32 s52, s52, 1
  s_cmp_lt_u32 s52, 15
  s_waitcnt vmcnt(11)
Lw58:
  s_cbranch_scc1 Ll57
  s_barrier
  s_xor_b32 s50, s27, 1
  s_or_b32 s50, s50, s22
  s_cmp_lg_u32 s50, 0
  s_cbranch_scc1 Lt65
  v_and_b32 v3, 1, v1
  v_lshlrev_b32 v3, 7, v3
  s_brev_b32 s71, 1
  buffer_load_dword v4, v3, s[72:75], 4 offen sc1
Lt65:
  s_cmp_lg_u32 s27, 2
  s_cbranch_scc1 Lt65b
  s_lshr_b32 s71, s2, 16
  s_add_u32 s42, s69, 512
  buffer_load_dword v4, v17, s[28:31], s42 offen sc1
Lt65b:
  s_mov_b32 m0, s45
  s_nop 0
  buffer_load_dwordx4 v30, s[64:67], s44 offen offset:0 sc1 lds
  s_add_u32 s46, s46, 1
  s_add_u32 s45, s45, 16384
  s_cmp_ge_u32 s45, s60
  s_cselect_b32 s45, s53, s45
  buffer_load_dwordx4 v30, s[64:67], s44 offen offset:1024 sc1 lds
  v_readlane_b32 s4, v155, s46
  buffer_load_dwordx4 v30, s[64:67], s44 offen offset:2048 sc1 lds
  buffer_load_dwordx4 v30, s[64:67], s44 offen offset:3072 sc1 lds
  s_mov_b32 s44, s4
  s_mov_b32 m0, s56
  s_add_u32 s47, s47, 1
  buffer_load_dwordx4 v140, s[84:87], s51 offen offset:0  lds
  v_readlane_b32 s5, v156, s47
  s_add_u32 s56, s56, 28672
  s_cmp_eq_u32 s56, s61
  s_cselect_b32 s56, s54, s56
  buffer_load_dwordx4 v141, s[84:87], s51 offen offset:1024  lds
  buffer_load_dwordx4 v142, s[84:87], s51 offen offset:2048  lds
  buffer_load_dwordx4 v143, s[84:87], s51 offen offset:3072  lds
  s_add_u32 m0, m0, 4096
  s_nop 0
  buffer_load_dwordx4 v144, s[84:87], s51 offen offset:0  lds
  buffer_load_dwordx4 v145, s[84:87], s51 offen offset:1024  lds
  buffer_load_dwordx4 v146, s[84:87], s51 offen offset:2048  lds
  s_mov_b32 s51, s5
  s_waitcnt vmcnt(11)
  s_cmp_lg_u32 s27, 2
  s_cbranch_scc1 Lt65c
  v_cmp_gt_u32 vcc, s71, v4
  s_nop 4
  s_cbranch_vccz Lt64
  s_mov_b64 exec, 1
  s_mov_b32 s70, 0
Lp66:
  s_sleep 8
  buffer_load_dword v4, v17, s[28:31], s42 offen sc1
  s_add_u32 s70, s70, 1
  s_waitcnt vmcnt(0)
  v_cmp_gt_u32 vcc, s71, v4
  s_cmp_gt_u32 s70, 2097152
  s_cbranch_scc1 Lq67
  s_nop 2
  s_cbranch_vccnz Lp66
Lq67:
  s_mov_b64 exec, -1
Lt65c:
  s_cmp_lg_u32 s50, 0
  s_cbranch_scc1 Lt64
  v_cmp_gt_u32 vcc, s71, v4
  s_nop 4
  s_cbranch_vccz Lt64p
  s_mov_b64 exec, 3
  s_mov_b32 s70, 0
Lp68:
  s_sleep 24
  buffer_load_dword v4, v3, s[72:75], 4 offen sc1
  s_add_u32 s70, s70, 1
  s_waitcnt vmcnt(0)
  v_cmp_gt_u32 vcc, s71, v4
  s_cmp_gt_u32 s70, 2097152
  s_cbranch_scc1 Lq69
  s_nop 2
  s_cbranch_vccnz Lp68
Lq69:
  s_mov_b64 exec, -1
Lt64p:
Lt64:
  s_barrier
  s_setprio 3
  v_lshrrev_b32 v6, 4, v1
  v_and_b32 v5, 15, v1
  v_lshlrev_b32 v4, 10, v6
  v_lshl_add_u32 v4, v5, 4, v4
  v_lshrrev_b32 v7, 1, v6
  v_mul_u32_u24 v7, 34816, v7
  v_add_u32 v7, v4, v7
  s_lshl_b32 s43, s27, 8
  s_add_u32 s39, s43, s23
  s_lshl_b32 s43, s27, 8
  s_add_u32 s39, s39, 41943040
  s_add_u32 s40, s0, s39
  s_add_u32 s41, s1, s39
  s_cmp_eq_u32 s22, 0
  s_cbranch_scc1 Lt72
  s_add_u32 s50, s40, 0
  buffer_load_dwordx4 v[32:35], v7, s[28:31], s50 offen sc1
  s_add_u32 s50, s40, 81920
  buffer_load_dwordx4 v[36:39], v7, s[28:31], s50 offen sc1
  s_add_u32 s50, s40, 131072
  buffer_load_dwordx4 v[40:43], v7, s[28:31], s50 offen sc1
  s_add_u32 s50, s40, 212992
  buffer_load_dwordx4 v[44:47], v7, s[28:31], s50 offen sc1
  s_add_u32 s50, s41, 0
  buffer_load_dwordx4 v[48:51], v7, s[28:31], s50 offen sc1
  s_add_u32 s50, s41, 81920
  buffer_load_dwordx4 v[52:55], v7, s[28:31], s50 offen sc1
  s_add_u32 s50, s41, 131072
  buffer_load_dwordx4 v[56:59], v7, s[28:31], s50 offen sc1
  s_add_u32 s50, s41, 212992
  buffer_load_dwordx4 v[60:63], v7, s[28:31], s50 offen sc1
  v_readlane_b32 s51, v158, 1
  s_mul_i32 s54, s27, 4096
  s_add_u32 s54, s54, 65536
  s_add_i32 s61, s54, 81920
  s_add_i32 s56, s54, 16384
  s_mov_b32 s47, 1
  s_mov_b32 m0, s56
  s_add_u32 s47, s47, 1
  buffer_load_dwordx4 v149, s[88:91], s51 offen offset:0 sc1 lds
  v_readlane_b32 s5, v158, s47
  s_add_u32 s56, s56, 16384
  s_cmp_eq_u32 s56, s61
  s_cselect_b32 s56, s54, s56
  buffer_load_dwordx4 v150, s[16:19], s51 offen offset:1024 sc1 lds
  buffer_load_dwordx4 v151, s[88:91], s51 offen offset:2048 sc1 lds
  buffer_load_dwordx4 v152, s[16:19], s51 offen offset:3072 sc1 lds
  s_mov_b32 s51, s5
  s_waitcnt vmcnt(12)
  s_barrier
  s_waitcnt vmcnt(4)
  s_mov_b32 m0, s56
  s_add_u32 s47, s47, 1
  buffer_load_dwordx4 v149, s[88:91], s51 offen offset:0 sc1 lds
  v_readlane_b32 s5, v158, s47
  s_add_u32 s56, s56, 16384
  s_cmp_eq_u32 s56, s61
  s_cselect_b32 s56, s54, s56
  v_add_f32 v32, v32, v48
  v_add_f32 v33, v33, v49
  v_add_f32 v34, v34, v50
  v_add_f32 v35, v35, v51
  v_add_f32 v36, v36, v52
  v_add_f32 v37, v37, v53
  v_add_f32 v38, v38, v54
  v_add_f32 v39, v39, v55
  v_add_f32 v40, v40, v56
  v_add_f32 v41, v41, v57
  v_add_f32 v42, v42, v58
  v_add_f32 v43, v43, v59
  v_add_f32 v44, v44, v60
  v_add_f32 v45, v45, v61
  v_add_f32 v46, v46, v62
  v_add_f32 v47, v47, v63
  v_add_f32 v32, v32, v40
  v_add_f32 v33, v33, v41
  v_add_f32 v34, v34, v42
  buffer_load_dwordx4 v150, s[16:19], s51 offen offset:1024 sc1 lds
  v_add_f32 v35, v35, v43
  v_add_f32 v36, v36, v44
  v_add_f32 v37, v37, v45
  v_add_f32 v38, v38, v46
  v_add_f32 v39, v39, v47
  v_add_f32 v32, v32, v36
  v_add_f32 v33, v33, v37
  v_add_f32 v34, v34, v38
  v_add_f32 v35, v35, v39
  v_and_b32 v7, 1, v6
  v_cmp_eq_u32 vcc, 1, v7
  v_permlane32_swap_b32 v32, v34
  v_permlane32_swap_b32 v33, v35
  v_lshlrev_b32 v4, 9, v7
  v_add_f32 v32, v32, v34
  v_add_f32 v33, v33, v35
  v_mov_b32 v34, v32
  v_mov_b32 v35, v33
  v_lshrrev_b32 v7, 1, v6
  buffer_load_dwordx4 v151, s[88:91], s51 offen offset:2048 sc1 lds
  v_permlane16_swap_b32 v32, v34
  v_permlane16_swap_b32 v33, v35
  v_lshl_add_u32 v4, v7, 2, v4
  v_add_f32 v32, v32, v34
  v_add_f32 v33, v33, v35
  v_mul_f32 v32, 0xba800000, v32
  v_mul_f32 v33, 0x3a800000, v33
  v_fma_f32 v33, -v32, v32, v33
  v_max_f32 v33, 0, v33
  v_add_f32 v33, 0x3727c5ac, v33
  v_rsq_f32 v33, v33
  v_lshl_add_u32 v4, v5, 3, v4
  v_cndmask_b32 v32, v32, v33, vcc
  s_lshl_b32 s43, s27, 7
  s_add_u32 s43, s43, 155648
  v_add_u32 v4, s43, v4
  ds_write_b32 v4, v32
  buffer_load_dwordx4 v152, s[16:19], s51 offen offset:3072 sc1 lds
  s_mov_b32 s51, s5
  s_branch Lt71
Lt72:
  s_lshl_b32 s71, s25, 14
  s_add_u32 s71, s71, s43
  s_add_u32 s71, s71, 96731136
  buffer_load_dwordx4 v[64:67], v4, s[28:31], s71 offen sc1
  s_add_u32 s71, s71, 4096
  buffer_load_dwordx4 v[68:71], v4, s[28:31], s71 offen sc1
  s_add_u32 s71, s71, 4096
  buffer_load_dwordx4 v[72:75], v4, s[28:31], s71 offen sc1
  s_add_u32 s71, s71, 4096
  buffer_load_dwordx4 v[76:79], v4, s[28:31], s71 offen sc1
  s_add_u32 s71, s71, 4096
  s_add_u32 s50, s40, 0
  buffer_load_dwordx4 v[32:35], v7, s[28:31], s50 offen sc1
  s_add_u32 s50, s40, 81920
  buffer_load_dwordx4 v[36:39], v7, s[28:31], s50 offen sc1
  s_add_u32 s50, s40, 131072
  buffer_load_dwordx4 v[40:43], v7, s[28:31], s50 offen sc1
  s_add_u32 s50, s40, 212992
  buffer_load_dwordx4 v[44:47], v7, s[28:31], s50 offen sc1
  s_add_u32 s50, s41, 0
  buffer_load_dwordx4 v[48:51], v7, s[28:31], s50 offen sc1
  s_add_u32 s50, s41, 81920
  buffer_load_dwordx4 v[52:55], v7, s[28:31], s50 offen sc1
  s_add_u32 s50, s41, 131072
  buffer_load_dwordx4 v[56:59], v7, s[28:31], s50 offen sc1
  s_add_u32 s50, s41, 212992
  buffer_load_dwordx4 v[60:63], v7, s[28:31], s50 offen sc1
  s_waitcnt vmcnt(12)
  s_barrier
  s_waitcnt vmcnt(0)
  v_readlane_b32 s51, v158, 1
  s_mul_i32 s54, s27, 4096
  s_add_u32 s54, s54, 65536
  s_add_i32 s61, s54, 81920
  s_add_i32 s56, s54, 16384
  s_mov_b32 s47, 1
  s_mov_b32 m0, s56
  s_add_u32 s47, s47, 1
  buffer_load_dwordx4 v149, s[88:91], s51 offen offset:0 sc1 lds
  v_readlane_b32 s5, v158, s47
  s_add_u32 s56, s56, 16384
  s_cmp_eq_u32 s56, s61
  s_cselect_b32 s56, s54, s56
  v_add_f32 v64, v64, v72
  v_add_f32 v65, v65, v73
  v_add_f32 v66, v66, v74
  v_add_f32 v67, v67, v75
  v_add_f32 v68, v68, v76
  v_add_f32 v69, v69, v77
  v_add_f32 v70, v70, v78
  v_add_f32 v71, v71, v79
  v_add_f32 v64, v64, v68
  v_add_f32 v65, v65, v69
  v_add_f32 v66, v66, v70
  v_add_f32 v67, v67, v71
  buffer_load_dwordx4 v150, s[16:19], s51 offen offset:1024 sc1 lds
  s_nop 2
  v_permlane32_swap_b32 v64, v66
  v_permlane32_swap_b32 v65, v67
  s_nop 0
  v_add_f32 v64, v64, v66
  v_add_f32 v65, v65, v67
  s_nop 1
  v_permlane16_swap_b32 v64, v65
  s_nop 0
  v_add_f32 v64, v64, v65
  v_lshlrev_b32 v3, 2, v6
  v_lshl_add_u32 v3, v5, 4, v3
  buffer_load_dwordx4 v151, s[88:91], s51 offen offset:2048 sc1 lds
  s_lshl_b32 s43, s27, 8
  s_add_u32 s43, s43, 157696
  v_add_u32 v3, s43, v3
  ds_write_b32 v3, v64
  v_add_f32 v32, v32, v48
  v_add_f32 v33, v33, v49
  v_add_f32 v34, v34, v50
  v_add_f32 v35, v35, v51
  v_add_f32 v36, v36, v52
  v_add_f32 v37, v37, v53
  v_add_f32 v38, v38, v54
  v_add_f32 v39, v39, v55
  buffer_load_dwordx4 v152, s[16:19], s51 offen offset:3072 sc1 lds
  s_mov_b32 s51, s5
  v_add_f32 v40, v40, v56
  v_add_f32 v41, v41, v57
  v_add_f32 v42, v42, v58
  v_add_f32 v43, v43, v59
  v_add_f32 v44, v44, v60
  v_add_f32 v45, v45, v61
  v_add_f32 v46, v46, v62
  v_add_f32 v47, v47, v63
  v_add_f32 v32, v32, v40
  v_add_f32 v33, v33, v41
  v_add_f32 v34, v34, v42
  v_add_f32 v35, v35, v43
  s_mov_b32 m0, s56
  s_add_u32 s47, s47, 1
  buffer_load_dwordx4 v149, s[88:91], s51 offen offset:0 sc1 lds
  v_readlane_b32 s5, v158, s47
  s_add_u32 s56, s56, 16384
  s_cmp_eq_u32 s56, s61
  s_cselect_b32 s56, s54, s56
  v_add_f32 v36, v36, v44
  v_add_f32 v37, v37, v45
  v_add_f32 v38, v38, v46
  v_add_f32 v39, v39, v47
  v_add_f32 v32, v32, v36
  v_add_f32 v33, v33, v37
  v_add_f32 v34, v34, v38
  v_add_f32 v35, v35, v39
  v_and_b32 v7, 1, v6
  v_cmp_eq_u32 vcc, 1, v7
  v_permlane32_swap_b32 v32, v34
  v_permlane32_swap_b32 v33, v35
  buffer_load_dwordx4 v150, s[16:19], s51 offen offset:1024 sc1 lds
  v_lshlrev_b32 v4, 9, v7
  v_add_f32 v32, v32, v34
  v_add_f32 v33, v33, v35
  v_mov_b32 v34, v32
  v_mov_b32 v35, v33
  v_lshrrev_b32 v7, 1, v6
  v_permlane16_swap_b32 v32, v34
  v_permlane16_swap_b32 v33, v35
  v_lshl_add_u32 v4, v7, 2, v4
  v_add_f32 v32, v32, v34
  v_add_f32 v33, v33, v35
  v_mul_f32 v32, 0xba800000, v32
  buffer_load_dwordx4 v151, s[88:91], s51 offen offset:2048 sc1 lds
  v_mul_f32 v33, 0x3a800000, v33
  v_fma_f32 v33, -v32, v32, v33
  v_max_f32 v33, 0, v33
  v_add_f32 v33, 0x3727c5ac, v33
  v_rsq_f32 v33, v33
  v_lshl_add_u32 v4, v5, 3, v4
  v_cndmask_b32 v32, v32, v33, vcc
  s_lshl_b32 s43, s27, 7
  s_add_u32 s43, s43, 155648
  v_add_u32 v4, s43, v4
  ds_write_b32 v4, v32
  buffer_load_dwordx4 v152, s[16:19], s51 offen offset:3072 sc1 lds
  s_mov_b32 s51, s5
Lt71:
  s_waitcnt lgkmcnt(0)
  s_barrier
  s_setprio 3
  v_readlane_b32 s51, v158, 0
  s_mul_i32 s54, s27, 4096
  s_add_u32 s54, s54, 65536
  s_add_i32 s61, s54, 81920
  s_add_i32 s56, s54, 0
  s_mov_b32 s47, 0
  s_mov_b32 m0, s56
  s_add_u32 s47, s47, 1
  buffer_load_dwordx4 v149, s[88:91], s51 offen offset:0 sc1 lds
  v_readlane_b32 s5, v158, s47
  s_add_u32 s56, s56, 16384
  s_cmp_eq_u32 s56, s61
  s_cselect_b32 s56, s54, s56
  buffer_load_dwordx4 v150, s[16:19], s51 offen offset:1024 sc1 lds
  buffer_load_dwordx4 v151, s[88:91], s51 offen offset:2048 sc1 lds
  buffer_load_dwordx4 v152, s[16:19], s51 offen offset:3072 sc1 lds
  s_mov_b32 s51, s5
  v_readlane_b32 s51, v158, 3
  s_mul_i32 s54, s27, 4096
  s_add_u32 s54, s54, 65536
  s_add_i32 s61, s54, 81920
  s_add_i32 s56, s54, 49152
  s_mov_b32 s47, 3
  v_readlane_b32 s44, v157, 3
  s_add_u32 s60, s53, 65536
  s_add_u32 s45, s53, 49152
  s_mov_b32 s46, 3
  s_nop 0
  s_waitcnt vmcnt(4)
  s_mov_b32 m0, s56
  s_add_u32 s47, s47, 1
  buffer_load_dwordx4 v149, s[88:91], s51 offen offset:0 sc1 lds
  v_readlane_b32 s5, v158, s47
  s_add_u32 s56, s56, 16384
  s_cmp_eq_u32 s56, s61
  s_cselect_b32 s56, s54, s56
  buffer_load_dwordx4 v150, s[16:19], s51 offen offset:1024 sc1 lds
  buffer_load_dwordx4 v151, s[88:91], s51 offen offset:2048 sc1 lds
  buffer_load_dwordx4 v152, s[16:19], s51 offen offset:3072 sc1 lds
  s_mov_b32 s51, s5
  s_waitcnt vmcnt(4)
  s_mov_b32 m0, s56
  s_add_u32 s47, s47, 1
  buffer_load_dwordx4 v149, s[88:91], s51 offen offset:0 sc1 lds
  v_readlane_b32 s5, v158, s47
  s_add_u32 s56, s56, 16384
  s_cmp_eq_u32 s56, s61
  s_cselect_b32 s56, s54, s56
  buffer_load_dwordx4 v150, s[16:19], s51 offen offset:1024 sc1 lds
  buffer_load_dwordx4 v151, s[88:91], s51 offen offset:2048 sc1 lds
  buffer_load_dwordx4 v152, s[16:19], s51 offen offset:3072 sc1 lds
  s_mov_b32 s51, s5
  s_waitcnt vmcnt(0)
  s_add_u32 s77, s77, 8
  v_mov_b32 v10, 1
  s_cmp_lg_u32 s27, 1
  s_barrier
  s_cbranch_scc1 Ls73
  s_mov_b64 exec, 1
  buffer_atomic_add v10, v17, s[28:31], s78 offen sc0 sc1
  s_mov_b64 exec, -1
Ls73:
  s_cmp_lg_u32 s22, 0
  s_cbranch_scc1 Lpf75
  s_sub_u32 s32, s6, 4096
  s_subb_u32 s33, s7, 0
  s_mov_b32 s34, 6295552
  s_mov_b32 s35, 0x20000
  v_lshrrev_b32 v3, 3, v1
  v_and_b32 v4, 7, v1
  v_and_b32 v5, 6, v3
  v_xor_b32 v4, v4, v5
  v_lshlrev_b32 v4, 4, v4
  s_lshl_b32 s43, s27, 4
  v_mul_u32_u24 v6, 6144, v3
  v_add_u32 v6, v6, v4
  s_mul_i32 s43, s43, 6144
  s_mov_b32 s63, s25
  s_mul_i32 s48, s25, 128
  s_add_u32 s43, s43, s48
  s_mov_b32 s50, s43
  v_add_u32 v6, s50, v6
  v_add_u32 v11, 4096, v6
  v_add_u32 v12, 5120, v6
  v_add_u32 v13, 6144, v6
  v_add_u32 v14, 50176, v6
  v_add_u32 v15, 55296, v6
  v_add_u32 v16, 56320, v6
  s_and_b32 s63, s25, 7
  s_and_b32 s50, s25, 8
  v_cmp_lt_u32 vcc, 0, v1
  v_mov_b32 v7, 1
  v_subrev_u32 v8, 0, v1
  v_cndmask_b32 v3, 0, v7, vcc
  v_sub_u32 v3, v1, v3
  v_cmp_lt_u32 vcc, 7, v1
  v_mov_b32 v9, 14
  s_and_b32 s62, s63, 7
  v_cndmask_b32 v6, 0, 7, vcc
  v_cndmask_b32 v9, 6, v9, vcc
  v_subrev_u32 v4, s57, v3
  v_and_b32 v4, 3, v4
  v_sub_u32 v5, v3, v4
  v_cmp_ge_i32 vcc, v5, v6
  v_add_u32 v5, 2, v5
  v_cmp_le_i32 s[48:49], v5, v9
  v_lshlrev_b32 v4, 2, v4
  s_and_b64 vcc, vcc, s[48:49]
  s_mov_b32 s48, 0x0ff2
  v_bfe_i32 v4, s48, v4, 4
  v_cndmask_b32 v4, 0, v4, vcc
  v_add_u32 v3, v3, v4
  v_med3_i32 v3, v3, v6, v9
  v_cmp_le_u32 vcc, s62, v3
  v_add_u32 v5, s63, v8
  v_cmp_gt_u32 s[48:49], 1, v8
  v_cndmask_b32 v4, 0, v7, vcc
  v_add_u32 v3, v3, v4
  v_cndmask_b32 v3, v3, v5, s[48:49]
  v_xor_b32 v3, s50, v3
  s_mov_b32 s48, 393216
  v_mul_lo_u32 v29, v3, s48
  s_and_b32 s48, s24, 7
  s_mul_i32 s48, s48, 524288
  v_lshl_add_u32 v28, v3, 15, s48
  s_mov_b32 s64, s20
  s_mov_b32 s65, s21
  s_mov_b32 s66, 0x10000000
  s_lshr_b32 s48, s26, 1
  s_lshl_b32 s48, s48, 1
  s_add_u32 s48, s48, s26
  s_lshl_b32 s48, s48, 12
  v_lshl_add_u32 v20, v1, 4, s48
  v_lshl_add_u32 v21, v1, 4, s48
  v_lshl_add_u32 v22, v1, 4, s48
  v_lshl_add_u32 v23, v1, 4, s48
  s_lshr_b32 s42, s24, 2
  s_lshl_b32 s43, s42, 1
  s_lshr_b32 s62, s3, s43
  s_lshr_b32 s63, s55, 13
  s_xor_b32 s63, s63, s42
  v_bfe_u32 v3, v28, 18, 1
  v_lshrrev_b32 v3, v3, s62
  v_and_b32 v3, 1, v3
  v_lshl_add_u32 v28, v3, 13, v28
  v_add_u32 v28, 46137344, v28
  v_add_u32 v3, 2, v1
  v_min_u32 v3, 14, v3
  v_cmp_le_u32 vcc, 3, v3
  s_and_b32 s42, s25, 8
  s_mov_b32 s43, 393216
  v_addc_co_u32 v3, vcc, 0, v3, vcc
  v_xor_b32 v3, s42, v3
  v_mul_lo_u32 v128, v3, s43
  s_bfe_u32 s39, s2, 0x50003
  s_lshl_b32 s39, s39, 1
  s_add_u32 s39, s39, s36
  s_mul_i32 s39, s39, 6144
  s_lshl_b32 s42, s42, 7
  s_add_u32 s39, s39, s42
  s_lshl_b32 s42, s37, 11
  s_add_u32 s39, s39, s42
  s_add_u32 s39, s39, 384
  s_add_u32 s8, s6, s39
  s_addc_u32 s9, s7, 0
Lpf75:
  s_barrier
  s_cmp_lg_u32 s27, 1
  s_cbranch_scc1 Ls74
  s_waitcnt vmcnt(0)
  v_readfirstlane_b32 s70, v10
  s_nop 0
  s_add_u32 s70, s70, 1
  s_cmp_ge_u32 s70, s77
  s_cbranch_scc1 Ls74
  s_mov_b64 exec, 1
  s_mov_b32 s70, 0
Lp76:
  buffer_load_dword v5, v17, s[28:31], s78 offen sc1
  s_add_u32 s70, s70, 1
  s_waitcnt vmcnt(0)
  v_cmp_gt_u32 vcc, s77, v5
  s_cmp_gt_u32 s70, 2097152
  s_cbranch_scc1 Lq77
  s_nop 2
  s_cbranch_vccnz Lp76
Lq77:
  s_mov_b64 exec, -1
Ls74:
  s_barrier
  s_mov_b32 m0, s45
  s_nop 0
  buffer_load_dwordx4 v30, s[64:67], s44 offen offset:0 sc1 lds
  s_add_u32 s46, s46, 1
  s_add_u32 s45, s45, 16384
  s_cmp_ge_u32 s45, s60
  s_cselect_b32 s45, s53, s45
  buffer_load_dwordx4 v30, s[64:67], s44 offen offset:1024 sc1 lds
  v_readlane_b32 s4, v157, s46
  buffer_load_dwordx4 v30, s[64:67], s44 offen offset:2048 sc1 lds
  buffer_load_dwordx4 v30, s[64:67], s44 offen offset:3072 sc1 lds
  s_mov_b32 s44, s4
  s_mov_b32 m0, s45
  s_nop 0
  buffer_load_dwordx4 v30, s[64:67], s44 offen offset:0 sc1 lds
  s_add_u32 s46, s46, 1
  s_add_u32 s45, s45, 16384
  s_cmp_ge_u32 s45, s60
  s_cselect_b32 s45, s53, s45
  buffer_load_dwordx4 v30, s[64:67], s44 offen offset:1024 sc1 lds
  v_readlane_b32 s4, v157, s46
  buffer_load_dwordx4 v30, s[64:67], s44 offen offset:2048 sc1 lds
  buffer_load_dwordx4 v30, s[64:67], s44 offen offset:3072 sc1 lds
  s_mov_b32 s44, s4
  s_mov_b32 m0, s56
  s_add_u32 s47, s47, 1
  s_add_u32 s77, s77, 8
  s_cmp_lg_u32 s27, 0
  s_barrier
  s_cbranch_scc1 Ls78
  s_mov_b64 exec, 1
  buffer_atomic_add v18, v17, s[28:31], s78 offen sc1
  s_mov_b64 exec, -1
Ls78:
  buffer_load_dwordx4 v149, s[88:91], s51 offen offset:0 sc1 lds
  v_readlane_b32 s5, v158, s47
  s_add_u32 s56, s56, 16384
  s_cmp_eq_u32 s56, s61
  s_cselect_b32 s56, s54, s56
  buffer_load_dwordx4 v150, s[16:19], s51 offen offset:1024 sc1 lds
  buffer_load_dwordx4 v151, s[88:91], s51 offen offset:2048 sc1 lds
  buffer_load_dwordx4 v152, s[16:19], s51 offen offset:3072 sc1 lds
  s_mov_b32 s51, s5
  s_mov_b32 m0, s45
  s_nop 0
  buffer_load_dwordx4 v30, s[64:67], s44 offen offset:0 sc1 lds
  s_add_u32 s46, s46, 1
  s_add_u32 s45, s45, 16384
  s_cmp_ge_u32 s45, s60
  s_cselect_b32 s45, s53, s45
  buffer_load_dwordx4 v30, s[64:67], s44 offen offset:1024 sc1 lds
  v_readlane_b32 s4, v157, s46
  buffer_load_dwordx4 v30, s[64:67], s44 offen offset:2048 sc1 lds
  buffer_load_dwordx4 v30, s[64:67], s44 offen offset:3072 sc1 lds
  s_mov_b32 s44, s4
  s_mov_b32 m0, s56
  s_add_u32 s47, s47, 1
  s_waitcnt vmcnt(12)
  s_barrier
  buffer_load_dwordx4 v149, s[88:91], s51 offen offset:0 sc1 lds
  v_readlane_b32 s5, v158, s47
  s_add_u32 s56, s56, 16384
  s_cmp_eq_u32 s56, s61
  s_cselect_b32 s56, s54, s56
  buffer_load_dwordx4 v150, s[16:19], s51 offen offset:1024 sc1 lds
  buffer_load_dwordx4 v151, s[88:91], s51 offen offset:2048 sc1 lds
  buffer_load_dwordx4 v152, s[16:19], s51 offen offset:3072 sc1 lds
  s_mov_b32 s51, s5
  s_mov_b32 m0, s45
  s_nop 0
  buffer_load_dwordx4 v30, s[64:67], s44 offen offset:0 sc1 lds
  s_add_u32 s46, s46, 1
  s_add_u32 s45, s45, 16384
  s_cmp_ge_u32 s45, s60
  s_cselect_b32 s45, s53, s45
  buffer_load_dwordx4 v30, s[64:67], s44 offen offset:1024 sc1 lds
  v_readlane_b32 s4, v157, s46
  buffer_load_dwordx4 v30, s[64:67], s44 offen offset:2048 sc1 lds
  buffer_load_dwordx4 v30, s[64:67], s44 offen offset:3072 sc1 lds
  s_mov_b32 s44, s4
  s_mov_b32 m0, s56
  s_add_u32 s47, s47, 1
  s_waitcnt vmcnt(16)
  s_barrier
  buffer_load_dwordx4 v149, s[88:91], s51 offen offset:0 sc1 lds
  v_readlane_b32 s5, v158, s47
  s_add_u32 s56, s56, 16384
  s_cmp_eq_u32 s56, s61
  s_cselect_b32 s56, s54, s56
  buffer_load_dwordx4 v150, s[16:19], s51 offen offset:1024 sc1 lds
  buffer_load_dwordx4 v151, s[88:91], s51 offen offset:2048 sc1 lds
  buffer_load_dwordx4 v152, s[16:19], s51 offen offset:3072 sc1 lds
  s_mov_b32 s51, s5
  s_mov_b32 m0, s45
  s_nop 0
  buffer_load_dwordx4 v30, s[64:67], s44 offen offset:0 sc1 lds
  s_add_u32 s46, s46, 1
  s_add_u32 s45, s45, 16384
  s_cmp_ge_u32 s45, s60
  s_cselect_b32 s45, s53, s45
  buffer_load_dwordx4 v30, s[64:67], s44 offen offset:1024 sc1 lds
  v_readlane_b32 s4, v157, s46
  buffer_load_dwordx4 v30, s[64:67], s44 offen offset:2048 sc1 lds
  s_waitcnt vmcnt(15)
  s_cmp_lg_u32 s27, 1
  s_barrier
  s_cbranch_scc1 Ls79
  buffer_load_dword v4, v17, s[28:31], s78 offen sc1
Ls79:
  buffer_load_dwordx4 v30, s[64:67], s44 offen offset:3072 sc1 lds
  s_mov_b32 s44, s4
  s_mov_b32 m0, s56
  s_add_u32 s47, s47, 1
  buffer_load_dwordx4 v149, s[88:91], s51 offen offset:0 sc1 lds
  v_readlane_b32 s5, v158, s47
  s_add_u32 s56, s56, 16384
  s_cmp_eq_u32 s56, s61
  s_cselect_b32 s56, s54, s56
  buffer_load_dwordx4 v150, s[16:19], s51 offen offset:1024 sc1 lds
  buffer_load_dwordx4 v151, s[88:91], s51 offen offset:2048 sc1 lds
  buffer_load_dwordx4 v152, s[16:19], s51 offen offset:3072 sc1 lds
  s_mov_b32 s51, s5
  s_mov_b32 m0, s45
  s_nop 0
  buffer_load_dwordx4 v30, s[64:67], s44 offen offset:0 sc1 lds
  s_add_u32 s46, s46, 1
  s_add_u32 s45, s45, 16384
  s_cmp_ge_u32 s45, s60
  s_cselect_b32 s45, s53, s45
  buffer_load_dwordx4 v30, s[64:67], s44 offen offset:1024 sc1 lds
  v_readlane_b32 s4, v157, s46
  buffer_load_dwordx4 v30, s[64:67], s44 offen offset:2048 sc1 lds
  s_waitcnt vmcnt(15)
  s_cmp_lg_u32 s27, 1
  s_cbranch_scc1 Ls80
  s_waitcnt vmcnt(8)
  v_cmp_gt_u32 vcc, s77, v4
  s_nop 4
  s_cbranch_vccz Ls80
  s_mov_b64 exec, 1
  s_mov_b32 s70, 0
Lp81:
  buffer_load_dword v4, v17, s[28:31], s78 offen sc1
  s_add_u32 s70, s70, 1
  s_waitcnt vmcnt(0)
  v_cmp_gt_u32 vcc, s77, v4
  s_cmp_gt_u32 s70, 2097152
  s_cbranch_scc1 Lq82
  s_nop 2
  s_cbranch_vccnz Lp81
Lq82:
  s_mov_b64 exec, -1
Ls80:
  s_barrier
  buffer_load_dwordx4 v30, s[64:67], s44 offen offset:3072 sc1 lds
  s_mov_b32 s44, s4
  s_mov_b32 m0, s56
  s_add_u32 s47, s47, 1
  buffer_load_dwordx4 v149, s[88:91], s51 offen offset:0 sc1 lds
  v_readlane_b32 s5, v158, s47
  s_add_u32 s56, s56, 16384
  s_cmp_eq_u32 s56, s61
  s_cselect_b32 s56, s54, s56
  buffer_load_dwordx4 v150, s[16:19], s51 offen offset:1024 sc1 lds
  buffer_load_dwordx4 v151, s[88:91], s51 offen offset:2048 sc1 lds
  buffer_load_dwordx4 v152, s[16:19], s51 offen offset:3072 sc1 lds
  s_mov_b32 s51, s5
  s_mov_b32 m0, s45
  s_nop 0
  buffer_load_dwordx4 v30, s[64:67], s44 offen offset:0 sc1 lds
  s_add_u32 s46, s46, 1
  s_add_u32 s45, s45, 16384
  s_cmp_ge_u32 s45, s60
  s_cselect_b32 s45, s53, s45
  buffer_load_dwordx4 v30, s[64:67], s44 offen offset:1024 sc1 lds
  v_readlane_b32 s4, v157, s46
  buffer_load_dwordx4 v30, s[64:67], s44 offen offset:2048 sc1 lds
  s_waitcnt vmcnt(15)
  s_barrier
  buffer_load_dwordx4 v30, s[64:67], s44 offen offset:3072 sc1 lds
  s_mov_b32 s44, s4
  s_mov_b32 m0, s56
  s_add_u32 s47, s47, 1
  buffer_load_dwordx4 v149, s[88:91], s51 offen offset:0 sc1 lds
  v_readlane_b32 s5, v158, s47
  s_add_u32 s56, s56, 16384
  s_cmp_eq_u32 s56, s61
  s_cselect_b32 s56, s54, s56
  buffer_load_dwordx4 v150, s[16:19], s51 offen offset:1024 sc1 lds
  buffer_load_dwordx4 v151, s[88:91], s51 offen offset:2048 sc1 lds
  buffer_load_dwordx4 v152, s[16:19], s51 offen offset:3072 sc1 lds
  s_mov_b32 s51, s5
  s_mov_b32 m0, s45
  s_nop 0
  buffer_load_dwordx4 v30, s[64:67], s44 offen offset:0 sc1 lds
  s_add_u32 s46, s46, 1
  s_add_u32 s45, s45, 16384
  s_cmp_ge_u32 s45, s60
  s_cselect_b32 s45, s53, s45
  buffer_load_dwordx4 v30, s[64:67], s44 offen offset:1024 sc1 lds
  v_readlane_b32 s4, v157, s46
  s_waitcnt vmcnt(14)
  s_barrier
  buffer_load_dwordx4 v30, s[64:67], s44 offen offset:2048 sc1 lds
  buffer_load_dwordx4 v30, s[64:67], s44 offen offset:3072 sc1 lds
  s_mov_b32 s44, s4
  s_mov_b32 m0, s56
  s_add_u32 s47, s47, 1
  buffer_load_dwordx4 v149, s[88:91], s51 offen offset:0 sc1 lds
  v_readlane_b32 s5, v158, s47
  s_add_u32 s56, s56, 16384
  s_cmp_eq_u32 s56, s61
  s_cselect_b32 s56, s54, s56
  buffer_load_dwordx4 v150, s[16:19], s51 offen offset:1024 sc1 lds
  buffer_load_dwordx4 v151, s[88:91], s51 offen offset:2048 sc1 lds
  buffer_load_dwordx4 v152, s[16:19], s51 offen offset:3072 sc1 lds
  s_mov_b32 s51, s5
  s_mov_b32 m0, s45
  s_nop 0
  buffer_load_dwordx4 v30, s[64:67], s44 offen offset:0 sc1 lds
  s_add_u32 s46, s46, 1
  s_add_u32 s45, s45, 16384
  s_cmp_ge_u32 s45, s60
  s_cselect_b32 s45, s53, s45
  buffer_load_dwordx4 v30, s[64:67], s44 offen offset:1024 sc1 lds
  v_readlane_b32 s4, v157, s46
  s_waitcnt vmcnt(14)
  s_barrier
  buffer_load_dwordx4 v30, s[64:67], s44 offen offset:2048 sc1 lds
  buffer_load_dwordx4 v30, s[64:67], s44 offen offset:3072 sc1 lds
  s_mov_b32 s44, s4
  s_mov_b32 m0, s56
  s_add_u32 s47, s47, 1
  buffer_load_dwordx4 v149, s[88:91], s51 offen offset:0 sc1 lds
  v_readlane_b32 s5, v158, s47
  s_add_u32 s56, s56, 16384
  s_cmp_eq_u32 s56, s61
  s_cselect_b32 s56, s54, s56
  buffer_load_dwordx4 v150, s[16:19], s51 offen offset:1024 sc1 lds
  buffer_load_dwordx4 v151, s[88:91], s51 offen offset:2048 sc1 lds
  buffer_load_dwordx4 v152, s[16:19], s51 offen offset:3072 sc1 lds
  s_mov_b32 s51, s5
  s_mov_b32 m0, s45
  s_nop 0
  buffer_load_dwordx4 v30, s[64:67], s44 offen offset:0 sc1 lds
  s_add_u32 s46, s46, 1
  s_add_u32 s45, s45, 16384
  s_cmp_ge_u32 s45, s60
  s_cselect_b32 s45, s53, s45
  buffer_load_dwordx4 v30, s[64:67], s44 offen offset:1024 sc1 lds
  v_readlane_b32 s4, v157, s46
  s_waitcnt vmcnt(14)
  s_barrier
  buffer_load_dwordx4 v30, s[64:67], s44 offen offset:2048 sc1 lds
  buffer_load_dwordx4 v30, s[64:67], s44 offen offset:3072 sc1 lds
  s_mov_b32 s44, s4
  s_mov_b32 m0, s56
  s_add_u32 s47, s47, 1
  buffer_load_dwordx4 v149, s[88:91], s51 offen offset:0 sc1 lds
  v_readlane_b32 s5, v158, s47
  s_add_u32 s56, s56, 16384
  s_cmp_eq_u32 s56, s61
  s_cselect_b32 s56, s54, s56
  buffer_load_dwordx4 v150, s[16:19], s51 offen offset:1024 sc1 lds
  buffer_load_dwordx4 v151, s[88:91], s51 offen offset:2048 sc1 lds
  buffer_load_dwordx4 v152, s[16:19], s51 offen offset:3072 sc1 lds
  s_mov_b32 s51, s5
  s_mov_b32 m0, s45
  s_nop 0
  buffer_load_dwordx4 v30, s[64:67], s44 offen offset:0 sc1 lds
  s_add_u32 s46, s46, 1
  s_add_u32 s45, s45, 16384
  s_cmp_ge_u32 s45, s60
  s_cselect_b32 s45, s53, s45
  s_waitcnt vmcnt(13)
  s_barrier
  buffer_load_dwordx4 v30, s[64:67], s44 offen offset:1024 sc1 lds
  v_readlane_b32 s4, v157, s46
  buffer_load_dwordx4 v30, s[64:67], s44 offen offset:2048 sc1 lds
  buffer_load_dwordx4 v30, s[64:67], s44 offen offset:3072 sc1 lds
  s_mov_b32 s44, s4
  s_mov_b32 m0, s56
  s_add_u32 s47, s47, 1
  buffer_load_dwordx4 v149, s[88:91], s51 offen offset:0 sc1 lds
  v_readlane_b32 s5, v158, s47
  s_add_u32 s56, s56, 16384
  s_cmp_eq_u32 s56, s61
  s_cselect_b32 s56, s54, s56
  buffer_load_dwordx4 v150, s[16:19], s51 offen offset:1024 sc1 lds
  buffer_load_dwordx4 v151, s[88:91], s51 offen offset:2048 sc1 lds
  buffer_load_dwordx4 v152, s[16:19], s51 offen offset:3072 sc1 lds
  s_mov_b32 s51, s5
  s_mov_b32 m0, s45
  s_nop 0
  buffer_load_dwordx4 v30, s[64:67], s44 offen offset:0 sc1 lds
  s_add_u32 s46, s46, 1
  s_add_u32 s45, s45, 16384
  s_cmp_ge_u32 s45, s60
  s_cselect_b32 s45, s53, s45
  s_waitcnt vmcnt(13)
  s_barrier
  buffer_load_dwordx4 v30, s[64:67], s44 offen offset:1024 sc1 lds
  v_readlane_b32 s4, v157, s46
  buffer_load_dwordx4 v30, s[64:67], s44 offen offset:2048 sc1 lds
  buffer_load_dwordx4 v30, s[64:67], s44 offen offset:3072 sc1 lds
  s_mov_b32 s44, s4
  s_mov_b32 m0, s56
  s_add_u32 s47, s47, 1
  buffer_load_dwordx4 v149, s[88:91], s51 offen offset:0 sc1 lds
  v_readlane_b32 s5, v158, s47
  s_add_u32 s56, s56, 16384
  s_cmp_eq_u32 s56, s61
  s_cselect_b32 s56, s54, s56
  buffer_load_dwordx4 v150, s[16:19], s51 offen offset:1024 sc1 lds
  buffer_load_dwordx4 v151, s[88:91], s51 offen offset:2048 sc1 lds
  buffer_load_dwordx4 v152, s[16:19], s51 offen offset:3072 sc1 lds
  s_mov_b32 s51, s5
  s_mov_b32 m0, s45
  s_nop 0
  buffer_load_dwordx4 v30, s[64:67], s44 offen offset:0 sc1 lds
  s_add_u32 s46, s46, 1
  s_add_u32 s45, s45, 16384
  s_cmp_ge_u32 s45, s60
  s_cselect_b32 s45, s53, s45
  s_waitcnt vmcnt(13)
  s_barrier
  buffer_load_dwordx4 v30, s[64:67], s44 offen offset:1024 sc1 lds
  v_readlane_b32 s4, v157, s46
  buffer_load_dwordx4 v30, s[64:67], s44 offen offset:2048 sc1 lds
  buffer_load_dwordx4 v30, s[64:67], s44 offen offset:3072 sc1 lds
  s_mov_b32 s44, s4
  s_mov_b32 m0, s56
  s_add_u32 s47, s47, 1
  buffer_load_dwordx4 v149, s[88:91], s51 offen offset:0 sc1 lds
  v_readlane_b32 s5, v158, s47
  s_add_u32 s56, s56, 16384
  s_cmp_eq_u32 s56, s61
  s_cselect_b32 s56, s54, s56
  buffer_load_dwordx4 v150, s[16:19], s51 offen offset:1024 sc1 lds
  buffer_load_dwordx4 v151, s[88:91], s51 offen offset:2048 sc1 lds
  buffer_load_dwordx4 v152, s[16:19], s51 offen offset:3072 sc1 lds
  s_mov_b32 s51, s5
  s_mov_b32 m0, s45
  s_nop 0
  s_waitcnt vmcnt(12)
  s_barrier
  buffer_load_dwordx4 v30, s[64:67], s44 offen offset:0 sc1 lds
  s_add_u32 s46, s46, 1
  s_add_u32 s45, s45, 16384
  s_cmp_ge_u32 s45, s60
  s_cselect_b32 s45, s53, s45
  buffer_load_dwordx4 v30, s[64:67], s44 offen offset:1024 sc1 lds
  v_readlane_b32 s4, v157, s46
  buffer_load_dwordx4 v30, s[64:67], s44 offen offset:2048 sc1 lds
  buffer_load_dwordx4 v30, s[64:67], s44 offen offset:3072 sc1 lds
  s_mov_b32 s44, s4
  s_mov_b32 m0, s56
  s_add_u32 s47, s47, 1
  buffer_load_dwordx4 v149, s[88:91], s51 offen offset:0 sc1 lds
  v_readlane_b32 s5, v158, s47
  s_add_u32 s56, s56, 16384
  s_cmp_eq_u32 s56, s61
  s_cselect_b32 s56, s54, s56
  buffer_load_dwordx4 v150, s[16:19], s51 offen offset:1024 sc1 lds
  buffer_load_dwordx4 v151, s[88:91], s51 offen offset:2048 sc1 lds
  buffer_load_dwordx4 v152, s[16:19], s51 offen offset:3072 sc1 lds
  s_mov_b32 s51, s5
  s_mov_b32 m0, s45
  s_nop 0
  s_waitcnt vmcnt(12)
  s_barrier
  buffer_load_dwordx4 v30, s[64:67], s44 offen offset:0 sc1 lds
  s_add_u32 s46, s46, 1
  s_add_u32 s45, s45, 16384
  s_cmp_ge_u32 s45, s60
  s_cselect_b32 s45, s53, s45
  buffer_load_dwordx4 v30, s[64:67], s44 offen offset:1024 sc1 lds
  v_readlane_b32 s4, v157, s46
  buffer_load_dwordx4 v30, s[64:67], s44 offen offset:2048 sc1 lds
  buffer_load_dwordx4 v30, s[64:67], s44 offen offset:3072 sc1 lds
  s_mov_b32 s44, s4
  s_mov_b32 m0, s56
  s_add_u32 s47, s47, 1
  buffer_load_dwordx4 v149, s[88:91], s51 offen offset:0 sc1 lds
  v_readlane_b32 s5, v158, s47
  s_add_u32 s56, s56, 16384
  s_cmp_eq_u32 s56, s61
  s_cselect_b32 s56, s54, s56
  buffer_load_dwordx4 v150, s[16:19], s51 offen offset:1024 sc1 lds
  buffer_load_dwordx4 v151, s[88:91], s51 offen offset:2048 sc1 lds
  buffer_load_dwordx4 v152, s[16:19], s51 offen offset:3072 sc1 lds
  s_mov_b32 s51, s5
  s_mov_b32 m0, s45
  s_nop 0
  s_waitcnt vmcnt(12)
  s_barrier
  buffer_load_dwordx4 v30, s[64:67], s44 offen offset:0 sc1 lds
  s_add_u32 s46, s46, 1
  s_add_u32 s45, s45, 16384
  s_cmp_ge_u32 s45, s60
  s_cselect_b32 s45, s53, s45
  buffer_load_dwordx4 v30, s[64:67], s44 offen offset:1024 sc1 lds
  v_readlane_b32 s4, v157, s46
  buffer_load_dwordx4 v30, s[64:67], s44 offen offset:2048 sc1 lds
  buffer_load_dwordx4 v30, s[64:67], s44 offen offset:3072 sc1 lds
  s_mov_b32 s44, s4
  s_mov_b32 m0, s56
  s_add_u32 s47, s47, 1
  buffer_load_dwordx4 v149, s[88:91], s51 offen offset:0 sc1 lds
  v_readlane_b32 s5, v158, s47
  s_add_u32 s56, s56, 16384
  s_cmp_eq_u32 s56, s61
  s_cselect_b32 s56, s54, s56
  buffer_load_dwordx4 v150, s[16:19], s51 offen offset:1024 sc1 lds
  buffer_load_dwordx4 v151, s[88:91], s51 offen offset:2048 sc1 lds
  s_waitcnt vmcnt(11)
  s_barrier
  buffer_load_dwordx4 v152, s[16:19], s51 offen offset:3072 sc1 lds
  s_mov_b32 s51, s5
  s_mov_b32 m0, s45
  s_nop 0
  buffer_load_dwordx4 v30, s[64:67], s44 offen offset:0 sc1 lds
  s_add_u32 s46, s46, 1
  s_add_u32 s45, s45, 16384
  s_cmp_ge_u32 s45, s60
  s_cselect_b32 s45, s53, s45
  buffer_load_dwordx4 v30, s[64:67], s44 offen offset:1024 sc1 lds
  v_readlane_b32 s4, v157, s46
  buffer_load_dwordx4 v30, s[64:67], s44 offen offset:2048 sc1 lds
  buffer_load_dwordx4 v30, s[64:67], s44 offen offset:3072 sc1 lds
  s_mov_b32 s44, s4
  s_mov_b32 m0, s56
  s_add_u32 s47, s47, 1
  buffer_load_dwordx4 v149, s[88:91], s51 offen offset:0 sc1 lds
  v_readlane_b32 s5, v158, s47
  s_add_u32 s56, s56, 16384
  s_cmp_eq_u32 s56, s61
  s_cselect_b32 s56, s54, s56
  buffer_load_dwordx4 v150, s[16:19], s51 offen offset:1024 sc1 lds
  buffer_load_dwordx4 v151, s[88:91], s51 offen offset:2048 sc1 lds
  s_waitcnt vmcnt(11)
  s_barrier
  buffer_load_dwordx4 v152, s[16:19], s51 offen offset:3072 sc1 lds
  s_mov_b32 s51, s5
  s_mov_b32 m0, s45
  s_nop 0
  buffer_load_dwordx4 v30, s[64:67], s44 offen offset:0 sc1 lds
  s_add_u32 s46, s46, 1
  s_add_u32 s45, s45, 16384
  s_cmp_ge_u32 s45, s60
  s_cselect_b32 s45, s53, s45
  buffer_load_dwordx4 v30, s[64:67], s44 offen offset:1024 sc1 lds
  v_readlane_b32 s4, v157, s46
  buffer_load_dwordx4 v30, s[64:67], s44 offen offset:2048 sc1 lds
  buffer_load_dwordx4 v30, s[64:67], s44 offen offset:3072 sc1 lds
  s_mov_b32 s44, s4
  s_mov_b32 m0, s56
  s_add_u32 s47, s47, 1
  buffer_load_dwordx4 v149, s[88:91], s51 offen offset:0 sc1 lds
  v_readlane_b32 s5, v158, s47
  s_add_u32 s56, s56, 16384
  s_cmp_eq_u32 s56, s61
  s_cselect_b32 s56, s54, s56
  buffer_load_dwordx4 v150, s[16:19], s51 offen offset:1024 sc1 lds
  buffer_load_dwordx4 v151, s[88:91], s51 offen offset:2048 sc1 lds
  s_waitcnt vmcnt(11)
  s_barrier
  buffer_load_dwordx4 v152, s[16:19], s51 offen offset:3072 sc1 lds
  s_mov_b32 s51, s5
  s_mov_b32 m0, s45
  s_nop 0
  buffer_load_dwordx4 v30, s[64:67], s44 offen offset:0 sc1 lds
  s_add_u32 s46, s46, 1
  s_add_u32 s45, s45, 16384
  s_cmp_ge_u32 s45, s60
  s_cselect_b32 s45, s53, s45
  buffer_load_dwordx4 v30, s[64:67], s44 offen offset:1024 sc1 lds
  v_readlane_b32 s4, v157, s46
  buffer_load_dwordx4 v30, s[64:67], s44 offen offset:2048 sc1 lds
  buffer_load_dwordx4 v30, s[64:67], s44 offen offset:3072 sc1 lds
  s_mov_b32 s44, s4
  s_mov_b32 m0, s56
  s_add_u32 s47, s47, 1
  buffer_load_dwordx4 v149, s[88:91], s51 offen offset:0 sc1 lds
  v_readlane_b32 s5, v158, s47
  s_add_u32 s56, s56, 16384
  s_cmp_eq_u32 s56, s61
  s_cselect_b32 s56, s54, s56
  buffer_load_dwordx4 v150, s[16:19], s51 offen offset:1024 sc1 lds
  s_waitcnt vmcnt(10)
  s_barrier
  buffer_load_dwordx4 v151, s[88:91], s51 offen offset:2048 sc1 lds
  buffer_load_dwordx4 v152, s[16:19], s51 offen offset:3072 sc1 lds
  s_mov_b32 s51, s5
  s_mov_b32 m0, s45
  s_nop 0
  buffer_load_dwordx4 v30, s[64:67], s44 offen offset:0 sc1 lds
  s_add_u32 s46, s46, 1
  s_add_u32 s45, s45, 16384
  s_cmp_ge_u32 s45, s60
  s_cselect_b32 s45, s53, s45
  buffer_load_dwordx4 v30, s[64:67], s44 offen offset:1024 sc1 lds
  v_readlane_b32 s4, v157, s46
  buffer_load_dwordx4 v30, s[64:67], s44 offen offset:2048 sc1 lds
  buffer_load_dwordx4 v30, s[64:67], s44 offen offset:3072 sc1 lds
  s_mov_b32 s44, s4
  s_mov_b32 m0, s56
  s_add_u32 s47, s47, 1
  buffer_load_dwordx4 v149, s[88:91], s51 offen offset:0 sc1 lds
  v_readlane_b32 s5, v158, s47
  s_add_u32 s56, s56, 16384
  s_cmp_eq_u32 s56, s61
  s_cselect_b32 s56, s54, s56
  buffer_load_dwordx4 v150, s[16:19], s51 offen offset:1024 sc1 lds
  s_waitcnt vmcnt(10)
  s_barrier
  buffer_load_dwordx4 v151, s[88:91], s51 offen offset:2048 sc1 lds
  buffer_load_dwordx4 v152, s[16:19], s51 offen offset:3072 sc1 lds
  s_mov_b32 s51, s5
  s_mov_b32 m0, s45
  s_nop 0
  buffer_load_dwordx4 v30, s[64:67], s44 offen offset:0 sc1 lds
  s_add_u32 s46, s46, 1
  s_add_u32 s45, s45, 16384
  s_cmp_ge_u32 s45, s60
  s_cselect_b32 s45, s53, s45
  buffer_load_dwordx4 v30, s[64:67], s44 offen offset:1024 sc1 lds
  v_readlane_b32 s4, v157, s46
  buffer_load_dwordx4 v30, s[64:67], s44 offen offset:2048 sc1 lds
  buffer_load_dwordx4 v30, s[64:67], s44 offen offset:3072 sc1 lds
  s_mov_b32 s44, s4
  s_mov_b32 m0, s56
  s_add_u32 s47, s47, 1
  buffer_load_dwordx4 v149, s[88:91], s51 offen offset:0 sc1 lds
  v_readlane_b32 s5, v158, s47
  s_add_u32 s56, s56, 16384
  s_cmp_eq_u32 s56, s61
  s_cselect_b32 s56, s54, s56
  buffer_load_dwordx4 v150, s[16:19], s51 offen offset:1024 sc1 lds
  s_waitcnt vmcnt(10)
  s_barrier
  buffer_load_dwordx4 v151, s[88:91], s51 offen offset:2048 sc1 lds
  buffer_load_dwordx4 v152, s[16:19], s51 offen offset:3072 sc1 lds
  s_mov_b32 s51, s5
  s_mov_b32 m0, s45
  s_nop 0
  buffer_load_dwordx4 v30, s[64:67], s44 offen offset:0 sc1 lds
  s_add_u32 s46, s46, 1
  s_add_u32 s45, s45, 16384
  s_cmp_ge_u32 s45, s60
  s_cselect_b32 s45, s53, s45
  buffer_load_dwordx4 v30, s[64:67], s44 offen offset:1024 sc1 lds
  v_readlane_b32 s4, v157, s46
  buffer_load_dwordx4 v30, s[64:67], s44 offen offset:2048 sc1 lds
  buffer_load_dwordx4 v30, s[64:67], s44 offen offset:3072 sc1 lds
  s_mov_b32 s44, s4
  s_mov_b32 m0, s56
  s_add_u32 s47, s47, 1
  buffer_load_dwordx4 v149, s[88:91], s51 offen offset:0 sc1 lds
  v_readlane_b32 s5, v158, s47
  s_add_u32 s56, s56, 16384
  s_cmp_eq_u32 s56, s61
  s_cselect_b32 s56, s54, s56
  s_waitcnt vmcnt(9)
  s_barrier
  buffer_load_dwordx4 v150, s[16:19], s51 offen offset:1024 sc1 lds
  buffer_load_dwordx4 v151, s[88:91], s51 offen offset:2048 sc1 lds
  buffer_load_dwordx4 v152, s[16:19], s51 offen offset:3072 sc1 lds
  s_mov_b32 s51, s5
  s_mov_b32 m0, s45
  s_nop 0
  buffer_load_dwordx4 v30, s[64:67], s44 offen offset:0 sc1 lds
  s_add_u32 s46, s46, 1
  s_add_u32 s45, s45, 16384
  s_cmp_ge_u32 s45, s60
  s_cselect_b32 s45, s53, s45
  buffer_load_dwordx4 v30, s[64:67], s44 offen offset:1024 sc1 lds
  v_readlane_b32 s4, v157, s46
  buffer_load_dwordx4 v30, s[64:67], s44 offen offset:2048 sc1 lds
  buffer_load_dwordx4 v30, s[64:67], s44 offen offset:3072 sc1 lds
  s_mov_b32 s44, s4
  s_mov_b32 m0, s56
  s_add_u32 s47, s47, 1
  buffer_load_dwordx4 v149, s[88:91], s51 offen offset:0 sc1 lds
  v_readlane_b32 s5, v158, s47
  s_add_u32 s56, s56, 16384
  s_cmp_eq_u32 s56, s61
  s_cselect_b32 s56, s54, s56
  s_waitcnt vmcnt(9)
  s_barrier
  buffer_load_dwordx4 v150, s[16:19], s51 offen offset:1024 sc1 lds
  buffer_load_dwordx4 v151, s[88:91], s51 offen offset:2048 sc1 lds
  buffer_load_dwordx4 v152, s[16:19], s51 offen offset:3072 sc1 lds
  s_mov_b32 s51, s5
  s_mov_b32 m0, s45
  s_nop 0
  buffer_load_dwordx4 v30, s[64:67], s44 offen offset:0 sc1 lds
  s_add_u32 s46, s46, 1
  s_add_u32 s45, s45, 16384
  s_cmp_ge_u32 s45, s60
  s_cselect_b32 s45, s53, s45
  buffer_load_dwordx4 v30, s[64:67], s44 offen offset:1024 sc1 lds
  v_readlane_b32 s4, v157, s46
  buffer_load_dwordx4 v30, s[64:67], s44 offen offset:2048 sc1 lds
  buffer_load_dwordx4 v30, s[64:67], s44 offen offset:3072 sc1 lds
  s_mov_b32 s44, s4
  s_mov_b32 m0, s56
  s_add_u32 s47, s47, 1
  buffer_load_dwordx4 v149, s[88:91], s51 offen offset:0 sc1 lds
  v_readlane_b32 s5, v158, s47
  s_add_u32 s56, s56, 16384
  s_cmp_eq_u32 s56, s61
  s_cselect_b32 s56, s54, s56
  s_waitcnt vmcnt(9)
  s_barrier
  buffer_load_dwordx4 v150, s[16:19], s51 offen offset:1024 sc1 lds
  buffer_load_dwordx4 v151, s[88:91], s51 offen offset:2048 sc1 lds
  buffer_load_dwordx4 v152, s[16:19], s51 offen offset:3072 sc1 lds
  s_mov_b32 s51, s5
  s_mov_b32 m0, s45
  s_nop 0
  buffer_load_dwordx4 v30, s[64:67], s44 offen offset:0 sc1 lds
  s_add_u32 s46, s46, 1
  s_add_u32 s45, s45, 16384
  s_cmp_ge_u32 s45, s60
  s_cselect_b32 s45, s53, s45
  buffer_load_dwordx4 v30, s[64:67], s44 offen offset:1024 sc1 lds
  v_readlane_b32 s4, v157, s46
  buffer_load_dwordx4 v30, s[64:67], s44 offen offset:2048 sc1 lds
  buffer_load_dwordx4 v30, s[64:67], s44 offen offset:3072 sc1 lds
  s_mov_b32 s44, s4
  v_readlane_b32 s51, v29, 0
  s_mul_i32 s54, s27, 6144
  s_add_u32 s54, s54, 131072
  s_add_i32 s61, s54, -73728
  s_add_i32 s56, s54, 0
  s_mov_b32 s47, 0
  s_waitcnt vmcnt(8)
  s_barrier
  s_cmp_eq_u32 s22, 0
  s_cbranch_scc1 Le83
  s_waitcnt vmcnt(0)
  s_barrier
  s_endpgm
Le83:
  s_mov_b32 m0, s56
  s_add_u32 s47, s47, 1
  buffer_load_dwordx4 v11, s[32:35], s51 offen offset:0  lds
  v_readlane_b32 s5, v29, s47
  s_sub_u32 s56, s56, 24576
  s_cmp_eq_u32 s56, s61
  s_cselect_b32 s56, s54, s56
  buffer_load_dwordx4 v12, s[32:35], s51 offen offset:1024  lds
  buffer_load_dwordx4 v13, s[32:35], s51 offen offset:2048  lds
  buffer_load_dwordx4 v14, s[32:35], s51 offen offset:3072  lds
  s_add_u32 m0, m0, 4096
  s_nop 0
  buffer_load_dwordx4 v15, s[32:35], s51 offen offset:0  lds
  buffer_load_dwordx4 v16, s[32:35], s51 offen offset:1024  lds
  s_mov_b32 s51, s5
  s_waitcnt vmcnt(6)
  s_barrier
  s_barrier
  s_cmp_lg_u32 s22, 0
  s_cbranch_scc1 L_end
  s_mov_b32 s22, 1
  s_mov_b32 s23, 46137344
  s_mov_b32 s58, 64
  s_mov_b32 s38, 64
  s_mov_b32 s59, 64
  v_add_u32 v153, s23, v153
  v_add_u32 v155, s23, v155
  v_add_u32 v157, s23, v157
  s_mov_b32 m0, s56
  s_add_u32 s47, s47, 1
  buffer_load_dwordx4 v11, s[32:35], s51 offen offset:0  lds
  v_readlane_b32 s5, v29, s47
  s_sub_u32 s56, s56, 24576
  s_cmp_eq_u32 s56, s61
  s_cselect_b32 s56, s54, s56
  buffer_load_dwordx4 v12, s[32:35], s51 offen offset:1024  lds
  buffer_load_dwordx4 v13, s[32:35], s51 offen offset:2048  lds
  buffer_load_dwordx4 v14, s[32:35], s51 offen offset:3072  lds
  s_add_u32 m0, m0, 4096
  s_nop 0
  buffer_load_dwordx4 v15, s[32:35], s51 offen offset:0  lds
  buffer_load_dwordx4 v16, s[32:35], s51 offen offset:1024  lds
  s_mov_b32 s51, s5
  s_barrier
  s_mov_b32 m0, s56
  s_add_u32 s47, s47, 1
  buffer_load_dwordx4 v11, s[32:35], s51 offen offset:0  lds
  v_readlane_b32 s5, v29, s47
  s_sub_u32 s56, s56, 24576
  s_cmp_eq_u32 s56, s61
  s_cselect_b32 s56, s54, s56
  buffer_load_dwordx4 v12, s[32:35], s51 offen offset:1024  lds
  buffer_load_dwordx4 v13, s[32:35], s51 offen offset:2048  lds
  buffer_load_dwordx4 v14, s[32:35], s51 offen offset:3072  lds
  s_add_u32 m0, m0, 4096
  s_nop 0
  buffer_load_dwordx4 v15, s[32:35], s51 offen offset:0  lds
  buffer_load_dwordx4 v16, s[32:35], s51 offen offset:1024  lds
  s_mov_b32 s51, s5
  v_readlane_b32 s51, v29, 3
  s_mul_i32 s54, s27, 6144
  s_add_u32 s54, s54, 131072
  s_add_i32 s61, s54, -73728
  s_add_i32 s56, s54, 0
  s_mov_b32 s47, 3
  v_readlane_b32 s44, v28, 1
  s_add_u32 s60, s53, 49152
  s_add_u32 s45, s53, 16384
  s_mov_b32 s46, 1
  s_nop 0
  v_readlane_b32 s70, v128, 0
  s_nop 3
  s_load_dwordx2 s[10:11], s[8:9], s70 offset:60
  s_load_dwordx2 s[10:11], s[8:9], s70 offset:2108
  v_readlane_b32 s70, v128, 1
  s_nop 3
  s_load_dwordx2 s[10:11], s[8:9], s70 offset:60
  s_load_dwordx2 s[10:11], s[8:9], s70 offset:2108
  v_readlane_b32 s70, v128, 2
  s_nop 3
  s_load_dwordx2 s[10:11], s[8:9], s70 offset:60
  s_load_dwordx2 s[10:11], s[8:9], s70 offset:2108
  v_readlane_b32 s70, v128, 3
  s_nop 3
  s_load_dwordx2 s[10:11], s[8:9], s70 offset:60
  s_load_dwordx2 s[10:11], s[8:9], s70 offset:2108
  s_waitcnt vmcnt(12)
  s_add_u32 s77, s77, 8
  v_mov_b32 v10, 1
  s_cmp_lg_u32 s27, 1
  s_barrier
  s_cbranch_scc1 Ls84
  s_mov_b64 exec, 1
  buffer_atomic_add v10, v17, s[28:31], s78 offen sc0 sc1
  s_mov_b64 exec, -1
Ls84:
  s_cmp_lg_u32 s27, 1
  s_cbranch_scc1 Ls85
  s_waitcnt vmcnt(0)
  v_readfirstlane_b32 s70, v10
  s_nop 0
  s_add_u32 s70, s70, 1
  s_cmp_ge_u32 s70, s77
  s_cbranch_scc1 Ls85
  s_mov_b64 exec, 1
  s_mov_b32 s70, 0
Lp86:
  buffer_load_dword v5, v17, s[28:31], s78 offen sc1
  s_add_u32 s70, s70, 1
  s_waitcnt vmcnt(0)
  v_cmp_gt_u32 vcc, s77, v5
  s_cmp_gt_u32 s70, 2097152
  s_cbranch_scc1 Lq87
  s_nop 2
  s_cbranch_vccnz Lp86
Lq87:
  s_mov_b64 exec, -1
Ls85:
  s_barrier
  s_mov_b32 m0, s45
  s_nop 0
  buffer_load_dwordx4 v20, s[64:67], s44 offen offset:0 sc1 lds
  s_add_u32 s46, s46, 1
  s_add_u32 s45, s45, 16384
  s_cmp_ge_u32 s45, s60
  s_cselect_b32 s45, s53, s45
  buffer_load_dwordx4 v21, s[64:67], s44 offen offset:1024 sc1 lds
  v_readlane_b32 s4, v28, s46
  buffer_load_dwordx4 v22, s[64:67], s44 offen offset:2048 sc1 lds
  buffer_load_dwordx4 v23, s[64:67], s44 offen offset:3072 sc1 lds
  s_mov_b32 s44, s4
  s_mov_b32 m0, s45
  s_nop 0
  buffer_load_dwordx4 v20, s[64:67], s44 offen offset:0 sc1 lds
  s_add_u32 s46, s46, 1
  s_add_u32 s45, s45, 16384
  s_cmp_ge_u32 s45, s60
  s_cselect_b32 s45, s53, s45
  buffer_load_dwordx4 v21, s[64:67], s44 offen offset:1024 sc1 lds
  v_readlane_b32 s4, v28, s46
  buffer_load_dwordx4 v22, s[64:67], s44 offen offset:2048 sc1 lds
  buffer_load_dwordx4 v23, s[64:67], s44 offen offset:3072 sc1 lds
  s_mov_b32 s44, s4
  s_add_u32 s2, s2, 0x100000
  s_waitcnt vmcnt(4)
  s_cmp_lg_u32 s27, 2
  s_cbranch_scc1 Ls88
  s_mov_b64 exec, 1
  buffer_atomic_add v18, v17, s[28:31], s69 offen offset:512 sc1
  s_mov_b64 exec, -1
Ls88:
  s_mov_b32 s52, 3
  s_branch Ll_layer
Le5:
  s_barrier
  s_setprio 3
  buffer_load_dwordx4 v20, s[64:67], s44 offen offset:0 sc1 lds
  s_add_u32 s46, s46, 1
  s_add_u32 s45, s45, 16384
  s_cmp_ge_u32 s45, s60
  s_cselect_b32 s45, s53, s45
  buffer_load_dwordx4 v21, s[64:67], s44 offen offset:1024 sc1 lds
  v_readlane_b32 s4, v28, s46
  ds_read_b64_tr_b16 v[64:65], v124 offset:0
  ds_read_b64_tr_b16 v[66:67], v124 offset:6144
  ds_read_b64_tr_b16 v[68:69], v125 offset:0
  ds_read_b64_tr_b16 v[70:71], v125 offset:6144
  ds_read_b64_tr_b16 v[72:73], v126 offset:0
  ds_read_b64_tr_b16 v[74:75], v126 offset:6144
  ds_read_b64_tr_b16 v[76:77], v127 offset:0
  ds_read_b64_tr_b16 v[78:79], v127 offset:6144
  ds_read_b64_tr_b16 v[80:81], v124 offset:12288
  buffer_load_dwordx4 v22, s[64:67], s44 offen offset:2048 sc1 lds
  ds_read_b64_tr_b16 v[82:83], v124 offset:18432
  ds_read_b64_tr_b16 v[84:85], v125 offset:12288
  ds_read_b64_tr_b16 v[86:87], v125 offset:18432
  ds_read_b64_tr_b16 v[88:89], v126 offset:12288
  ds_read_b64_tr_b16 v[90:91], v126 offset:18432
  ds_read_b64_tr_b16 v[92:93], v127 offset:12288
  ds_read_b64_tr_b16 v[94:95], v127 offset:18432
  ds_read_b128 v[160:163], v25 offset:0
  ds_read_b128 v[164:167], v25 offset:2048
  buffer_load_dwordx4 v23, s[64:67], s44 offen offset:3072 sc1 lds
  ds_read_b128 v[168:171], v25 offset:4096
  ds_read_b128 v[172:175], v25 offset:6144
  v_mov_b32 v96, 0x3f803f80
  v_mov_b32 v97, 0x3f803f80
  v_mov_b32 v98, 0x3f803f80
  v_mov_b32 v99, 0x3f803f80
  v_and_b32 v3, 3, v1
  v_lshrrev_b32 v4, 4, v1
  v_bfe_u32 v5, v1, 2, 2
  s_mov_b32 s44, s4
  s_mov_b32 m0, s56
  s_add_u32 s47, s47, 1
  buffer_load_dwordx4 v11, s[32:35], s51 offen offset:0  lds
  v_readlane_b32 s5, v29, s47
  s_sub_u32 s56, s56, 24576
  s_cmp_eq_u32 s56, s61
  s_cselect_b32 s56, s54, s56
  v_cmp_eq_u32 s[94:95], 1, v3
  v_cmp_eq_u32 s[40:41], 2, v3
  v_cmp_eq_u32 s[48:49], 3, v3
  v_cmp_eq_u32 s[62:63], v4, v5
  s_waitcnt lgkmcnt(0)
  v_mfma_f32_16x16x32_bf16 v[100:103], v[64:67], v[96:99], 0
  v_mfma_f32_16x16x32_bf16 v[104:107], v[68:71], v[96:99], 0
  v_mfma_f32_16x16x32_bf16 v[108:111], v[72:75], v[96:99], 0
  v_mfma_f32_16x16x32_bf16 v[112:115], v[76:79], v[96:99], 0
  buffer_load_dwordx4 v12, s[32:35], s51 offen offset:1024  lds
  v_readlane_b32 s70, v128, s47
  v_mfma_f32_16x16x32_bf16 v[100:103], v[80:83], v[96:99], v[100:103]
  v_mfma_f32_16x16x32_bf16 v[104:107], v[84:87], v[96:99], v[104:107]
  v_mfma_f32_16x16x32_bf16 v[108:111], v[88:91], v[96:99], v[108:111]
  v_mfma_f32_16x16x32_bf16 v[112:115], v[92:95], v[96:99], v[112:115]
  v_mfma_f32_16x16x32_bf16 v[176:179], v[160:163], v[160:163], 0
  v_mfma_f32_16x16x32_bf16 v[180:183], v[164:167], v[164:167], 0
  v_mfma_f32_16x16x32_bf16 v[184:187], v[168:171], v[168:171], 0
  v_mfma_f32_16x16x32_bf16 v[188:191], v[172:175], v[172:175], 0
  v_mfma_f32_16x16x32_bf16 v[192:195], v[96:99], v[160:163], 0
  buffer_load_dwordx4 v13, s[32:35], s51 offen offset:2048  lds
  s_load_dwordx2 s[10:11], s[8:9], s70 offset:60
  s_load_dwordx2 s[10:11], s[8:9], s70 offset:2108
  v_mfma_f32_16x16x32_bf16 v[196:199], v[96:99], v[164:167], 0
  v_mfma_f32_16x16x32_bf16 v[200:203], v[96:99], v[168:171], 0
  v_mfma_f32_16x16x32_bf16 v[204:207], v[96:99], v[172:175], 0
  s_lshl_b32 s39, s25, 14
  s_lshl_b32 s42, s24, 10
  s_add_u32 s39, s39, s42
  s_lshl_b32 s42, s27, 8
  s_add_u32 s42, s42, s39
  s_add_u32 s42, s42, 96468992
  buffer_load_dwordx4 v14, s[32:35], s51 offen offset:3072  lds
  s_and_b32 s43, s25, 1
  s_lshl_b32 s43, s43, 12
  s_and_b32 s39, s25, 2
  s_lshl_b32 s39, s39, 13
  s_add_u32 s43, s43, s39
  s_lshl_b32 s39, s37, 10
  s_add_u32 s43, s43, s39
  s_lshl_b32 s39, s36, 9
  s_add_u32 s43, s43, s39
  s_add_u32 m0, m0, 4096
  s_nop 0
  buffer_load_dwordx4 v15, s[32:35], s51 offen offset:0  lds
  s_add_u32 s43, s43, s55
  s_add_u32 s43, s43, 41945088
  s_lshl_b32 s39, s36, 8
  s_sub_u32 s43, s43, s39
  buffer_load_dwordx4 v16, s[32:35], s51 offen offset:1024  lds
  s_mov_b32 s51, s5
  s_setprio 0
  s_add_u32 s52, s52, 1
  s_cmp_lt_u32 s52, 15
  s_waitcnt vmcnt(10)
  s_branch Lw4
Le6:
  s_barrier
  s_setprio 3
  buffer_load_dwordx4 v20, s[64:67], s44 offen offset:0 sc1 lds
  s_add_u32 s46, s46, 1
  s_add_u32 s45, s45, 16384
  s_cmp_ge_u32 s45, s60
  s_cselect_b32 s45, s53, s45
  buffer_load_dwordx4 v21, s[64:67], s44 offen offset:1024 sc1 lds
  v_readlane_b32 s4, v28, s46
  v_cndmask_b32 v100, v100, v104, s[94:95]
  v_cndmask_b32 v101, v101, v105, s[94:95]
  v_cndmask_b32 v102, v102, v106, s[94:95]
  v_cndmask_b32 v103, v103, v107, s[94:95]
  v_cndmask_b32 v100, v100, v108, s[40:41]
  v_cndmask_b32 v101, v101, v109, s[40:41]
  v_cndmask_b32 v102, v102, v110, s[40:41]
  buffer_load_dwordx4 v22, s[64:67], s44 offen offset:2048 sc1 lds
  v_cndmask_b32 v103, v103, v111, s[40:41]
  v_cndmask_b32 v100, v100, v112, s[48:49]
  v_cndmask_b32 v101, v101, v113, s[48:49]
  v_cndmask_b32 v102, v102, v114, s[48:49]
  v_cndmask_b32 v103, v103, v115, s[48:49]
  v_cndmask_b32 v176, v176, v177, s[94:95]
  v_cndmask_b32 v180, v180, v181, s[94:95]
  buffer_load_dwordx4 v23, s[64:67], s44 offen offset:3072 sc1 lds
  v_cndmask_b32 v184, v184, v185, s[94:95]
  v_cndmask_b32 v188, v188, v189, s[94:95]
  v_cndmask_b32 v176, v176, v178, s[40:41]
  v_cndmask_b32 v180, v180, v182, s[40:41]
  v_cndmask_b32 v184, v184, v186, s[40:41]
  v_cndmask_b32 v188, v188, v190, s[40:41]
  v_cndmask_b32 v176, v176, v179, s[48:49]
  s_mov_b32 s44, s4
  s_mov_b32 m0, s56
  s_add_u32 s47, s47, 1
  buffer_load_dwordx4 v11, s[32:35], s51 offen offset:0  lds
  v_readlane_b32 s5, v29, s47
  s_sub_u32 s56, s56, 24576
  s_cmp_eq_u32 s56, s61
  s_cselect_b32 s56, s54, s56
  v_cndmask_b32 v180, v180, v183, s[48:49]
  v_cndmask_b32 v184, v184, v187, s[48:49]
  v_cndmask_b32 v188, v188, v191, s[48:49]
  v_cndmask_b32 v176, 0, v176, s[62:63]
  v_cndmask_b32 v177, 0, v180, s[62:63]
  v_cndmask_b32 v178, 0, v184, s[62:63]
  v_cndmask_b32 v179, 0, v188, s[62:63]
  buffer_load_dwordx4 v12, s[32:35], s51 offen offset:1024  lds
  v_readlane_b32 s70, v128, s47
  v_mul_f32 v192, 0x3e800000, v192
  v_mul_f32 v193, 0x3e800000, v196
  v_mul_f32 v194, 0x3e800000, v200
  v_mul_f32 v195, 0x3e800000, v204
  s_nop 2
  v_permlane32_swap_b32 v192, v194
  v_permlane32_swap_b32 v193, v195
  buffer_load_dwordx4 v13, s[32:35], s51 offen offset:2048  lds
  s_load_dwordx2 s[10:11], s[8:9], s70 offset:60
  s_load_dwordx2 s[10:11], s[8:9], s70 offset:2108
  v_permlane32_swap_b32 v176, v178
  v_permlane32_swap_b32 v177, v179
  v_add_f32 v192, v192, v194
  v_add_f32 v193, v193, v195
  v_add_f32 v176, v176, v178
  v_add_f32 v177, v177, v179
  v_permlane16_swap_b32 v192, v193
  buffer_load_dwordx4 v14, s[32:35], s51 offen offset:3072  lds
  s_nop 0
  v_permlane16_swap_b32 v176, v177
  v_add_f32 v192, v192, v193
  v_add_f32 v193, v176, v177
  v_lshlrev_b32 v3, 6, v3
  v_lshl_add_u32 v3, v4, 4, v3
  v_lshrrev_b32 v5, 5, v1
  s_add_u32 m0, m0, 4096
  s_nop 0
  buffer_load_dwordx4 v15, s[32:35], s51 offen offset:0  lds
  s_lshl_b32 s39, s36, 9
  s_sub_u32 s39, 512, s39
  v_mul_u32_u24 v5, s39, v5
  v_lshl_add_u32 v4, v1, 3, v5
  buffer_load_dwordx4 v16, s[32:35], s51 offen offset:1024  lds
  s_mov_b32 s51, s5
  buffer_store_dwordx2 v[192:193], v4, s[28:31], s43 offen sc1
  s_mov_b32 exec_lo, 0x000f000f
  s_mov_b32 exec_hi, 0x000f000f
  buffer_store_dwordx4 v[100:103], v3, s[28:31], s42 offen sc1
  s_mov_b64 exec, -1
  s_setprio 0
  s_add_u32 s52, s52, 1
  s_cmp_lt_u32 s52, 15
  s_waitcnt vmcnt(12)
  s_branch Lw4
Le7:
  s_barrier
  buffer_load_dwordx4 v20, s[64:67], s44 offen offset:0 sc1 lds
  s_add_u32 s46, s46, 1
  s_add_u32 s45, s45, 16384
  s_cmp_ge_u32 s45, s60
  s_cselect_b32 s45, s53, s45
  buffer_load_dwordx4 v21, s[64:67], s44 offen offset:1024 sc1 lds
  v_readlane_b32 s4, v28, s46
  buffer_load_dwordx4 v22, s[64:67], s44 offen offset:2048 sc1 lds
  buffer_load_dwordx4 v23, s[64:67], s44 offen offset:3072 sc1 lds
  s_mov_b32 s44, s4
  s_mov_b32 m0, s56
  s_add_u32 s47, s47, 1
  buffer_load_dwordx4 v11, s[32:35], s51 offen offset:0  lds
  v_readlane_b32 s5, v29, s47
  s_sub_u32 s56, s56, 24576
  s_cmp_eq_u32 s56, s61
  s_cselect_b32 s56, s54, s56
  buffer_load_dwordx4 v12, s[32:35], s51 offen offset:1024  lds
  v_readlane_b32 s70, v128, s47
  buffer_load_dwordx4 v13, s[32:35], s51 offen offset:2048  lds
  s_load_dwordx2 s[10:11], s[8:9], s70 offset:60
  s_load_dwordx2 s[10:11], s[8:9], s70 offset:2108
  buffer_load_dwordx4 v14, s[32:35], s51 offen offset:3072  lds
  s_add_u32 m0, m0, 4096
  s_nop 0
  buffer_load_dwordx4 v15, s[32:35], s51 offen offset:0  lds
  buffer_load_dwordx4 v16, s[32:35], s51 offen offset:1024  lds
  s_mov_b32 s51, s5
  v_min_u32 v26, 18, v1
  v_lshlrev_b32 v26, 7, v26
  s_mul_i32 s39, s92, 2432
  s_add_u32 s39, s39, 0
  v_add_u32 v26, s39, v26
  v_min_u32 v26, 2097024, v26
  global_load_dword v27, v26, s[8:9]
  v_min_u32 v26, 63, v1
  v_lshlrev_b32 v26, 7, v26
  s_mul_i32 s39, s92, 8192
  s_add_u32 s39, s39, 0
  v_add_u32 v26, s39, v26
  v_min_u32 v26, 7339904, v26
  global_load_dword v27, v26, s[12:13]
  v_lshrrev_b32 v5, 3, v1
  v_and_b32 v6, 7, v1
  s_lshl_b32 s39, s92, 13
  v_lshl_add_u32 v5, v5, 10, s39
  v_lshl_add_u32 v129, v6, 4, v5
  global_load_dwordx4 v[132:135], v129, s[14:15] offset:384
  s_add_u32 s52, s52, 1
  s_cmp_lt_u32 s52, 15
  s_waitcnt vmcnt(13)
  s_branch Lw4
Le8:
  s_barrier
  buffer_load_dword v4, v17, s[28:31], s68 offen sc1
  buffer_load_dwordx4 v20, s[64:67], s44 offen offset:0 sc1 lds
  s_add_u32 s46, s46, 1
  s_add_u32 s45, s45, 16384
  s_cmp_ge_u32 s45, s60
  s_cselect_b32 s45, s53, s45
  buffer_load_dwordx4 v21, s[64:67], s44 offen offset:1024 sc1 lds
  v_readlane_b32 s4, v28, s46
  buffer_load_dwordx4 v22, s[64:67], s44 offen offset:2048 sc1 lds
  buffer_load_dwordx4 v23, s[64:67], s44 offen offset:3072 sc1 lds
  s_mov_b32 s44, s4
  s_mov_b32 m0, s56
  s_add_u32 s47, s47, 1
  buffer_load_dwordx4 v11, s[32:35], s51 offen offset:0  lds
  v_readlane_b32 s5, v29, s47
  s_sub_u32 s56, s56, 24576
  s_cmp_eq_u32 s56, s61
  s_cselect_b32 s56, s54, s56
  buffer_load_dwordx4 v12, s[32:35], s51 offen offset:1024  lds
  v_readlane_b32 s70, v128, s47
  buffer_load_dwordx4 v13, s[32:35], s51 offen offset:2048  lds
  s_load_dwordx2 s[10:11], s[8:9], s70 offset:60
  s_load_dwordx2 s[10:11], s[8:9], s70 offset:2108
  buffer_load_dwordx4 v14, s[32:35], s51 offen offset:3072  lds
  s_add_u32 m0, m0, 4096
  s_nop 0
  buffer_load_dwordx4 v15, s[32:35], s51 offen offset:0  lds
  buffer_load_dwordx4 v16, s[32:35], s51 offen offset:1024  lds
  s_mov_b32 s51, s5
  s_waitcnt vmcnt(10)
  v_cmp_gt_u32 vcc, s77, v4
  s_nop 4
  s_cbranch_vccz Lo9
  s_mov_b64 exec, 1
  s_mov_b32 s70, 0
Lp10:
  buffer_load_dword v4, v17, s[28:31], s68 offen sc1
  s_add_u32 s70, s70, 1
  s_waitcnt vmcnt(0)
  v_cmp_gt_u32 vcc, s77, v4
  s_cmp_gt_u32 s70, 2097152
  s_cbranch_scc1 Lq11
  s_nop 2
  s_cbranch_vccnz Lp10
Lq11:
  s_mov_b64 exec, -1
Lo9:
  s_add_u32 s52, s52, 1
  s_cmp_lt_u32 s52, 15
  s_waitcnt vmcnt(10)
  s_branch Lw4
Le59:
  s_barrier
  buffer_load_dwordx4 v30, s[64:67], s44 offen offset:0 sc1 lds
  s_add_u32 s46, s46, 1
  s_add_u32 s45, s45, 16384
  s_cmp_ge_u32 s45, s60
  s_cselect_b32 s45, s53, s45
  buffer_load_dwordx4 v30, s[64:67], s44 offen offset:1024 sc1 lds
  v_readlane_b32 s4, v155, s46
  buffer_load_dwordx4 v30, s[64:67], s44 offen offset:2048 sc1 lds
  buffer_load_dwordx4 v30, s[64:67], s44 offen offset:3072 sc1 lds
  s_mov_b32 s44, s4
  s_mov_b32 m0, s56
  s_add_u32 s47, s47, 1
  buffer_load_dwordx4 v140, s[84:87], s51 offen offset:0  lds
  v_readlane_b32 s5, v156, s47
  s_add_u32 s56, s56, 28672
  s_cmp_eq_u32 s56, s61
  s_cselect_b32 s56, s54, s56
  buffer_load_dwordx4 v141, s[84:87], s51 offen offset:1024  lds
  buffer_load_dwordx4 v142, s[84:87], s51 offen offset:2048  lds
  buffer_load_dwordx4 v143, s[84:87], s51 offen offset:3072  lds
  s_add_u32 m0, m0, 4096
  s_nop 0
  buffer_load_dwordx4 v144, s[84:87], s51 offen offset:0  lds
  buffer_load_dwordx4 v145, s[84:87], s51 offen offset:1024  lds
  buffer_load_dwordx4 v146, s[84:87], s51 offen offset:2048  lds
  s_mov_b32 s51, s5
  v_min_u32 v26, 63, v1
  v_lshlrev_b32 v26, 7, v26
  s_mul_i32 s39, s92, 8192
  s_add_u32 s39, s39, 0
  v_add_u32 v26, s39, v26
  v_min_u32 v26, 7339904, v26
  global_load_dword v27, v26, s[14:15]
  s_add_u32 s52, s52, 1
  s_cmp_lt_u32 s52, 15
  s_waitcnt vmcnt(12)
  s_branch Lw58
Le60:
  s_barrier
  buffer_load_dword v4, v17, s[28:31], s68 offen sc1
  buffer_load_dwordx4 v30, s[64:67], s44 offen offset:0 sc1 lds
  s_add_u32 s46, s46, 1
  s_add_u32 s45, s45, 16384
  s_cmp_ge_u32 s45, s60
  s_cselect_b32 s45, s53, s45
  buffer_load_dwordx4 v30, s[64:67], s44 offen offset:1024 sc1 lds
  v_readlane_b32 s4, v155, s46
  buffer_load_dwordx4 v30, s[64:67], s44 offen offset:2048 sc1 lds
  buffer_load_dwordx4 v30, s[64:67], s44 offen offset:3072 sc1 lds
  s_mov_b32 s44, s4
  s_mov_b32 m0, s56
  s_add_u32 s47, s47, 1
  buffer_load_dwordx4 v140, s[84:87], s51 offen offset:0  lds
  v_readlane_b32 s5, v156, s47
  s_add_u32 s56, s56, 28672
  s_cmp_eq_u32 s56, s61
  s_cselect_b32 s56, s54, s56
  buffer_load_dwordx4 v141, s[84:87], s51 offen offset:1024  lds
  buffer_load_dwordx4 v142, s[84:87], s51 offen offset:2048  lds
  buffer_load_dwordx4 v143, s[84:87], s51 offen offset:3072  lds
  s_add_u32 m0, m0, 4096
  s_nop 0
  buffer_load_dwordx4 v144, s[84:87], s51 offen offset:0  lds
  buffer_load_dwordx4 v145, s[84:87], s51 offen offset:1024  lds
  buffer_load_dwordx4 v146, s[84:87], s51 offen offset:2048  lds
  s_mov_b32 s51, s5
  s_waitcnt vmcnt(11)
  v_cmp_gt_u32 vcc, s77, v4
  s_nop 4
  s_cbranch_vccz Lo61
  s_mov_b64 exec, 1
  s_mov_b32 s70, 0
Lp62:
  buffer_load_dword v4, v17, s[28:31], s68 offen sc1
  s_add_u32 s70, s70, 1
  s_waitcnt vmcnt(0)
  v_cmp_gt_u32 vcc, s77, v4
  s_cmp_gt_u32 s70, 2097152
  s_cbranch_scc1 Lq63
  s_nop 2
  s_cbranch_vccnz Lp62
Lq63:
  s_mov_b64 exec, -1
Lo61:
  s_add_u32 s52, s52, 1
  s_cmp_lt_u32 s52, 15
  s_waitcnt vmcnt(11)
  s_branch Lw58
L_compute:
  s_waitcnt lgkmcnt(0)
  s_mov_b32 s28, s20
  s_mov_b32 s29, s21
  s_lshr_b32 s36, s26, 1
  s_and_b32 s37, s26, 1
  s_setprio 2
  s_mov_b32 s64, s4
  s_mov_b32 s65, s5
  s_mov_b32 s66, 4194304
  v_lshrrev_b32 v184, 4, v1
  v_bfe_u32 v185, v1, 2, 2
  v_and_b32 v186, 3, v1
  v_and_b32 v187, 1, v184
  v_lshl_add_u32 v187, v187, 2, v185
  v_lshrrev_b32 v188, 1, v184
  v_mul_u32_u24 v188, 3072, v188
  v_lshl_add_u32 v188, v187, 7, v188
  v_lshl_add_u32 v188, v186, 3, v188
  v_add_u32 v188, 131072, v188
  v_lshrrev_b32 v189, 1, v187
  s_lshl_b32 s38, s36, 13
  v_and_b32 v176, 15, v1
  v_lshrrev_b32 v177, 1, v176
  v_xor_b32 v177, v177, v184
  v_lshlrev_b32 v177, 4, v177
  v_lshl_add_u32 v177, v176, 7, v177
  v_add_u32 v6, s38, v177
  v_xor_b32 v7, 64, v6
  s_lshl_b32 s39, s37, 1
  s_add_u32 s39, s39, 0
  v_xor_b32 v176, s39, v189
  v_lshl_add_u32 v224, v176, 5, v188
  s_lshl_b32 s39, s37, 1
  s_add_u32 s39, s39, 1
  v_xor_b32 v176, s39, v189
  v_lshl_add_u32 v225, v176, 5, v188
  s_mov_b32 s44, 1
  s_mov_b32 s45, 1
  s_mov_b32 s46, 16384
  s_mov_b32 s47, 4294942720
  s_mov_b32 s48, 0
  s_mov_b32 s80, 16384
  s_mov_b32 s81, 4294934528
  s_mov_b32 s82, 4294942720
  s_mov_b32 s83, 49152
  s_waitcnt lgkmcnt(0)
Lc_layer:
  s_barrier
  ds_read_b64_tr_b16 v[176:177], v224 offset:1024
  ds_read_b128 v[112:115], v6 offset:0
  ds_read_b64_tr_b16 v[178:179], v224 offset:7168
  ds_read_b128 v[128:131], v7 offset:0
  ds_read_b64_tr_b16 v[180:181], v224 offset:13312
  ds_read_b64_tr_b16 v[182:183], v224 offset:19456
  ds_read_b128 v[116:119], v6 offset:2048
  ds_read_b128 v[132:135], v7 offset:2048
  ds_read_b64_tr_b16 v[184:185], v225 offset:1024
  ds_read_b128 v[120:123], v6 offset:4096
  ds_read_b64_tr_b16 v[186:187], v225 offset:7168
  ds_read_b128 v[136:139], v7 offset:4096
  ds_read_b128 v[124:127], v6 offset:6144
  ds_read_b64_tr_b16 v[188:189], v225 offset:13312
  ds_read_b128 v[140:143], v7 offset:6144
  ds_read_b64_tr_b16 v[190:191], v225 offset:19456
  s_waitcnt lgkmcnt(10)
  v_mfma_f32_16x16x32_bf16 v[48:51], v[176:179], v[112:115], 0
  ds_read_b64_tr_b16 v[192:193], v224 offset:2048
  v_mfma_f32_16x16x32_bf16 v[48:51], v[180:183], v[128:131], v[48:51]
  ds_read_b64_tr_b16 v[194:195], v224 offset:8192
  s_waitcnt lgkmcnt(10)
  v_mfma_f32_16x16x32_bf16 v[52:55], v[180:183], v[132:135], 0
  ds_read_b64_tr_b16 v[196:197], v224 offset:14336
  v_mfma_f32_16x16x32_bf16 v[52:55], v[176:179], v[116:119], v[52:55]
  ds_read_b64_tr_b16 v[198:199], v224 offset:20480
  s_waitcnt lgkmcnt(8)
  v_mfma_f32_16x16x32_bf16 v[56:59], v[176:179], v[120:123], 0
  v_add_u32 v6, s46, v6
  v_mfma_f32_16x16x32_bf16 v[56:59], v[180:183], v[136:139], v[56:59]
  v_add_u32 v7, s46, v7
  s_waitcnt lgkmcnt(5)
  v_mfma_f32_16x16x32_bf16 v[60:63], v[180:183], v[140:143], 0
  v_mfma_f32_16x16x32_bf16 v[60:63], v[176:179], v[124:127], v[60:63]
  s_waitcnt lgkmcnt(4)
  v_mfma_f32_16x16x32_bf16 v[76:79], v[184:187], v[124:127], 0
  ds_read_b64_tr_b16 v[176:177], v225 offset:2048
  v_mfma_f32_16x16x32_bf16 v[76:79], v[188:191], v[140:143], v[76:79]
  ds_read_b64_tr_b16 v[178:179], v225 offset:8192
  v_mfma_f32_16x16x32_bf16 v[72:75], v[188:191], v[136:139], 0
  ds_read_b64_tr_b16 v[180:181], v225 offset:14336
  v_mfma_f32_16x16x32_bf16 v[72:75], v[184:187], v[120:123], v[72:75]
  ds_read_b64_tr_b16 v[182:183], v225 offset:20480
  v_mfma_f32_16x16x32_bf16 v[68:71], v[184:187], v[116:119], 0
  v_mfma_f32_16x16x32_bf16 v[68:71], v[188:191], v[132:135], v[68:71]
  v_mfma_f32_16x16x32_bf16 v[64:67], v[188:191], v[128:131], 0
  v_mfma_f32_16x16x32_bf16 v[64:67], v[184:187], v[112:115], v[64:67]
  s_waitcnt lgkmcnt(4)
  v_mfma_f32_16x16x32_bf16 v[80:83], v[112:115], v[192:195], 0
  ds_read_b64_tr_b16 v[184:185], v224 offset:0
  v_mfma_f32_16x16x32_bf16 v[80:83], v[128:131], v[196:199], v[80:83]
  ds_read_b64_tr_b16 v[186:187], v224 offset:6144
  v_mfma_f32_16x16x32_bf16 v[84:87], v[132:135], v[196:199], 0
  ds_read_b64_tr_b16 v[188:189], v224 offset:12288
  v_mfma_f32_16x16x32_bf16 v[84:87], v[116:119], v[192:195], v[84:87]
  ds_read_b64_tr_b16 v[190:191], v224 offset:18432
  v_mfma_f32_16x16x32_bf16 v[88:91], v[120:123], v[192:195], 0
  v_add_u32 v224, s47, v224
  v_mfma_f32_16x16x32_bf16 v[88:91], v[136:139], v[196:199], v[88:91]
  v_mfma_f32_16x16x32_bf16 v[92:95], v[140:143], v[196:199], 0
  v_mfma_f32_16x16x32_bf16 v[92:95], v[124:127], v[192:195], v[92:95]
  s_waitcnt lgkmcnt(4)
  v_mfma_f32_16x16x32_bf16 v[108:111], v[124:127], v[176:179], 0
  ds_read_b64_tr_b16 v[192:193], v225 offset:0
  v_mfma_f32_16x16x32_bf16 v[108:111], v[140:143], v[180:183], v[108:111]
  ds_read_b64_tr_b16 v[194:195], v225 offset:6144
  v_mfma_f32_16x16x32_bf16 v[104:107], v[136:139], v[180:183], 0
  ds_read_b64_tr_b16 v[196:197], v225 offset:12288
  v_mfma_f32_16x16x32_bf16 v[104:107], v[120:123], v[176:179], v[104:107]
  ds_read_b64_tr_b16 v[198:199], v225 offset:18432
  v_mfma_f32_16x16x32_bf16 v[100:103], v[116:119], v[176:179], 0
  v_add_u32 v225, s47, v225
  v_mfma_f32_16x16x32_bf16 v[100:103], v[132:135], v[180:183], v[100:103]
  s_add_u32 s44, s44, 1
  s_cmp_eq_u32 s44, 3
  v_mfma_f32_16x16x32_bf16 v[96:99], v[128:131], v[180:183], 0
  s_cselect_b32 s44, 0, s44
  s_cselect_b32 s46, s81, s80
  v_mfma_f32_16x16x32_bf16 v[96:99], v[112:115], v[176:179], v[96:99]
  s_cselect_b32 s47, s83, s82
  s_waitcnt lgkmcnt(4)
  v_mfma_f32_16x16x32_bf16 v[16:19], v[184:187], v[112:115], 0
  v_mfma_f32_16x16x32_bf16 v[16:19], v[188:191], v[128:131], v[16:19]
  v_mfma_f32_16x16x32_bf16 v[20:23], v[188:191], v[132:135], 0
  s_waitcnt lgkmcnt(0)
  v_mfma_f32_16x16x32_bf16 v[20:23], v[184:187], v[116:119], v[20:23]
  s_waitcnt vmcnt(0)
  s_barrier
  v_mfma_f32_16x16x32_bf16 v[24:27], v[184:187], v[120:123], 0
  v_mfma_f32_16x16x32_bf16 v[24:27], v[188:191], v[136:139], v[24:27]
  v_mfma_f32_16x16x32_bf16 v[28:31], v[188:191], v[140:143], 0
  v_mfma_f32_16x16x32_bf16 v[28:31], v[184:187], v[124:127], v[28:31]
  v_mfma_f32_16x16x32_bf16 v[44:47], v[192:195], v[124:127], 0
  v_mfma_f32_16x16x32_bf16 v[44:47], v[196:199], v[140:143], v[44:47]
  v_mfma_f32_16x16x32_bf16 v[40:43], v[196:199], v[136:139], 0
  v_mfma_f32_16x16x32_bf16 v[40:43], v[192:195], v[120:123], v[40:43]
  v_mfma_f32_16x16x32_bf16 v[36:39], v[192:195], v[116:119], 0
  v_mfma_f32_16x16x32_bf16 v[36:39], v[196:199], v[132:135], v[36:39]
  v_mfma_f32_16x16x32_bf16 v[32:35], v[196:199], v[128:131], 0
  v_mfma_f32_16x16x32_bf16 v[32:35], v[192:195], v[112:115], v[32:35]
  v_and_b32 v4, 15, v1
  v_lshrrev_b32 v5, 4, v1
  s_lshl_b32 s39, s36, 8
  s_add_u32 s39, s39, 155648
  v_lshl_add_u32 v14, v4, 2, s39
  v_lshl_add_u32 v15, v5, 4, s39
  s_lshl_b32 s39, s37, 7
  s_add_u32 s39, s39, 155648
  v_lshl_add_u32 v12, v5, 4, s39
  s_add_u32 s39, s39, 1536
  v_lshl_add_u32 v11, v4, 2, s39
  v_mov_b32 v8, 158728
  v_lshlrev_b32 v13, 4, v1
  s_lshl_b32 s42, s36, 11
  s_sub_u32 s43, 6144, s42
  s_mul_i32 s39, s37, 24576
  s_add_u32 s39, s39, 16384
  s_add_u32 s40, s42, s39
  s_add_u32 s41, s43, s39
  v_add_u32 v2, s40, v13
  v_add_u32 v3, s41, v13
  s_lshl_b32 s39, s37, 14
  s_add_u32 s39, s39, s23
  s_add_u32 s39, s39, 16777216
  s_add_u32 s40, s39, s42
  s_add_u32 s41, s39, s43
  s_add_u32 s42, s40, 4194304
  s_add_u32 s43, s41, 4194304
  s_add_u32 s49, s24, s25
  s_and_b32 s49, s49, 15
  s_mul_i32 s49, s49, 6
  s_lshr_b32 s49, s49, 4
  s_max_u32 s49, s49, 1
  s_add_u32 s49, s49, 2
  s_and_b32 s49, s49, 14
  s_cmp_eq_u32 s26, 0
  s_cselect_b32 s49, s49, -1
  s_cmp_eq_u32 s22, 0
  s_cselect_b32 s49, s49, -1
  s_barrier
  ds_read_b64_tr_b16 v[176:177], v224 offset:1024
  ds_read_b128 v[112:115], v6 offset:0
  ds_read_b64_tr_b16 v[178:179], v224 offset:7168
  ds_read_b128 v[128:131], v7 offset:0
  ds_read_b64_tr_b16 v[180:181], v224 offset:13312
  ds_read_b64_tr_b16 v[182:183], v224 offset:19456
  ds_read_b128 v[116:119], v6 offset:2048
  ds_read_b128 v[132:135], v7 offset:2048
  ds_read_b64_tr_b16 v[184:185], v225 offset:1024
  ds_read_b128 v[120:123], v6 offset:4096
  ds_read_b64_tr_b16 v[186:187], v225 offset:7168
  ds_read_b128 v[136:139], v7 offset:4096
.p2align 6
Lg89:
  s_waitcnt lgkmcnt(6)
  v_mfma_f32_16x16x32_bf16 v[48:51], v[176:179], v[112:115], v[48:51]
  ds_read_b128 v[124:127], v6 offset:6144
  v_mfma_f32_16x16x32_bf16 v[48:51], v[180:183], v[128:131], v[48:51]
  ds_read_b64_tr_b16 v[188:189], v225 offset:13312
  s_waitcnt lgkmcnt(6)
  v_mfma_f32_16x16x32_bf16 v[52:55], v[180:183], v[132:135], v[52:55]
  ds_read_b128 v[140:143], v7 offset:6144
  v_mfma_f32_16x16x32_bf16 v[52:55], v[176:179], v[116:119], v[52:55]
  ds_read_b64_tr_b16 v[190:191], v225 offset:19456
  s_waitcnt lgkmcnt(4)
  v_mfma_f32_16x16x32_bf16 v[56:59], v[176:179], v[120:123], v[56:59]
  ds_read_b64_tr_b16 v[192:193], v224 offset:2048
  v_mfma_f32_16x16x32_bf16 v[56:59], v[180:183], v[136:139], v[56:59]
  ds_read_b64_tr_b16 v[194:195], v224 offset:8192
  s_waitcnt lgkmcnt(3)
  v_mfma_f32_16x16x32_bf16 v[60:63], v[180:183], v[140:143], v[60:63]
  ds_read_b64_tr_b16 v[196:197], v224 offset:14336
  v_mfma_f32_16x16x32_bf16 v[60:63], v[176:179], v[124:127], v[60:63]
  ds_read_b64_tr_b16 v[198:199], v224 offset:20480
  s_waitcnt lgkmcnt(4)
  v_mfma_f32_16x16x32_bf16 v[76:79], v[184:187], v[124:127], v[76:79]
  ds_read_b64_tr_b16 v[176:177], v225 offset:2048
  v_mfma_f32_16x16x32_bf16 v[76:79], v[188:191], v[140:143], v[76:79]
  ds_read_b64_tr_b16 v[178:179], v225 offset:8192
  v_mfma_f32_16x16x32_bf16 v[72:75], v[188:191], v[136:139], v[72:75]
  ds_read_b64_tr_b16 v[180:181], v225 offset:14336
  v_mfma_f32_16x16x32_bf16 v[72:75], v[184:187], v[120:123], v[72:75]
  ds_read_b64_tr_b16 v[182:183], v225 offset:20480
  v_mfma_f32_16x16x32_bf16 v[68:71], v[184:187], v[116:119], v[68:71]
  v_add_u32 v6, s46, v6
  v_mfma_f32_16x16x32_bf16 v[68:71], v[188:191], v[132:135], v[68:71]
  v_add_u32 v7, s46, v7
  v_mfma_f32_16x16x32_bf16 v[64:67], v[188:191], v[128:131], v[64:67]
  v_mfma_f32_16x16x32_bf16 v[64:67], v[184:187], v[112:115], v[64:67]
  s_waitcnt lgkmcnt(4)
  v_mfma_f32_16x16x32_bf16 v[80:83], v[112:115], v[192:195], v[80:83]
  ds_read_b64_tr_b16 v[184:185], v224 offset:0
  v_mfma_f32_16x16x32_bf16 v[80:83], v[128:131], v[196:199], v[80:83]
  ds_read_b64_tr_b16 v[186:187], v224 offset:6144
  v_mfma_f32_16x16x32_bf16 v[84:87], v[132:135], v[196:199], v[84:87]
  ds_read_b64_tr_b16 v[188:189], v224 offset:12288
  v_mfma_f32_16x16x32_bf16 v[84:87], v[116:119], v[192:195], v[84:87]
  ds_read_b64_tr_b16 v[190:191], v224 offset:18432
  v_mfma_f32_16x16x32_bf16 v[88:91], v[120:123], v[192:195], v[88:91]
  v_add_u32 v224, s47, v224
  v_mfma_f32_16x16x32_bf16 v[88:91], v[136:139], v[196:199], v[88:91]
  v_mfma_f32_16x16x32_bf16 v[92:95], v[140:143], v[196:199], v[92:95]
  v_mfma_f32_16x16x32_bf16 v[92:95], v[124:127], v[192:195], v[92:95]
  s_waitcnt lgkmcnt(4)
  v_mfma_f32_16x16x32_bf16 v[108:111], v[124:127], v[176:179], v[108:111]
  ds_read_b64_tr_b16 v[192:193], v225 offset:0
  v_mfma_f32_16x16x32_bf16 v[108:111], v[140:143], v[180:183], v[108:111]
  ds_read_b64_tr_b16 v[194:195], v225 offset:6144
  v_mfma_f32_16x16x32_bf16 v[104:107], v[136:139], v[180:183], v[104:107]
  ds_read_b64_tr_b16 v[196:197], v225 offset:12288
  v_mfma_f32_16x16x32_bf16 v[104:107], v[120:123], v[176:179], v[104:107]
  ds_read_b64_tr_b16 v[198:199], v225 offset:18432
  v_mfma_f32_16x16x32_bf16 v[100:103], v[116:119], v[176:179], v[100:103]
  v_add_u32 v225, s47, v225
  v_mfma_f32_16x16x32_bf16 v[100:103], v[132:135], v[180:183], v[100:103]
  s_add_u32 s44, s44, 1
  s_cmp_eq_u32 s44, 3
  v_mfma_f32_16x16x32_bf16 v[96:99], v[128:131], v[180:183], v[96:99]
  s_cselect_b32 s44, 0, s44
  s_cselect_b32 s46, s81, s80
  v_mfma_f32_16x16x32_bf16 v[96:99], v[112:115], v[176:179], v[96:99]
  s_cselect_b32 s47, s83, s82
  s_cmp_eq_u32 s48, s49
  s_waitcnt lgkmcnt(4)
  v_mfma_f32_16x16x32_bf16 v[16:19], v[184:187], v[112:115], v[16:19]
  v_mfma_f32_16x16x32_bf16 v[16:19], v[188:191], v[128:131], v[16:19]
  v_mfma_f32_16x16x32_bf16 v[20:23], v[188:191], v[132:135], v[20:23]
  s_waitcnt lgkmcnt(0)
  v_mfma_f32_16x16x32_bf16 v[20:23], v[184:187], v[116:119], v[20:23]
  s_barrier
  v_mfma_f32_16x16x32_bf16 v[24:27], v[184:187], v[120:123], v[24:27]
  s_cbranch_scc1 Lrare90
Lback91:
  ds_read_b64_tr_b16 v[176:177], v224 offset:1024
  v_mfma_f32_16x16x32_bf16 v[24:27], v[188:191], v[136:139], v[24:27]
  ds_read_b128 v[144:147], v6 offset:0
  v_mfma_f32_16x16x32_bf16 v[28:31], v[188:191], v[140:143], v[28:31]
  ds_read_b64_tr_b16 v[178:179], v224 offset:7168
  v_mfma_f32_16x16x32_bf16 v[28:31], v[184:187], v[124:127], v[28:31]
  ds_read_b128 v[160:163], v7 offset:0
  v_mfma_f32_16x16x32_bf16 v[44:47], v[192:195], v[124:127], v[44:47]
  ds_read_b64_tr_b16 v[180:181], v224 offset:13312
  v_mfma_f32_16x16x32_bf16 v[44:47], v[196:199], v[140:143], v[44:47]
  ds_read_b64_tr_b16 v[182:183], v224 offset:19456
  v_mfma_f32_16x16x32_bf16 v[40:43], v[196:199], v[136:139], v[40:43]
  ds_read_b128 v[148:151], v6 offset:2048
  v_mfma_f32_16x16x32_bf16 v[40:43], v[192:195], v[120:123], v[40:43]
  ds_read_b128 v[164:167], v7 offset:2048
  v_mfma_f32_16x16x32_bf16 v[36:39], v[192:195], v[116:119], v[36:39]
  ds_read_b64_tr_b16 v[184:185], v225 offset:1024
  v_mfma_f32_16x16x32_bf16 v[36:39], v[196:199], v[132:135], v[36:39]
  ds_read_b128 v[152:155], v6 offset:4096
  v_mfma_f32_16x16x32_bf16 v[32:35], v[196:199], v[128:131], v[32:35]
  ds_read_b64_tr_b16 v[186:187], v225 offset:7168
  v_mfma_f32_16x16x32_bf16 v[32:35], v[192:195], v[112:115], v[32:35]
  ds_read_b128 v[168:171], v7 offset:4096
  s_waitcnt lgkmcnt(6)
  v_mfma_f32_16x16x32_bf16 v[48:51], v[176:179], v[144:147], v[48:51]
  ds_read_b128 v[156:159], v6 offset:6144
  v_mfma_f32_16x16x32_bf16 v[48:51], v[180:183], v[160:163], v[48:51]
  ds_read_b64_tr_b16 v[188:189], v225 offset:13312
  s_waitcnt lgkmcnt(6)
  v_mfma_f32_16x16x32_bf16 v[52:55], v[180:183], v[164:167], v[52:55]
  ds_read_b128 v[172:175], v7 offset:6144
  v_mfma_f32_16x16x32_bf16 v[52:55], v[176:179], v[148:151], v[52:55]
  ds_read_b64_tr_b16 v[190:191], v225 offset:19456
  s_waitcnt lgkmcnt(4)
  v_mfma_f32_16x16x32_bf16 v[56:59], v[176:179], v[152:155], v[56:59]
  ds_read_b64_tr_b16 v[192:193], v224 offset:2048
  v_mfma_f32_16x16x32_bf16 v[56:59], v[180:183], v[168:171], v[56:59]
  ds_read_b64_tr_b16 v[194:195], v224 offset:8192
  s_waitcnt lgkmcnt(3)
  v_mfma_f32_16x16x32_bf16 v[60:63], v[180:183], v[172:175], v[60:63]
  ds_read_b64_tr_b16 v[196:197], v224 offset:14336
  v_mfma_f32_16x16x32_bf16 v[60:63], v[176:179], v[156:159], v[60:63]
  ds_read_b64_tr_b16 v[198:199], v224 offset:20480
  s_waitcnt lgkmcnt(4)
  v_mfma_f32_16x16x32_bf16 v[76:79], v[184:187], v[156:159], v[76:79]
  ds_read_b64_tr_b16 v[176:177], v225 offset:2048
  v_mfma_f32_16x16x32_bf16 v[76:79], v[188:191], v[172:175], v[76:79]
  ds_read_b64_tr_b16 v[178:179], v225 offset:8192
  v_mfma_f32_16x16x32_bf16 v[72:75], v[188:191], v[168:171], v[72:75]
  ds_read_b64_tr_b16 v[180:181], v225 offset:14336
  v_mfma_f32_16x16x32_bf16 v[72:75], v[184:187], v[152:155], v[72:75]
  ds_read_b64_tr_b16 v[182:183], v225 offset:20480
  v_mfma_f32_16x16x32_bf16 v[68:71], v[184:187], v[148:151], v[68:71]
  v_add_u32 v6, s46, v6
  v_mfma_f32_16x16x32_bf16 v[68:71], v[188:191], v[164:167], v[68:71]
  v_add_u32 v7, s46, v7
  v_mfma_f32_16x16x32_bf16 v[64:67], v[188:191], v[160:163], v[64:67]
  v_mfma_f32_16x16x32_bf16 v[64:67], v[184:187], v[144:147], v[64:67]
  s_waitcnt lgkmcnt(4)
  v_mfma_f32_16x16x32_bf16 v[80:83], v[144:147], v[192:195], v[80:83]
  ds_read_b64_tr_b16 v[184:185], v224 offset:0
  v_mfma_f32_16x16x32_bf16 v[80:83], v[160:163], v[196:199], v[80:83]
  ds_read_b64_tr_b16 v[186:187], v224 offset:6144
  v_mfma_f32_16x16x32_bf16 v[84:87], v[164:167], v[196:199], v[84:87]
  ds_read_b64_tr_b16 v[188:189], v224 offset:12288
  v_mfma_f32_16x16x32_bf16 v[84:87], v[148:151], v[192:195], v[84:87]
  ds_read_b64_tr_b16 v[190:191], v224 offset:18432
  v_mfma_f32_16x16x32_bf16 v[88:91], v[152:155], v[192:195], v[88:91]
  v_add_u32 v224, s47, v224
  v_mfma_f32_16x16x32_bf16 v[88:91], v[168:171], v[196:199], v[88:91]
  v_mfma_f32_16x16x32_bf16 v[92:95], v[172:175], v[196:199], v[92:95]
  v_mfma_f32_16x16x32_bf16 v[92:95], v[156:159], v[192:195], v[92:95]
  s_waitcnt lgkmcnt(4)
  v_mfma_f32_16x16x32_bf16 v[108:111], v[156:159], v[176:179], v[108:111]
  ds_read_b64_tr_b16 v[192:193], v225 offset:0
  v_mfma_f32_16x16x32_bf16 v[108:111], v[172:175], v[180:183], v[108:111]
  ds_read_b64_tr_b16 v[194:195], v225 offset:6144
  v_mfma_f32_16x16x32_bf16 v[104:107], v[168:171], v[180:183], v[104:107]
  ds_read_b64_tr_b16 v[196:197], v225 offset:12288
  v_mfma_f32_16x16x32_bf16 v[104:107], v[152:155], v[176:179], v[104:107]
  ds_read_b64_tr_b16 v[198:199], v225 offset:18432
  v_mfma_f32_16x16x32_bf16 v[100:103], v[148:151], v[176:179], v[100:103]
  v_add_u32 v225, s47, v225
  v_mfma_f32_16x16x32_bf16 v[100:103], v[164:167], v[180:183], v[100:103]
  s_add_u32 s44, s44, 1
  s_cmp_eq_u32 s44, 3
  v_mfma_f32_16x16x32_bf16 v[96:99], v[160:163], v[180:183], v[96:99]
  s_cselect_b32 s44, 0, s44
  s_cselect_b32 s46, s81, s80
  v_mfma_f32_16x16x32_bf16 v[96:99], v[144:147], v[176:179], v[96:99]
  s_cselect_b32 s47, s83, s82
  s_waitcnt lgkmcnt(4)
  v_mfma_f32_16x16x32_bf16 v[16:19], v[184:187], v[144:147], v[16:19]
  v_mfma_f32_16x16x32_bf16 v[16:19], v[188:191], v[160:163], v[16:19]
  v_mfma_f32_16x16x32_bf16 v[20:23], v[188:191], v[164:167], v[20:23]
  s_waitcnt lgkmcnt(0)
  v_mfma_f32_16x16x32_bf16 v[20:23], v[184:187], v[148:151], v[20:23]
  s_barrier
  v_mfma_f32_16x16x32_bf16 v[24:27], v[184:187], v[152:155], v[24:27]
  ds_read_b64_tr_b16 v[176:177], v224 offset:1024
  v_mfma_f32_16x16x32_bf16 v[24:27], v[188:191], v[168:171], v[24:27]
  ds_read_b128 v[112:115], v6 offset:0
  v_mfma_f32_16x16x32_bf16 v[28:31], v[188:191], v[172:175], v[28:31]
  ds_read_b64_tr_b16 v[178:179], v224 offset:7168
  v_mfma_f32_16x16x32_bf16 v[28:31], v[184:187], v[156:159], v[28:31]
  ds_read_b128 v[128:131], v7 offset:0
  v_mfma_f32_16x16x32_bf16 v[44:47], v[192:195], v[156:159], v[44:47]
  ds_read_b64_tr_b16 v[180:181], v224 offset:13312
  s_add_u32 s48, s48, 2
  v_mfma_f32_16x16x32_bf16 v[44:47], v[196:199], v[172:175], v[44:47]
  ds_read_b64_tr_b16 v[182:183], v224 offset:19456
  v_mfma_f32_16x16x32_bf16 v[40:43], v[196:199], v[168:171], v[40:43]
  ds_read_b128 v[116:119], v6 offset:2048
  s_cmp_lt_u32 s48, 14
  v_mfma_f32_16x16x32_bf16 v[40:43], v[192:195], v[152:155], v[40:43]
  ds_read_b128 v[132:135], v7 offset:2048
  v_mfma_f32_16x16x32_bf16 v[36:39], v[192:195], v[148:151], v[36:39]
  ds_read_b64_tr_b16 v[184:185], v225 offset:1024
  v_mfma_f32_16x16x32_bf16 v[36:39], v[196:199], v[164:167], v[36:39]
  ds_read_b128 v[120:123], v6 offset:4096
  v_mfma_f32_16x16x32_bf16 v[32:35], v[196:199], v[160:163], v[32:35]
  ds_read_b64_tr_b16 v[186:187], v225 offset:7168
  v_mfma_f32_16x16x32_bf16 v[32:35], v[192:195], v[144:147], v[32:35]
  ds_read_b128 v[136:139], v7 offset:4096
  s_cbranch_scc1 Lg89
  s_waitcnt lgkmcnt(6)
  v_mfma_f32_16x16x32_bf16 v[48:51], v[176:179], v[112:115], v[48:51]
  ds_read_b128 v[124:127], v6 offset:6144
  v_mfma_f32_16x16x32_bf16 v[48:51], v[180:183], v[128:131], v[48:51]
  ds_read_b64_tr_b16 v[188:189], v225 offset:13312
  s_waitcnt lgkmcnt(6)
  v_mfma_f32_16x16x32_bf16 v[52:55], v[180:183], v[132:135], v[52:55]
  ds_read_b128 v[140:143], v7 offset:6144
  v_mfma_f32_16x16x32_bf16 v[52:55], v[176:179], v[116:119], v[52:55]
  ds_read_b64_tr_b16 v[190:191], v225 offset:19456
  s_waitcnt lgkmcnt(4)
  v_mfma_f32_16x16x32_bf16 v[56:59], v[176:179], v[120:123], v[56:59]
  ds_read_b64_tr_b16 v[192:193], v224 offset:2048
  v_mfma_f32_16x16x32_bf16 v[56:59], v[180:183], v[136:139], v[56:59]
  ds_read_b64_tr_b16 v[194:195], v224 offset:8192
  s_waitcnt lgkmcnt(3)
  v_mfma_f32_16x16x32_bf16 v[60:63], v[180:183], v[140:143], v[60:63]
  ds_read_b64_tr_b16 v[196:197], v224 offset:14336
  v_mfma_f32_16x16x32_bf16 v[60:63], v[176:179], v[124:127], v[60:63]
  ds_read_b64_tr_b16 v[198:199], v224 offset:20480
  s_waitcnt lgkmcnt(4)
  v_mfma_f32_16x16x32_bf16 v[76:79], v[184:187], v[124:127], v[76:79]
  ds_read_b64_tr_b16 v[176:177], v225 offset:2048
  v_mfma_f32_16x16x32_bf16 v[76:79], v[188:191], v[140:143], v[76:79]
  ds_read_b64_tr_b16 v[178:179], v225 offset:8192
  v_mfma_f32_16x16x32_bf16 v[72:75], v[188:191], v[136:139], v[72:75]
  ds_read_b64_tr_b16 v[180:181], v225 offset:14336
  v_mfma_f32_16x16x32_bf16 v[72:75], v[184:187], v[120:123], v[72:75]
  ds_read_b64_tr_b16 v[182:183], v225 offset:20480
  v_mfma_f32_16x16x32_bf16 v[68:71], v[184:187], v[116:119], v[68:71]
  v_add_u32 v6, s46, v6
  v_mfma_f32_16x16x32_bf16 v[68:71], v[188:191], v[132:135], v[68:71]
  v_add_u32 v7, s46, v7
  v_mfma_f32_16x16x32_bf16 v[64:67], v[188:191], v[128:131], v[64:67]
  v_mfma_f32_16x16x32_bf16 v[64:67], v[184:187], v[112:115], v[64:67]
  s_waitcnt lgkmcnt(4)
  v_mfma_f32_16x16x32_bf16 v[80:83], v[112:115], v[192:195], v[80:83]
  ds_read_b64_tr_b16 v[184:185], v224 offset:0
  v_mfma_f32_16x16x32_bf16 v[80:83], v[128:131], v[196:199], v[80:83]
  ds_read_b64_tr_b16 v[186:187], v224 offset:6144
  v_mfma_f32_16x16x32_bf16 v[84:87], v[132:135], v[196:199], v[84:87]
  ds_read_b64_tr_b16 v[188:189], v224 offset:12288
  v_mfma_f32_16x16x32_bf16 v[84:87], v[116:119], v[192:195], v[84:87]
  ds_read_b64_tr_b16 v[190:191], v224 offset:18432
  v_mfma_f32_16x16x32_bf16 v[88:91], v[120:123], v[192:195], v[88:91]
  v_mfma_f32_16x16x32_bf16 v[88:91], v[136:139], v[196:199], v[88:91]
  v_mfma_f32_16x16x32_bf16 v[92:95], v[140:143], v[196:199], v[92:95]
  v_mfma_f32_16x16x32_bf16 v[92:95], v[124:127], v[192:195], v[92:95]
  s_waitcnt lgkmcnt(4)
  v_mfma_f32_16x16x32_bf16 v[108:111], v[124:127], v[176:179], v[108:111]
  ds_read_b64_tr_b16 v[192:193], v225 offset:0
  v_mfma_f32_16x16x32_bf16 v[108:111], v[140:143], v[180:183], v[108:111]
  ds_read_b64_tr_b16 v[194:195], v225 offset:6144
  v_mfma_f32_16x16x32_bf16 v[104:107], v[136:139], v[180:183], v[104:107]
  ds_read_b64_tr_b16 v[196:197], v225 offset:12288
  v_mfma_f32_16x16x32_bf16 v[104:107], v[120:123], v[176:179], v[104:107]
  ds_read_b64_tr_b16 v[198:199], v225 offset:18432
  v_mfma_f32_16x16x32_bf16 v[100:103], v[116:119], v[176:179], v[100:103]
  v_mfma_f32_16x16x32_bf16 v[100:103], v[132:135], v[180:183], v[100:103]
  v_mfma_f32_16x16x32_bf16 v[96:99], v[128:131], v[180:183], v[96:99]
  v_mfma_f32_16x16x32_bf16 v[96:99], v[112:115], v[176:179], v[96:99]
  s_waitcnt lgkmcnt(4)
  v_mfma_f32_16x16x32_bf16 v[16:19], v[184:187], v[112:115], v[16:19]
  v_mfma_f32_16x16x32_bf16 v[16:19], v[188:191], v[128:131], v[16:19]
  v_mfma_f32_16x16x32_bf16 v[20:23], v[188:191], v[132:135], v[20:23]
  s_waitcnt lgkmcnt(0)
  v_mfma_f32_16x16x32_bf16 v[20:23], v[184:187], v[116:119], v[20:23]
  s_barrier
  v_mfma_f32_16x16x32_bf16 v[24:27], v[184:187], v[120:123], v[24:27]
  ds_read_b64 v[4:5], v8
  ds_read2_b32 v[144:145], v14 offset0:0 offset1:128
  ds_read2_b32 v[146:147], v14 offset0:16 offset1:144
  v_mfma_f32_16x16x32_bf16 v[24:27], v[188:191], v[136:139], v[24:27]
  ds_read2_b32 v[148:149], v14 offset0:32 offset1:160
  ds_read2_b32 v[150:151], v14 offset0:48 offset1:176
  ds_read_b128 v[164:167], v12 offset:1280
  v_mfma_f32_16x16x32_bf16 v[28:31], v[188:191], v[140:143], v[28:31]
  ds_read_b128 v[168:171], v12 offset:1344
  ds_read2_b32 v[152:153], v11 offset0:0 offset1:16
  ds_read_b128 v[200:203], v15 offset:0
  v_mfma_f32_16x16x32_bf16 v[28:31], v[184:187], v[124:127], v[28:31]
  ds_read_b128 v[216:219], v15 offset:512
  ds_read_b128 v[204:207], v15 offset:64
  ds_read_b128 v[220:223], v15 offset:576
  v_mfma_f32_16x16x32_bf16 v[44:47], v[192:195], v[124:127], v[44:47]
  ds_read_b128 v[208:211], v15 offset:128
  ds_read_b128 v[224:227], v15 offset:640
  ds_read_b128 v[212:215], v15 offset:192
  v_mfma_f32_16x16x32_bf16 v[44:47], v[196:199], v[140:143], v[44:47]
  ds_read_b128 v[228:231], v15 offset:704
  ds_read_b128 v[156:159], v12 offset:1024
  ds_read_b128 v[160:163], v12 offset:1088
  v_mfma_f32_16x16x32_bf16 v[40:43], v[196:199], v[136:139], v[40:43]
  v_mfma_f32_16x16x32_bf16 v[40:43], v[192:195], v[120:123], v[40:43]
  s_waitcnt lgkmcnt(11)
  v_readfirstlane_b32 s72, v4
  v_readfirstlane_b32 s71, v5
  v_pk_fma_f32 v[48:49], v[164:165], v[144:145], v[48:49] op_sel_hi:[1,0,1]
  v_pk_fma_f32 v[50:51], v[166:167], v[144:145], v[50:51] op_sel_hi:[1,0,1]
  v_pk_fma_f32 v[64:65], v[168:169], v[144:145], v[64:65] op_sel_hi:[1,0,1]
  v_pk_fma_f32 v[66:67], v[170:171], v[144:145], v[66:67] op_sel_hi:[1,0,1]
  v_pk_mul_f32 v[48:49], v[48:49], v[144:145] op_sel:[0,1] op_sel_hi:[1,1]
  v_pk_mul_f32 v[50:51], v[50:51], v[144:145] op_sel:[0,1] op_sel_hi:[1,1]
  v_pk_mul_f32 v[64:65], v[64:65], v[144:145] op_sel:[0,1] op_sel_hi:[1,1]
  v_pk_mul_f32 v[66:67], v[66:67], v[144:145] op_sel:[0,1] op_sel_hi:[1,1]
  v_cvt_pk_bf16_f32 v48, v48, v49
  v_cvt_pk_bf16_f32 v49, v50, v51
  v_cvt_pk_bf16_f32 v50, v64, v65
  v_cvt_pk_bf16_f32 v51, v66, v67
  s_add_u32 s40, s40, s72
  s_add_u32 s41, s41, s72
  s_add_u32 s42, s42, s72
  s_add_u32 s43, s43, s72
  buffer_store_dwordx4 v[48:51], v13, s[28:31], s40 offen offset:0 sc1
  v_pk_fma_f32 v[52:53], v[164:165], v[146:147], v[52:53] op_sel_hi:[1,0,1]
  v_pk_fma_f32 v[54:55], v[166:167], v[146:147], v[54:55] op_sel_hi:[1,0,1]
  v_pk_fma_f32 v[68:69], v[168:169], v[146:147], v[68:69] op_sel_hi:[1,0,1]
  v_pk_fma_f32 v[70:71], v[170:171], v[146:147], v[70:71] op_sel_hi:[1,0,1]
  v_pk_mul_f32 v[52:53], v[52:53], v[146:147] op_sel:[0,1] op_sel_hi:[1,1]
  v_pk_mul_f32 v[54:55], v[54:55], v[146:147] op_sel:[0,1] op_sel_hi:[1,1]
  v_pk_mul_f32 v[68:69], v[68:69], v[146:147] op_sel:[0,1] op_sel_hi:[1,1]
  v_pk_mul_f32 v[70:71], v[70:71], v[146:147] op_sel:[0,1] op_sel_hi:[1,1]
  v_cvt_pk_bf16_f32 v52, v52, v53
  v_cvt_pk_bf16_f32 v53, v54, v55
  v_cvt_pk_bf16_f32 v54, v68, v69
  v_cvt_pk_bf16_f32 v55, v70, v71
  buffer_store_dwordx4 v[52:55], v13, s[28:31], s40 offen offset:1024 sc1
  v_pk_fma_f32 v[56:57], v[164:165], v[148:149], v[56:57] op_sel_hi:[1,0,1]
  v_pk_fma_f32 v[58:59], v[166:167], v[148:149], v[58:59] op_sel_hi:[1,0,1]
  v_pk_fma_f32 v[72:73], v[168:169], v[148:149], v[72:73] op_sel_hi:[1,0,1]
  v_pk_fma_f32 v[74:75], v[170:171], v[148:149], v[74:75] op_sel_hi:[1,0,1]
  v_pk_mul_f32 v[56:57], v[56:57], v[148:149] op_sel:[0,1] op_sel_hi:[1,1]
  v_pk_mul_f32 v[58:59], v[58:59], v[148:149] op_sel:[0,1] op_sel_hi:[1,1]
  v_pk_mul_f32 v[72:73], v[72:73], v[148:149] op_sel:[0,1] op_sel_hi:[1,1]
  v_pk_mul_f32 v[74:75], v[74:75], v[148:149] op_sel:[0,1] op_sel_hi:[1,1]
  v_cvt_pk_bf16_f32 v56, v56, v57
  v_cvt_pk_bf16_f32 v57, v58, v59
  v_cvt_pk_bf16_f32 v58, v72, v73
  v_cvt_pk_bf16_f32 v59, v74, v75
  buffer_store_dwordx4 v[56:59], v13, s[28:31], s41 offen offset:0 sc1
  v_pk_fma_f32 v[60:61], v[164:165], v[150:151], v[60:61] op_sel_hi:[1,0,1]
  v_pk_fma_f32 v[62:63], v[166:167], v[150:151], v[62:63] op_sel_hi:[1,0,1]
  v_pk_fma_f32 v[76:77], v[168:169], v[150:151], v[76:77] op_sel_hi:[1,0,1]
  v_pk_fma_f32 v[78:79], v[170:171], v[150:151], v[78:79] op_sel_hi:[1,0,1]
  v_pk_mul_f32 v[60:61], v[60:61], v[150:151] op_sel:[0,1] op_sel_hi:[1,1]
  v_pk_mul_f32 v[62:63], v[62:63], v[150:151] op_sel:[0,1] op_sel_hi:[1,1]
  v_pk_mul_f32 v[76:77], v[76:77], v[150:151] op_sel:[0,1] op_sel_hi:[1,1]
  v_pk_mul_f32 v[78:79], v[78:79], v[150:151] op_sel:[0,1] op_sel_hi:[1,1]
  v_cvt_pk_bf16_f32 v60, v60, v61
  v_cvt_pk_bf16_f32 v61, v62, v63
  v_cvt_pk_bf16_f32 v62, v76, v77
  v_cvt_pk_bf16_f32 v63, v78, v79
  buffer_store_dwordx4 v[60:63], v13, s[28:31], s41 offen offset:1024 sc1
  s_waitcnt lgkmcnt(0)
  v_pk_fma_f32 v[80:81], v[200:201], v[152:153], v[80:81] op_sel_hi:[1,0,1]
  v_pk_fma_f32 v[82:83], v[202:203], v[152:153], v[82:83] op_sel_hi:[1,0,1]
  v_pk_fma_f32 v[84:85], v[204:205], v[152:153], v[84:85] op_sel_hi:[1,0,1]
  v_pk_fma_f32 v[86:87], v[206:207], v[152:153], v[86:87] op_sel_hi:[1,0,1]
  v_pk_mul_f32 v[80:81], v[80:81], v[216:217]
  v_pk_mul_f32 v[82:83], v[82:83], v[218:219]
  v_pk_mul_f32 v[84:85], v[84:85], v[220:221]
  v_pk_mul_f32 v[86:87], v[86:87], v[222:223]
  v_cvt_pk_bf16_f32 v80, v80, v81
  v_cvt_pk_bf16_f32 v81, v82, v83
  v_cvt_pk_bf16_f32 v82, v84, v85
  v_cvt_pk_bf16_f32 v83, v86, v87
  buffer_store_dwordx4 v[80:83], v13, s[28:31], s42 offen offset:0 sc1
  v_pk_fma_f32 v[96:97], v[200:201], v[152:153], v[96:97] op_sel:[0,1,0] op_sel_hi:[1,1,1]
  v_pk_fma_f32 v[98:99], v[202:203], v[152:153], v[98:99] op_sel:[0,1,0] op_sel_hi:[1,1,1]
  v_pk_fma_f32 v[100:101], v[204:205], v[152:153], v[100:101] op_sel:[0,1,0] op_sel_hi:[1,1,1]
  v_pk_fma_f32 v[102:103], v[206:207], v[152:153], v[102:103] op_sel:[0,1,0] op_sel_hi:[1,1,1]
  v_pk_mul_f32 v[96:97], v[96:97], v[216:217]
  v_pk_mul_f32 v[98:99], v[98:99], v[218:219]
  v_pk_mul_f32 v[100:101], v[100:101], v[220:221]
  v_pk_mul_f32 v[102:103], v[102:103], v[222:223]
  v_cvt_pk_bf16_f32 v96, v96, v97
  v_cvt_pk_bf16_f32 v97, v98, v99
  v_cvt_pk_bf16_f32 v98, v100, v101
  v_cvt_pk_bf16_f32 v99, v102, v103
  buffer_store_dwordx4 v[96:99], v13, s[28:31], s42 offen offset:1024 sc1
  v_pk_fma_f32 v[88:89], v[208:209], v[152:153], v[88:89] op_sel_hi:[1,0,1]
  v_pk_fma_f32 v[90:91], v[210:211], v[152:153], v[90:91] op_sel_hi:[1,0,1]
  v_pk_fma_f32 v[92:93], v[212:213], v[152:153], v[92:93] op_sel_hi:[1,0,1]
  v_pk_fma_f32 v[94:95], v[214:215], v[152:153], v[94:95] op_sel_hi:[1,0,1]
  v_pk_mul_f32 v[88:89], v[88:89], v[224:225]
  v_pk_mul_f32 v[90:91], v[90:91], v[226:227]
  v_pk_mul_f32 v[92:93], v[92:93], v[228:229]
  v_pk_mul_f32 v[94:95], v[94:95], v[230:231]
  v_cvt_pk_bf16_f32 v88, v88, v89
  v_cvt_pk_bf16_f32 v89, v90, v91
  v_cvt_pk_bf16_f32 v90, v92, v93
  v_cvt_pk_bf16_f32 v91, v94, v95
  buffer_store_dwordx4 v[88:91], v13, s[28:31], s43 offen offset:0 sc1
  v_pk_fma_f32 v[104:105], v[208:209], v[152:153], v[104:105] op_sel:[0,1,0] op_sel_hi:[1,1,1]
  v_pk_fma_f32 v[106:107], v[210:211], v[152:153], v[106:107] op_sel:[0,1,0] op_sel_hi:[1,1,1]
  v_pk_fma_f32 v[108:109], v[212:213], v[152:153], v[108:109] op_sel:[0,1,0] op_sel_hi:[1,1,1]
  v_pk_fma_f32 v[110:111], v[214:215], v[152:153], v[110:111] op_sel:[0,1,0] op_sel_hi:[1,1,1]
  v_pk_mul_f32 v[104:105], v[104:105], v[224:225]
  v_pk_mul_f32 v[106:107], v[106:107], v[226:227]
  v_pk_mul_f32 v[108:109], v[108:109], v[228:229]
  v_pk_mul_f32 v[110:111], v[110:111], v[230:231]
  v_cvt_pk_bf16_f32 v104, v104, v105
  v_cvt_pk_bf16_f32 v105, v106, v107
  v_cvt_pk_bf16_f32 v106, v108, v109
  v_cvt_pk_bf16_f32 v107, v110, v111
  buffer_store_dwordx4 v[104:107], v13, s[28:31], s43 offen offset:1024 sc1
  v_mfma_f32_16x16x32_bf16 v[36:39], v[192:195], v[116:119], v[36:39]
  ds_write_b128 v2, v[48:51] offset:0
  ds_write_b128 v2, v[52:55] offset:1024
  v_mfma_f32_16x16x32_bf16 v[36:39], v[196:199], v[132:135], v[36:39]
  ds_write_b128 v3, v[56:59] offset:0
  ds_write_b128 v3, v[60:63] offset:1024
  v_mfma_f32_16x16x32_bf16 v[32:35], v[196:199], v[128:131], v[32:35]
  ds_write_b128 v2, v[80:83] offset:49152
  ds_write_b128 v2, v[96:99] offset:50176
  v_mfma_f32_16x16x32_bf16 v[32:35], v[192:195], v[112:115], v[32:35]
  ds_write_b128 v3, v[88:91] offset:49152
  ds_write_b128 v3, v[104:107] offset:50176
  v_lshrrev_b32 v10, 4, v1
  v_and_b32 v11, 15, v1
  v_lshlrev_b32 v10, 2, v10
  v_sub_u32 v10, v11, v10
  s_mul_i32 s39, s37, 24576
  v_lshl_add_u32 v3, v1, 4, s39
  v_add_u32 v4, 49152, v3
  v_mov_b32 v12, 0xf149f2ca
  s_mov_b64 s[68:69], -1
  v_cmp_le_i32 s[50:51], 0, v10
  v_cmp_le_i32 s[52:53], 1, v10
  v_cmp_le_i32 s[54:55], 2, v10
  v_cmp_le_i32 s[56:57], 3, v10
  v_mov_b32 v216, 0x3f803f80
  v_mov_b32 v217, 0x3f803f80
  v_mov_b32 v218, 0x3f803f80
  v_mov_b32 v219, 0x3f803f80
  v_cndmask_b32 v200, 0, v12, s[50:51]
  v_cndmask_b32 v204, v12, 0, s[50:51]
  v_cndmask_b32 v201, 0, v12, s[52:53]
  v_cndmask_b32 v205, v12, 0, s[52:53]
  v_cndmask_b32 v202, 0, v12, s[54:55]
  v_cndmask_b32 v206, v12, 0, s[54:55]
  v_cndmask_b32 v203, 0, v12, s[56:57]
  v_cndmask_b32 v207, v12, 0, s[56:57]
  v_mul_f32 v145, 0x3e8293ee, v145
  v_mul_f32 v147, 0x3e8293ee, v147
  v_mul_f32 v149, 0x3e8293ee, v149
  v_mul_f32 v151, 0x3e8293ee, v151
  v_pk_fma_f32 v[28:29], v[156:157], v[150:151], v[28:29] op_sel_hi:[1,0,1]
  v_pk_fma_f32 v[30:31], v[158:159], v[150:151], v[30:31] op_sel_hi:[1,0,1]
  v_pk_fma_f32 v[44:45], v[160:161], v[150:151], v[44:45] op_sel_hi:[1,0,1]
  v_pk_fma_f32 v[46:47], v[162:163], v[150:151], v[46:47] op_sel_hi:[1,0,1]
  v_pk_mul_f32 v[28:29], v[28:29], v[150:151] op_sel:[0,1] op_sel_hi:[1,1]
  v_pk_mul_f32 v[30:31], v[30:31], v[150:151] op_sel:[0,1] op_sel_hi:[1,1]
  v_pk_mul_f32 v[44:45], v[44:45], v[150:151] op_sel:[0,1] op_sel_hi:[1,1]
  v_pk_mul_f32 v[46:47], v[46:47], v[150:151] op_sel:[0,1] op_sel_hi:[1,1]
  v_cvt_pk_bf16_f32 v28, v28, v29
  v_cvt_pk_bf16_f32 v29, v30, v31
  v_cvt_pk_bf16_f32 v30, v44, v45
  v_cvt_pk_bf16_f32 v31, v46, v47
  v_pk_fma_f32 v[24:25], v[156:157], v[148:149], v[24:25] op_sel_hi:[1,0,1]
  v_pk_fma_f32 v[26:27], v[158:159], v[148:149], v[26:27] op_sel_hi:[1,0,1]
  v_pk_fma_f32 v[40:41], v[160:161], v[148:149], v[40:41] op_sel_hi:[1,0,1]
  v_pk_fma_f32 v[42:43], v[162:163], v[148:149], v[42:43] op_sel_hi:[1,0,1]
  v_pk_mul_f32 v[24:25], v[24:25], v[148:149] op_sel:[0,1] op_sel_hi:[1,1]
  v_pk_mul_f32 v[26:27], v[26:27], v[148:149] op_sel:[0,1] op_sel_hi:[1,1]
  v_pk_mul_f32 v[40:41], v[40:41], v[148:149] op_sel:[0,1] op_sel_hi:[1,1]
  v_pk_mul_f32 v[42:43], v[42:43], v[148:149] op_sel:[0,1] op_sel_hi:[1,1]
  v_cvt_pk_bf16_f32 v24, v24, v25
  v_cvt_pk_bf16_f32 v25, v26, v27
  v_cvt_pk_bf16_f32 v26, v40, v41
  v_cvt_pk_bf16_f32 v27, v42, v43
  v_pk_fma_f32 v[20:21], v[156:157], v[146:147], v[20:21] op_sel_hi:[1,0,1]
  v_pk_fma_f32 v[22:23], v[158:159], v[146:147], v[22:23] op_sel_hi:[1,0,1]
  v_pk_fma_f32 v[36:37], v[160:161], v[146:147], v[36:37] op_sel_hi:[1,0,1]
  v_pk_fma_f32 v[38:39], v[162:163], v[146:147], v[38:39] op_sel_hi:[1,0,1]
  v_pk_mul_f32 v[20:21], v[20:21], v[146:147] op_sel:[0,1] op_sel_hi:[1,1]
  v_pk_mul_f32 v[22:23], v[22:23], v[146:147] op_sel:[0,1] op_sel_hi:[1,1]
  v_pk_mul_f32 v[36:37], v[36:37], v[146:147] op_sel:[0,1] op_sel_hi:[1,1]
  v_pk_mul_f32 v[38:39], v[38:39], v[146:147] op_sel:[0,1] op_sel_hi:[1,1]
  v_cvt_pk_bf16_f32 v20, v20, v21
  v_cvt_pk_bf16_f32 v21, v22, v23
  v_cvt_pk_bf16_f32 v22, v36, v37
  v_cvt_pk_bf16_f32 v23, v38, v39
  v_pk_fma_f32 v[16:17], v[156:157], v[144:145], v[16:17] op_sel_hi:[1,0,1]
  v_pk_fma_f32 v[18:19], v[158:159], v[144:145], v[18:19] op_sel_hi:[1,0,1]
  v_pk_fma_f32 v[32:33], v[160:161], v[144:145], v[32:33] op_sel_hi:[1,0,1]
  v_pk_fma_f32 v[34:35], v[162:163], v[144:145], v[34:35] op_sel_hi:[1,0,1]
  v_pk_mul_f32 v[16:17], v[16:17], v[144:145] op_sel:[0,1] op_sel_hi:[1,1]
  v_pk_mul_f32 v[18:19], v[18:19], v[144:145] op_sel:[0,1] op_sel_hi:[1,1]
  v_pk_mul_f32 v[32:33], v[32:33], v[144:145] op_sel:[0,1] op_sel_hi:[1,1]
  v_pk_mul_f32 v[34:35], v[34:35], v[144:145] op_sel:[0,1] op_sel_hi:[1,1]
  v_cvt_pk_bf16_f32 v16, v16, v17
  v_cvt_pk_bf16_f32 v17, v18, v19
  v_cvt_pk_bf16_f32 v18, v32, v33
  v_cvt_pk_bf16_f32 v19, v34, v35
  s_waitcnt lgkmcnt(0)
  s_barrier
  s_cmp_lg_u32 s36, 0
  s_cbranch_scc1 Lw93
  ds_read_b128 v[48:51], v3 offset:22528
  ds_read_b128 v[52:55], v3 offset:23552
  ds_read_b128 v[64:67], v4 offset:22528
  ds_read_b128 v[68:71], v4 offset:23552
  s_waitcnt lgkmcnt(2)
  v_mfma_f32_16x16x32_bf16 v[32:35], v[48:51], v[24:27], v[204:207]
  ds_read_b128 v[56:59], v3 offset:20480
  ds_read_b128 v[60:63], v3 offset:21504
  s_nop 6
  v_mfma_f32_16x16x32_bf16 v[40:43], v[48:51], v[28:31], 0
  v_exp_f32 v32, v32
  v_mfma_f32_16x16x32_bf16 v[44:47], v[52:55], v[28:31], v[204:207]
  v_exp_f32 v33, v33
  v_exp_f32 v34, v34
  v_exp_f32 v35, v35
  v_mov_b32 v210, 0
  v_mov_b32 v211, 0
  v_cvt_pk_bf16_f32 v208, v32, v33
  v_cvt_pk_bf16_f32 v209, v34, v35
  ds_read_b128 v[72:75], v4 offset:20480
  ds_read_b128 v[76:79], v4 offset:21504
  s_waitcnt lgkmcnt(2)
  v_mfma_f32_16x16x32_bf16 v[32:35], v[56:59], v[24:27], 0
  v_exp_f32 v40, v40
  v_mfma_f32_16x16x32_bf16 v[36:39], v[60:63], v[24:27], 0
  v_exp_f32 v41, v41
  v_mfma_f32_16x16x32_bf16 v[136:139], v[64:67], v[208:211], 0
  v_exp_f32 v42, v42
  v_mfma_f32_16x16x32_bf16 v[140:143], v[68:71], v[208:211], 0
  v_exp_f32 v43, v43
  v_mfma_f32_16x16x32_bf16 v[144:147], v[216:219], v[208:211], 0
  v_exp_f32 v44, v44
  v_cvt_pk_bf16_f32 v212, v40, v41
  v_exp_f32 v45, v45
  v_exp_f32 v46, v46
  v_cvt_pk_bf16_f32 v213, v42, v43
  v_exp_f32 v47, v47
  v_cvt_pk_bf16_f32 v214, v44, v45
  v_cvt_pk_bf16_f32 v215, v46, v47
  ds_read_b128 v[48:51], v3 offset:18432
  ds_read_b128 v[52:55], v3 offset:19456
  v_mfma_f32_16x16x32_bf16 v[40:43], v[56:59], v[28:31], 0
  v_exp_f32 v32, v32
  v_mfma_f32_16x16x32_bf16 v[44:47], v[60:63], v[28:31], 0
  v_exp_f32 v33, v33
  v_mfma_f32_16x16x32_bf16 v[148:151], v[64:67], v[212:215], 0
  v_exp_f32 v34, v34
  v_mfma_f32_16x16x32_bf16 v[152:155], v[68:71], v[212:215], 0
  v_exp_f32 v35, v35
  v_mfma_f32_16x16x32_bf16 v[156:159], v[216:219], v[212:215], 0
  v_exp_f32 v36, v36
  v_cvt_pk_bf16_f32 v208, v32, v33
  v_exp_f32 v37, v37
  v_exp_f32 v38, v38
  v_cvt_pk_bf16_f32 v209, v34, v35
  v_exp_f32 v39, v39
  v_cvt_pk_bf16_f32 v210, v36, v37
  v_cvt_pk_bf16_f32 v211, v38, v39
  ds_read_b128 v[64:67], v4 offset:18432
  ds_read_b128 v[68:71], v4 offset:19456
  s_waitcnt vmcnt(0)
  s_barrier
  s_cmp_lg_u32 s22, 0
  s_cbranch_scc1 Lq96
  s_lshl_b32 s39, s24, 18
  s_lshl_b32 s40, s36, 17
  s_add_u32 s39, s39, s40
  s_lshl_b32 s40, s25, 7
  s_add_u32 s39, s39, s40
  s_lshl_b32 s40, s37, 6
  s_add_u32 s40, s39, s40
  s_add_u32 s41, s40, 32768
  s_add_u32 s42, s40, 65536
  s_add_u32 s43, s40, 98304
  v_and_b32 v8, 15, v1
  v_lshlrev_b32 v8, 11, v8
  v_bfe_u32 v9, v1, 4, 1
  v_lshl_add_u32 v8, v9, 5, v8
  v_lshrrev_b32 v9, 5, v1
  v_lshl_add_u32 v8, v9, 4, v8
  buffer_load_dwordx4 v[232:235], v8, s[64:67], s40 offen
  buffer_load_dwordx4 v[236:239], v8, s[64:67], s41 offen
  buffer_load_dwordx4 v[240:243], v8, s[64:67], s42 offen
  buffer_load_dwordx4 v[244:247], v8, s[64:67], s43 offen
Lq96:
  s_waitcnt lgkmcnt(2)
  v_mfma_f32_16x16x32_bf16 v[32:35], v[48:51], v[24:27], 0
  v_exp_f32 v40, v40
  v_mfma_f32_16x16x32_bf16 v[36:39], v[52:55], v[24:27], 0
  v_exp_f32 v41, v41
  v_mfma_f32_16x16x32_bf16 v[136:139], v[72:75], v[208:211], v[136:139]
  v_exp_f32 v42, v42
  v_mfma_f32_16x16x32_bf16 v[140:143], v[76:79], v[208:211], v[140:143]
  v_exp_f32 v43, v43
  v_mfma_f32_16x16x32_bf16 v[144:147], v[216:219], v[208:211], v[144:147]
  v_exp_f32 v44, v44
  v_cvt_pk_bf16_f32 v212, v40, v41
  v_exp_f32 v45, v45
  v_exp_f32 v46, v46
  v_cvt_pk_bf16_f32 v213, v42, v43
  v_exp_f32 v47, v47
  v_cvt_pk_bf16_f32 v214, v44, v45
  v_cvt_pk_bf16_f32 v215, v46, v47
  ds_read_b128 v[56:59], v3 offset:16384
  ds_read_b128 v[60:63], v3 offset:17408
  v_mfma_f32_16x16x32_bf16 v[40:43], v[48:51], v[28:31], 0
  v_exp_f32 v32, v32
  v_mfma_f32_16x16x32_bf16 v[44:47], v[52:55], v[28:31], 0
  v_exp_f32 v33, v33
  v_mfma_f32_16x16x32_bf16 v[148:151], v[72:75], v[212:215], v[148:151]
  v_exp_f32 v34, v34
  v_mfma_f32_16x16x32_bf16 v[152:155], v[76:79], v[212:215], v[152:155]
  v_exp_f32 v35, v35
  v_mfma_f32_16x16x32_bf16 v[156:159], v[216:219], v[212:215], v[156:159]
  v_exp_f32 v36, v36
  v_cvt_pk_bf16_f32 v208, v32, v33
  v_exp_f32 v37, v37
  v_exp_f32 v38, v38
  v_cvt_pk_bf16_f32 v209, v34, v35
  v_exp_f32 v39, v39
  v_cvt_pk_bf16_f32 v210, v36, v37
  v_cvt_pk_bf16_f32 v211, v38, v39
  ds_read_b128 v[72:75], v4 offset:16384
  ds_read_b128 v[76:79], v4 offset:17408
  s_waitcnt lgkmcnt(2)
  v_exp_f32 v40, v40
  v_mfma_f32_16x16x32_bf16 v[32:35], v[56:59], v[16:19], v[204:207]
  v_exp_f32 v41, v41
  v_mfma_f32_16x16x32_bf16 v[136:139], v[64:67], v[208:211], v[136:139]
  v_exp_f32 v42, v42
  v_mfma_f32_16x16x32_bf16 v[140:143], v[68:71], v[208:211], v[140:143]
  v_exp_f32 v43, v43
  v_mfma_f32_16x16x32_bf16 v[144:147], v[216:219], v[208:211], v[144:147]
  v_exp_f32 v44, v44
  v_exp_f32 v45, v45
  v_exp_f32 v46, v46
  v_exp_f32 v47, v47
  v_cvt_pk_bf16_f32 v212, v40, v41
  v_cvt_pk_bf16_f32 v213, v42, v43
  v_cvt_pk_bf16_f32 v214, v44, v45
  v_cvt_pk_bf16_f32 v215, v46, v47
  v_mfma_f32_16x16x32_bf16 v[40:43], v[56:59], v[20:23], 0
  v_exp_f32 v32, v32
  v_mfma_f32_16x16x32_bf16 v[44:47], v[60:63], v[20:23], v[204:207]
  v_exp_f32 v33, v33
  v_mfma_f32_16x16x32_bf16 v[148:151], v[64:67], v[212:215], v[148:151]
  v_exp_f32 v34, v34
  v_mfma_f32_16x16x32_bf16 v[152:155], v[68:71], v[212:215], v[152:155]
  v_exp_f32 v35, v35
  v_mfma_f32_16x16x32_bf16 v[156:159], v[216:219], v[212:215], v[156:159]
  v_mov_b32 v210, 0
  v_mov_b32 v211, 0
  v_cvt_pk_bf16_f32 v208, v32, v33
  v_cvt_pk_bf16_f32 v209, v34, v35
  s_waitcnt lgkmcnt(0)
  v_mfma_f32_16x16x32_bf16 v[32:35], v[56:59], v[24:27], 0
  v_exp_f32 v40, v40
  v_mfma_f32_16x16x32_bf16 v[36:39], v[60:63], v[24:27], 0
  v_exp_f32 v41, v41
  v_mfma_f32_16x16x32_bf16 v[112:115], v[72:75], v[208:211], 0
  v_exp_f32 v42, v42
  v_mfma_f32_16x16x32_bf16 v[116:119], v[76:79], v[208:211], 0
  v_exp_f32 v43, v43
  v_mfma_f32_16x16x32_bf16 v[120:123], v[216:219], v[208:211], 0
  v_exp_f32 v44, v44
  v_cvt_pk_bf16_f32 v212, v40, v41
  v_exp_f32 v45, v45
  v_exp_f32 v46, v46
  v_cvt_pk_bf16_f32 v213, v42, v43
  v_exp_f32 v47, v47
  v_cvt_pk_bf16_f32 v214, v44, v45
  v_cvt_pk_bf16_f32 v215, v46, v47
  v_mfma_f32_16x16x32_bf16 v[40:43], v[56:59], v[28:31], 0
  v_exp_f32 v32, v32
  v_mfma_f32_16x16x32_bf16 v[44:47], v[60:63], v[28:31], 0
  v_exp_f32 v33, v33
  v_mfma_f32_16x16x32_bf16 v[124:127], v[72:75], v[212:215], 0
  v_exp_f32 v34, v34
  v_mfma_f32_16x16x32_bf16 v[128:131], v[76:79], v[212:215], 0
  v_exp_f32 v35, v35
  v_mfma_f32_16x16x32_bf16 v[132:135], v[216:219], v[212:215], 0
  v_exp_f32 v36, v36
  v_cvt_pk_bf16_f32 v208, v32, v33
  v_exp_f32 v37, v37
  v_exp_f32 v38, v38
  v_cvt_pk_bf16_f32 v209, v34, v35
  v_exp_f32 v39, v39
  v_cvt_pk_bf16_f32 v210, v36, v37
  v_cvt_pk_bf16_f32 v211, v38, v39
  v_exp_f32 v40, v40
  v_exp_f32 v41, v41
  v_mfma_f32_16x16x32_bf16 v[136:139], v[72:75], v[208:211], v[136:139]
  v_exp_f32 v42, v42
  v_mfma_f32_16x16x32_bf16 v[140:143], v[76:79], v[208:211], v[140:143]
  v_exp_f32 v43, v43
  v_mfma_f32_16x16x32_bf16 v[144:147], v[216:219], v[208:211], v[144:147]
  v_exp_f32 v44, v44
  v_exp_f32 v45, v45
  v_exp_f32 v46, v46
  v_exp_f32 v47, v47
  v_cvt_pk_bf16_f32 v212, v40, v41
  v_cvt_pk_bf16_f32 v213, v42, v43
  v_cvt_pk_bf16_f32 v214, v44, v45
  v_cvt_pk_bf16_f32 v215, v46, v47
  s_nop 1
  v_mfma_f32_16x16x32_bf16 v[148:151], v[72:75], v[212:215], v[148:151]
  v_mfma_f32_16x16x32_bf16 v[152:155], v[76:79], v[212:215], v[152:155]
  v_mfma_f32_16x16x32_bf16 v[156:159], v[216:219], v[212:215], v[156:159]
  v_lshrrev_b32 v184, 4, v1
  v_bfe_u32 v185, v1, 2, 2
  v_and_b32 v186, 3, v1
  v_and_b32 v187, 1, v184
  v_lshl_add_u32 v187, v187, 2, v185
  v_lshrrev_b32 v188, 1, v184
  v_mul_u32_u24 v188, 2048, v188
  v_lshl_add_u32 v188, v187, 7, v188
  v_lshl_add_u32 v188, v186, 3, v188
  v_add_u32 v188, 65536, v188
  v_lshrrev_b32 v189, 1, v187
  s_lshl_b32 s38, s36, 13
  v_lshl_add_u32 v248, v1, 4, s38
  v_add_u32 v249, 1024, v248
  s_lshl_b32 s39, s37, 1
  s_add_u32 s39, s39, 0
  v_xor_b32 v176, s39, v189
  v_lshl_add_u32 v250, v176, 5, v188
  s_lshl_b32 s39, s37, 1
  s_add_u32 s39, s39, 1
  v_xor_b32 v176, s39, v189
  v_lshl_add_u32 v251, v176, 5, v188
  s_and_b32 s76, s25, 1
  s_lshl_b32 s76, s76, 12
  s_and_b32 s39, s25, 2
  s_lshl_b32 s39, s39, 13
  s_add_u32 s76, s76, s39
  s_lshl_b32 s39, s37, 10
  s_add_u32 s76, s76, s39
  s_lshl_b32 s39, s36, 9
  s_add_u32 s76, s76, s39
  s_add_u32 s76, s76, s72
  s_lshl_b32 s39, s37, 10
  s_add_u32 s44, s72, s39
  s_add_u32 s44, s44, s23
  s_add_u32 s45, s44, 4214784
  s_add_u32 s44, s44, 4194304
  v_add_u32 v14, s39, v13
  v_add_u32 v15, 61440, v14
  v_add_u32 v14, 49152, v14
  s_barrier
  s_cmp_eq_u32 s24, 0
  s_cbranch_scc1 Lz95
  ds_read_b128 v[48:51], v3 offset:14336
  ds_read_b128 v[52:55], v3 offset:15360
  ds_read_b128 v[64:67], v4 offset:14336
  ds_read_b128 v[68:71], v4 offset:15360
  s_waitcnt lgkmcnt(2)
  v_mfma_f32_16x16x32_bf16 v[32:35], v[48:51], v[16:19], 0
  v_mfma_f32_16x16x32_bf16 v[36:39], v[52:55], v[16:19], 0
  ds_read_b128 v[56:59], v3 offset:12288
  ds_read_b128 v[60:63], v3 offset:13312
  s_nop 6
  v_mfma_f32_16x16x32_bf16 v[40:43], v[48:51], v[20:23], 0
  v_exp_f32 v32, v32
  v_mfma_f32_16x16x32_bf16 v[44:47], v[52:55], v[20:23], 0
  v_exp_f32 v33, v33
  v_exp_f32 v34, v34
  v_exp_f32 v35, v35
  v_exp_f32 v36, v36
  v_exp_f32 v37, v37
  v_exp_f32 v38, v38
  v_exp_f32 v39, v39
  v_cvt_pk_bf16_f32 v208, v32, v33
  v_cvt_pk_bf16_f32 v209, v34, v35
  v_cvt_pk_bf16_f32 v210, v36, v37
  v_cvt_pk_bf16_f32 v211, v38, v39
  ds_read_b128 v[72:75], v4 offset:12288
  ds_read_b128 v[76:79], v4 offset:13312
  s_waitcnt lgkmcnt(4)
  v_mfma_f32_16x16x32_bf16 v[32:35], v[48:51], v[24:27], 0
  v_exp_f32 v40, v40
  v_mfma_f32_16x16x32_bf16 v[36:39], v[52:55], v[24:27], 0
  v_exp_f32 v41, v41
  v_mfma_f32_16x16x32_bf16 v[112:115], v[64:67], v[208:211], v[112:115]
  v_exp_f32 v42, v42
  v_mfma_f32_16x16x32_bf16 v[116:119], v[68:71], v[208:211], v[116:119]
  v_exp_f32 v43, v43
  v_mfma_f32_16x16x32_bf16 v[120:123], v[216:219], v[208:211], v[120:123]
  v_exp_f32 v44, v44
  v_cvt_pk_bf16_f32 v212, v40, v41
  v_exp_f32 v45, v45
  v_exp_f32 v46, v46
  v_cvt_pk_bf16_f32 v213, v42, v43
  v_exp_f32 v47, v47
  v_cvt_pk_bf16_f32 v214, v44, v45
  v_cvt_pk_bf16_f32 v215, v46, v47
  v_mfma_f32_16x16x32_bf16 v[40:43], v[48:51], v[28:31], 0
  v_exp_f32 v32, v32
  v_mfma_f32_16x16x32_bf16 v[44:47], v[52:55], v[28:31], 0
  v_exp_f32 v33, v33
  v_mfma_f32_16x16x32_bf16 v[124:127], v[64:67], v[212:215], v[124:127]
  v_exp_f32 v34, v34
  v_mfma_f32_16x16x32_bf16 v[128:131], v[68:71], v[212:215], v[128:131]
  v_exp_f32 v35, v35
  v_mfma_f32_16x16x32_bf16 v[132:135], v[216:219], v[212:215], v[132:135]
  v_exp_f32 v36, v36
  v_cvt_pk_bf16_f32 v208, v32, v33
  v_exp_f32 v37, v37
  v_exp_f32 v38, v38
  v_cvt_pk_bf16_f32 v209, v34, v35
  v_exp_f32 v39, v39
  v_cvt_pk_bf16_f32 v210, v36, v37
  v_cvt_pk_bf16_f32 v211, v38, v39
  s_waitcnt lgkmcnt(2)
  v_mfma_f32_16x16x32_bf16 v[32:35], v[56:59], v[16:19], 0
  v_exp_f32 v40, v40
  v_mfma_f32_16x16x32_bf16 v[36:39], v[60:63], v[16:19], 0
  v_exp_f32 v41, v41
  v_mfma_f32_16x16x32_bf16 v[136:139], v[64:67], v[208:211], v[136:139]
  v_exp_f32 v42, v42
  v_mfma_f32_16x16x32_bf16 v[140:143], v[68:71], v[208:211], v[140:143]
  v_exp_f32 v43, v43
  v_mfma_f32_16x16x32_bf16 v[144:147], v[216:219], v[208:211], v[144:147]
  v_exp_f32 v44, v44
  v_cvt_pk_bf16_f32 v212, v40, v41
  v_exp_f32 v45, v45
  v_exp_f32 v46, v46
  v_cvt_pk_bf16_f32 v213, v42, v43
  v_exp_f32 v47, v47
  v_cvt_pk_bf16_f32 v214, v44, v45
  v_cvt_pk_bf16_f32 v215, v46, v47
  s_barrier
  ds_read_b128 v[48:51], v3 offset:10240
  ds_read_b128 v[52:55], v3 offset:11264
  v_mfma_f32_16x16x32_bf16 v[40:43], v[56:59], v[20:23], 0
  v_exp_f32 v32, v32
  v_mfma_f32_16x16x32_bf16 v[44:47], v[60:63], v[20:23], 0
  v_exp_f32 v33, v33
  v_mfma_f32_16x16x32_bf16 v[148:151], v[64:67], v[212:215], v[148:151]
  v_exp_f32 v34, v34
  v_mfma_f32_16x16x32_bf16 v[152:155], v[68:71], v[212:215], v[152:155]
  v_exp_f32 v35, v35
  v_mfma_f32_16x16x32_bf16 v[156:159], v[216:219], v[212:215], v[156:159]
  v_exp_f32 v36, v36
  v_cvt_pk_bf16_f32 v208, v32, v33
  v_exp_f32 v37, v37
  v_exp_f32 v38, v38
  v_cvt_pk_bf16_f32 v209, v34, v35
  v_exp_f32 v39, v39
  v_cvt_pk_bf16_f32 v210, v36, v37
  v_cvt_pk_bf16_f32 v211, v38, v39
  ds_read_b128 v[64:67], v4 offset:10240
  ds_read_b128 v[68:71], v4 offset:11264
  s_waitcnt lgkmcnt(4)
  v_mfma_f32_16x16x32_bf16 v[32:35], v[56:59], v[24:27], 0
  v_exp_f32 v40, v40
  v_mfma_f32_16x16x32_bf16 v[36:39], v[60:63], v[24:27], 0
  v_exp_f32 v41, v41
  v_mfma_f32_16x16x32_bf16 v[112:115], v[72:75], v[208:211], v[112:115]
  v_exp_f32 v42, v42
  v_mfma_f32_16x16x32_bf16 v[116:119], v[76:79], v[208:211], v[116:119]
  v_exp_f32 v43, v43
  v_mfma_f32_16x16x32_bf16 v[120:123], v[216:219], v[208:211], v[120:123]
  v_exp_f32 v44, v44
  v_cvt_pk_bf16_f32 v212, v40, v41
  v_exp_f32 v45, v45
  v_exp_f32 v46, v46
  v_cvt_pk_bf16_f32 v213, v42, v43
  v_exp_f32 v47, v47
  v_cvt_pk_bf16_f32 v214, v44, v45
  v_cvt_pk_bf16_f32 v215, v46, v47
  v_mfma_f32_16x16x32_bf16 v[40:43], v[56:59], v[28:31], 0
  v_exp_f32 v32, v32
  v_mfma_f32_16x16x32_bf16 v[44:47], v[60:63], v[28:31], 0
  v_exp_f32 v33, v33
  v_mfma_f32_16x16x32_bf16 v[124:127], v[72:75], v[212:215], v[124:127]
  v_exp_f32 v34, v34
  v_mfma_f32_16x16x32_bf16 v[128:131], v[76:79], v[212:215], v[128:131]
  v_exp_f32 v35, v35
  v_mfma_f32_16x16x32_bf16 v[132:135], v[216:219], v[212:215], v[132:135]
  v_exp_f32 v36, v36
  v_cvt_pk_bf16_f32 v208, v32, v33
  v_exp_f32 v37, v37
  v_exp_f32 v38, v38
  v_cvt_pk_bf16_f32 v209, v34, v35
  v_exp_f32 v39, v39
  v_cvt_pk_bf16_f32 v210, v36, v37
  v_cvt_pk_bf16_f32 v211, v38, v39
  s_waitcnt lgkmcnt(2)
  v_mfma_f32_16x16x32_bf16 v[32:35], v[48:51], v[16:19], 0
  v_exp_f32 v40, v40
  v_mfma_f32_16x16x32_bf16 v[36:39], v[52:55], v[16:19], 0
  v_exp_f32 v41, v41
  v_mfma_f32_16x16x32_bf16 v[136:139], v[72:75], v[208:211], v[136:139]
  v_exp_f32 v42, v42
  v_mfma_f32_16x16x32_bf16 v[140:143], v[76:79], v[208:211], v[140:143]
  v_exp_f32 v43, v43
  v_mfma_f32_16x16x32_bf16 v[144:147], v[216:219], v[208:211], v[144:147]
  v_exp_f32 v44, v44
  v_cvt_pk_bf16_f32 v212, v40, v41
  v_exp_f32 v45, v45
  v_exp_f32 v46, v46
  v_cvt_pk_bf16_f32 v213, v42, v43
  v_exp_f32 v47, v47
  v_cvt_pk_bf16_f32 v214, v44, v45
  v_cvt_pk_bf16_f32 v215, v46, v47
  ds_read_b128 v[56:59], v3 offset:8192
  ds_read_b128 v[60:63], v3 offset:9216
  v_mfma_f32_16x16x32_bf16 v[40:43], v[48:51], v[20:23], 0
  v_exp_f32 v32, v32
  v_mfma_f32_16x16x32_bf16 v[44:47], v[52:55], v[20:23], 0
  v_exp_f32 v33, v33
  v_mfma_f32_16x16x32_bf16 v[148:151], v[72:75], v[212:215], v[148:151]
  v_exp_f32 v34, v34
  v_mfma_f32_16x16x32_bf16 v[152:155], v[76:79], v[212:215], v[152:155]
  v_exp_f32 v35, v35
  v_mfma_f32_16x16x32_bf16 v[156:159], v[216:219], v[212:215], v[156:159]
  v_exp_f32 v36, v36
  v_cvt_pk_bf16_f32 v208, v32, v33
  v_exp_f32 v37, v37
  v_exp_f32 v38, v38
  v_cvt_pk_bf16_f32 v209, v34, v35
  v_exp_f32 v39, v39
  v_cvt_pk_bf16_f32 v210, v36, v37
  v_cvt_pk_bf16_f32 v211, v38, v39
  ds_read_b128 v[72:75], v4 offset:8192
  ds_read_b128 v[76:79], v4 offset:9216
  s_waitcnt lgkmcnt(4)
  v_mfma_f32_16x16x32_bf16 v[32:35], v[48:51], v[24:27], 0
  v_exp_f32 v40, v40
  v_mfma_f32_16x16x32_bf16 v[36:39], v[52:55], v[24:27], 0
  v_exp_f32 v41, v41
  v_mfma_f32_16x16x32_bf16 v[112:115], v[64:67], v[208:211], v[112:115]
  v_exp_f32 v42, v42
  v_mfma_f32_16x16x32_bf16 v[116:119], v[68:71], v[208:211], v[116:119]
  v_exp_f32 v43, v43
  v_mfma_f32_16x16x32_bf16 v[120:123], v[216:219], v[208:211], v[120:123]
  v_exp_f32 v44, v44
  v_cvt_pk_bf16_f32 v212, v40, v41
  v_exp_f32 v45, v45
  v_exp_f32 v46, v46
  v_cvt_pk_bf16_f32 v213, v42, v43
  v_exp_f32 v47, v47
  v_cvt_pk_bf16_f32 v214, v44, v45
  v_cvt_pk_bf16_f32 v215, v46, v47
  v_mfma_f32_16x16x32_bf16 v[40:43], v[48:51], v[28:31], 0
  v_exp_f32 v32, v32
  v_mfma_f32_16x16x32_bf16 v[44:47], v[52:55], v[28:31], 0
  v_exp_f32 v33, v33
  v_mfma_f32_16x16x32_bf16 v[124:127], v[64:67], v[212:215], v[124:127]
  v_exp_f32 v34, v34
  v_mfma_f32_16x16x32_bf16 v[128:131], v[68:71], v[212:215], v[128:131]
  v_exp_f32 v35, v35
  v_mfma_f32_16x16x32_bf16 v[132:135], v[216:219], v[212:215], v[132:135]
  v_exp_f32 v36, v36
  v_cvt_pk_bf16_f32 v208, v32, v33
  v_exp_f32 v37, v37
  v_exp_f32 v38, v38
  v_cvt_pk_bf16_f32 v209, v34, v35
  v_exp_f32 v39, v39
  v_cvt_pk_bf16_f32 v210, v36, v37
  v_cvt_pk_bf16_f32 v211, v38, v39
  s_waitcnt lgkmcnt(2)
  v_mfma_f32_16x16x32_bf16 v[32:35], v[56:59], v[16:19], 0
  v_exp_f32 v40, v40
  v_mfma_f32_16x16x32_bf16 v[36:39], v[60:63], v[16:19], 0
  v_exp_f32 v41, v41
  v_mfma_f32_16x16x32_bf16 v[136:139], v[64:67], v[208:211], v[136:139]
  v_exp_f32 v42, v42
  v_mfma_f32_16x16x32_bf16 v[140:143], v[68:71], v[208:211], v[140:143]
  v_exp_f32 v43, v43
  v_mfma_f32_16x16x32_bf16 v[144:147], v[216:219], v[208:211], v[144:147]
  v_exp_f32 v44, v44
  v_cvt_pk_bf16_f32 v212, v40, v41
  v_exp_f32 v45, v45
  v_exp_f32 v46, v46
  v_cvt_pk_bf16_f32 v213, v42, v43
  v_exp_f32 v47, v47
  v_cvt_pk_bf16_f32 v214, v44, v45
  v_cvt_pk_bf16_f32 v215, v46, v47
  s_barrier
  ds_read_b128 v[48:51], v3 offset:6144
  ds_read_b128 v[52:55], v3 offset:7168
  v_mfma_f32_16x16x32_bf16 v[40:43], v[56:59], v[20:23], 0
  v_exp_f32 v32, v32
  v_mfma_f32_16x16x32_bf16 v[44:47], v[60:63], v[20:23], 0
  v_exp_f32 v33, v33
  v_mfma_f32_16x16x32_bf16 v[148:151], v[64:67], v[212:215], v[148:151]
  v_exp_f32 v34, v34
  v_mfma_f32_16x16x32_bf16 v[152:155], v[68:71], v[212:215], v[152:155]
  v_exp_f32 v35, v35
  v_mfma_f32_16x16x32_bf16 v[156:159], v[216:219], v[212:215], v[156:159]
  v_exp_f32 v36, v36
  v_cvt_pk_bf16_f32 v208, v32, v33
  v_exp_f32 v37, v37
  v_exp_f32 v38, v38
  v_cvt_pk_bf16_f32 v209, v34, v35
  v_exp_f32 v39, v39
  v_cvt_pk_bf16_f32 v210, v36, v37
  v_cvt_pk_bf16_f32 v211, v38, v39
  ds_read_b128 v[64:67], v4 offset:6144
  ds_read_b128 v[68:71], v4 offset:7168
  s_waitcnt lgkmcnt(4)
  v_mfma_f32_16x16x32_bf16 v[32:35], v[56:59], v[24:27], 0
  v_exp_f32 v40, v40
  v_mfma_f32_16x16x32_bf16 v[36:39], v[60:63], v[24:27], 0
  v_exp_f32 v41, v41
  v_mfma_f32_16x16x32_bf16 v[112:115], v[72:75], v[208:211], v[112:115]
  v_exp_f32 v42, v42
  v_mfma_f32_16x16x32_bf16 v[116:119], v[76:79], v[208:211], v[116:119]
  v_exp_f32 v43, v43
  v_mfma_f32_16x16x32_bf16 v[120:123], v[216:219], v[208:211], v[120:123]
  v_exp_f32 v44, v44
  v_cvt_pk_bf16_f32 v212, v40, v41
  v_exp_f32 v45, v45
  v_exp_f32 v46, v46
  v_cvt_pk_bf16_f32 v213, v42, v43
  v_exp_f32 v47, v47
  v_cvt_pk_bf16_f32 v214, v44, v45
  v_cvt_pk_bf16_f32 v215, v46, v47
  v_mfma_f32_16x16x32_bf16 v[40:43], v[56:59], v[28:31], 0
  v_exp_f32 v32, v32
  v_mfma_f32_16x16x32_bf16 v[44:47], v[60:63], v[28:31], 0
  v_exp_f32 v33, v33
  v_mfma_f32_16x16x32_bf16 v[124:127], v[72:75], v[212:215], v[124:127]
  v_exp_f32 v34, v34
  v_mfma_f32_16x16x32_bf16 v[128:131], v[76:79], v[212:215], v[128:131]
  v_exp_f32 v35, v35
  v_mfma_f32_16x16x32_bf16 v[132:135], v[216:219], v[212:215], v[132:135]
  v_exp_f32 v36, v36
  v_cvt_pk_bf16_f32 v208, v32, v33
  v_exp_f32 v37, v37
  v_exp_f32 v38, v38
  v_cvt_pk_bf16_f32 v209, v34, v35
  v_exp_f32 v39, v39
  v_cvt_pk_bf16_f32 v210, v36, v37
  v_cvt_pk_bf16_f32 v211, v38, v39
  s_waitcnt lgkmcnt(2)
  v_mfma_f32_16x16x32_bf16 v[32:35], v[48:51], v[16:19], 0
  v_exp_f32 v40, v40
  v_mfma_f32_16x16x32_bf16 v[36:39], v[52:55], v[16:19], 0
  v_exp_f32 v41, v41
  v_mfma_f32_16x16x32_bf16 v[136:139], v[72:75], v[208:211], v[136:139]
  v_exp_f32 v42, v42
  v_mfma_f32_16x16x32_bf16 v[140:143], v[76:79], v[208:211], v[140:143]
  v_exp_f32 v43, v43
  v_mfma_f32_16x16x32_bf16 v[144:147], v[216:219], v[208:211], v[144:147]
  v_exp_f32 v44, v44
  v_cvt_pk_bf16_f32 v212, v40, v41
  v_exp_f32 v45, v45
  v_exp_f32 v46, v46
  v_cvt_pk_bf16_f32 v213, v42, v43
  v_exp_f32 v47, v47
  v_cvt_pk_bf16_f32 v214, v44, v45
  v_cvt_pk_bf16_f32 v215, v46, v47
  s_cmp_eq_u32 s24, 1
  s_cbranch_scc1 Lstub97
  ds_read_b128 v[56:59], v3 offset:4096
  ds_read_b128 v[60:63], v3 offset:5120
  v_mfma_f32_16x16x32_bf16 v[40:43], v[48:51], v[20:23], 0
  v_exp_f32 v32, v32
  v_mfma_f32_16x16x32_bf16 v[44:47], v[52:55], v[20:23], 0
  v_exp_f32 v33, v33
  v_mfma_f32_16x16x32_bf16 v[148:151], v[72:75], v[212:215], v[148:151]
  v_exp_f32 v34, v34
  v_mfma_f32_16x16x32_bf16 v[152:155], v[76:79], v[212:215], v[152:155]
  v_exp_f32 v35, v35
  v_mfma_f32_16x16x32_bf16 v[156:159], v[216:219], v[212:215], v[156:159]
  v_exp_f32 v36, v36
  v_cvt_pk_bf16_f32 v208, v32, v33
  v_exp_f32 v37, v37
  v_exp_f32 v38, v38
  v_cvt_pk_bf16_f32 v209, v34, v35
  v_exp_f32 v39, v39
  v_cvt_pk_bf16_f32 v210, v36, v37
  v_cvt_pk_bf16_f32 v211, v38, v39
  ds_read_b128 v[72:75], v4 offset:4096
  ds_read_b128 v[76:79], v4 offset:5120
  s_waitcnt lgkmcnt(4)
  v_mfma_f32_16x16x32_bf16 v[32:35], v[48:51], v[24:27], v[200:203]
  v_exp_f32 v40, v40
  v_mfma_f32_16x16x32_bf16 v[36:39], v[52:55], v[24:27], 0
  v_exp_f32 v41, v41
  v_mfma_f32_16x16x32_bf16 v[112:115], v[64:67], v[208:211], v[112:115]
  v_exp_f32 v42, v42
  v_mfma_f32_16x16x32_bf16 v[116:119], v[68:71], v[208:211], v[116:119]
  v_exp_f32 v43, v43
  v_mfma_f32_16x16x32_bf16 v[120:123], v[216:219], v[208:211], v[120:123]
  v_exp_f32 v44, v44
  v_cvt_pk_bf16_f32 v212, v40, v41
  v_exp_f32 v45, v45
  v_exp_f32 v46, v46
  v_cvt_pk_bf16_f32 v213, v42, v43
  v_exp_f32 v47, v47
  v_cvt_pk_bf16_f32 v214, v44, v45
  v_cvt_pk_bf16_f32 v215, v46, v47
  v_exp_f32 v32, v32
  v_mfma_f32_16x16x32_bf16 v[44:47], v[52:55], v[28:31], v[200:203]
  v_exp_f32 v33, v33
  v_mfma_f32_16x16x32_bf16 v[124:127], v[64:67], v[212:215], v[124:127]
  v_exp_f32 v34, v34
  v_mfma_f32_16x16x32_bf16 v[128:131], v[68:71], v[212:215], v[128:131]
  v_exp_f32 v35, v35
  v_mfma_f32_16x16x32_bf16 v[132:135], v[216:219], v[212:215], v[132:135]
  v_exp_f32 v36, v36
  v_exp_f32 v37, v37
  v_exp_f32 v38, v38
  v_exp_f32 v39, v39
  v_cvt_pk_bf16_f32 v208, v32, v33
  v_cvt_pk_bf16_f32 v209, v34, v35
  v_cvt_pk_bf16_f32 v210, v36, v37
  v_cvt_pk_bf16_f32 v211, v38, v39
  s_waitcnt lgkmcnt(2)
  v_mfma_f32_16x16x32_bf16 v[32:35], v[56:59], v[16:19], 0
  v_exp_f32 v44, v44
  v_mfma_f32_16x16x32_bf16 v[36:39], v[60:63], v[16:19], 0
  v_exp_f32 v45, v45
  v_mfma_f32_16x16x32_bf16 v[136:139], v[64:67], v[208:211], v[136:139]
  v_exp_f32 v46, v46
  v_mfma_f32_16x16x32_bf16 v[140:143], v[68:71], v[208:211], v[140:143]
  v_exp_f32 v47, v47
  v_mfma_f32_16x16x32_bf16 v[144:147], v[216:219], v[208:211], v[144:147]
  v_mov_b32 v212, 0
  v_mov_b32 v213, 0
  v_cvt_pk_bf16_f32 v214, v44, v45
  v_cvt_pk_bf16_f32 v215, v46, v47
  ds_read_b128 v[48:51], v3 offset:2048
  ds_read_b128 v[52:55], v3 offset:3072
  v_mfma_f32_16x16x32_bf16 v[40:43], v[56:59], v[20:23], 0
  v_exp_f32 v32, v32
  v_mfma_f32_16x16x32_bf16 v[44:47], v[60:63], v[20:23], 0
  v_exp_f32 v33, v33
  v_mfma_f32_16x16x32_bf16 v[148:151], v[64:67], v[212:215], v[148:151]
  v_exp_f32 v34, v34
  v_mfma_f32_16x16x32_bf16 v[152:155], v[68:71], v[212:215], v[152:155]
  v_exp_f32 v35, v35
  v_mfma_f32_16x16x32_bf16 v[156:159], v[216:219], v[212:215], v[156:159]
  v_exp_f32 v36, v36
  v_cvt_pk_bf16_f32 v208, v32, v33
  v_exp_f32 v37, v37
  v_exp_f32 v38, v38
  v_cvt_pk_bf16_f32 v209, v34, v35
  v_exp_f32 v39, v39
  v_cvt_pk_bf16_f32 v210, v36, v37
  v_cvt_pk_bf16_f32 v211, v38, v39
  ds_read_b128 v[64:67], v4 offset:2048
  ds_read_b128 v[68:71], v4 offset:3072
  s_waitcnt lgkmcnt(2)
  v_mfma_f32_16x16x32_bf16 v[32:35], v[48:51], v[16:19], 0
  v_exp_f32 v40, v40
  v_mfma_f32_16x16x32_bf16 v[36:39], v[52:55], v[16:19], 0
  v_exp_f32 v41, v41
  v_mfma_f32_16x16x32_bf16 v[112:115], v[72:75], v[208:211], v[112:115]
  v_exp_f32 v42, v42
  v_mfma_f32_16x16x32_bf16 v[116:119], v[76:79], v[208:211], v[116:119]
  v_exp_f32 v43, v43
  v_mfma_f32_16x16x32_bf16 v[120:123], v[216:219], v[208:211], v[120:123]
  v_exp_f32 v44, v44
  v_cvt_pk_bf16_f32 v212, v40, v41
  v_exp_f32 v45, v45
  v_exp_f32 v46, v46
  v_cvt_pk_bf16_f32 v213, v42, v43
  v_exp_f32 v47, v47
  v_cvt_pk_bf16_f32 v214, v44, v45
  v_cvt_pk_bf16_f32 v215, v46, v47
  ds_read_b128 v[56:59], v3 offset:0
  ds_read_b128 v[60:63], v3 offset:1024
  v_mfma_f32_16x16x32_bf16 v[40:43], v[48:51], v[20:23], 0
  v_exp_f32 v32, v32
  v_mfma_f32_16x16x32_bf16 v[44:47], v[52:55], v[20:23], 0
  v_exp_f32 v33, v33
  v_mfma_f32_16x16x32_bf16 v[124:127], v[72:75], v[212:215], v[124:127]
  v_exp_f32 v34, v34
  v_mfma_f32_16x16x32_bf16 v[128:131], v[76:79], v[212:215], v[128:131]
  v_exp_f32 v35, v35
  v_mfma_f32_16x16x32_bf16 v[132:135], v[216:219], v[212:215], v[132:135]
  v_exp_f32 v36, v36
  v_cvt_pk_bf16_f32 v208, v32, v33
  v_exp_f32 v37, v37
  v_exp_f32 v38, v38
  v_cvt_pk_bf16_f32 v209, v34, v35
  v_exp_f32 v39, v39
  v_cvt_pk_bf16_f32 v210, v36, v37
  v_cvt_pk_bf16_f32 v211, v38, v39
  ds_read_b128 v[72:75], v4 offset:0
  ds_read_b128 v[76:79], v4 offset:1024
  s_waitcnt lgkmcnt(2)
  v_mfma_f32_16x16x32_bf16 v[32:35], v[56:59], v[16:19], v[200:203]
  v_exp_f32 v40, v40
  v_mfma_f32_16x16x32_bf16 v[36:39], v[60:63], v[16:19], 0
  v_exp_f32 v41, v41
  v_mfma_f32_16x16x32_bf16 v[112:115], v[64:67], v[208:211], v[112:115]
  v_exp_f32 v42, v42
  v_mfma_f32_16x16x32_bf16 v[116:119], v[68:71], v[208:211], v[116:119]
  v_exp_f32 v43, v43
  v_mfma_f32_16x16x32_bf16 v[120:123], v[216:219], v[208:211], v[120:123]
  v_exp_f32 v44, v44
  v_cvt_pk_bf16_f32 v212, v40, v41
  v_exp_f32 v45, v45
  v_exp_f32 v46, v46
  v_cvt_pk_bf16_f32 v213, v42, v43
  v_exp_f32 v47, v47
  v_cvt_pk_bf16_f32 v214, v44, v45
  v_cvt_pk_bf16_f32 v215, v46, v47
  v_exp_f32 v32, v32
  v_mfma_f32_16x16x32_bf16 v[44:47], v[60:63], v[20:23], v[200:203]
  v_exp_f32 v33, v33
  v_mfma_f32_16x16x32_bf16 v[124:127], v[64:67], v[212:215], v[124:127]
  v_exp_f32 v34, v34
  v_mfma_f32_16x16x32_bf16 v[128:131], v[68:71], v[212:215], v[128:131]
  v_exp_f32 v35, v35
  v_mfma_f32_16x16x32_bf16 v[132:135], v[216:219], v[212:215], v[132:135]
  v_exp_f32 v36, v36
  v_exp_f32 v37, v37
  v_exp_f32 v38, v38
  v_exp_f32 v39, v39
  v_cvt_pk_bf16_f32 v208, v32, v33
  v_cvt_pk_bf16_f32 v209, v34, v35
  v_cvt_pk_bf16_f32 v210, v36, v37
  v_cvt_pk_bf16_f32 v211, v38, v39
  v_exp_f32 v44, v44
  v_exp_f32 v45, v45
  s_waitcnt lgkmcnt(0)
  v_mfma_f32_16x16x32_bf16 v[112:115], v[72:75], v[208:211], v[112:115]
  v_exp_f32 v46, v46
  v_mfma_f32_16x16x32_bf16 v[116:119], v[76:79], v[208:211], v[116:119]
  v_exp_f32 v47, v47
  v_mfma_f32_16x16x32_bf16 v[120:123], v[216:219], v[208:211], v[120:123]
  v_mov_b32 v212, 0
  v_mov_b32 v213, 0
  v_cvt_pk_bf16_f32 v214, v44, v45
  v_cvt_pk_bf16_f32 v215, v46, v47
  s_nop 1
  v_mfma_f32_16x16x32_bf16 v[124:127], v[72:75], v[212:215], v[124:127]
  v_mfma_f32_16x16x32_bf16 v[128:131], v[76:79], v[212:215], v[128:131]
  v_mfma_f32_16x16x32_bf16 v[132:135], v[216:219], v[212:215], v[132:135]
  s_branch Lfin94
Lw93:
  ds_read_b128 v[48:51], v3 offset:20480
  ds_read_b128 v[52:55], v3 offset:21504
  ds_read_b128 v[64:67], v4 offset:20480
  ds_read_b128 v[68:71], v4 offset:21504
  s_waitcnt lgkmcnt(2)
  v_mfma_f32_16x16x32_bf16 v[32:35], v[48:51], v[24:27], v[204:207]
  ds_read_b128 v[56:59], v3 offset:18432
  ds_read_b128 v[60:63], v3 offset:19456
  s_nop 6
  v_mfma_f32_16x16x32_bf16 v[40:43], v[48:51], v[28:31], 0
  v_exp_f32 v32, v32
  v_mfma_f32_16x16x32_bf16 v[44:47], v[52:55], v[28:31], v[204:207]
  v_exp_f32 v33, v33
  v_exp_f32 v34, v34
  v_exp_f32 v35, v35
  v_mov_b32 v210, 0
  v_mov_b32 v211, 0
  v_cvt_pk_bf16_f32 v208, v32, v33
  v_cvt_pk_bf16_f32 v209, v34, v35
  ds_read_b128 v[72:75], v4 offset:18432
  ds_read_b128 v[76:79], v4 offset:19456
  s_waitcnt lgkmcnt(2)
  v_exp_f32 v40, v40
  v_mfma_f32_16x16x32_bf16 v[32:35], v[56:59], v[16:19], v[204:207]
  v_exp_f32 v41, v41
  v_mfma_f32_16x16x32_bf16 v[136:139], v[64:67], v[208:211], 0
  v_exp_f32 v42, v42
  v_mfma_f32_16x16x32_bf16 v[140:143], v[68:71], v[208:211], 0
  v_exp_f32 v43, v43
  v_mfma_f32_16x16x32_bf16 v[144:147], v[216:219], v[208:211], 0
  v_exp_f32 v44, v44
  v_exp_f32 v45, v45
  v_exp_f32 v46, v46
  v_exp_f32 v47, v47
  v_cvt_pk_bf16_f32 v212, v40, v41
  v_cvt_pk_bf16_f32 v213, v42, v43
  v_cvt_pk_bf16_f32 v214, v44, v45
  v_cvt_pk_bf16_f32 v215, v46, v47
  ds_read_b128 v[48:51], v3 offset:16384
  ds_read_b128 v[52:55], v3 offset:17408
  v_mfma_f32_16x16x32_bf16 v[40:43], v[56:59], v[20:23], 0
  v_exp_f32 v32, v32
  v_mfma_f32_16x16x32_bf16 v[44:47], v[60:63], v[20:23], v[204:207]
  v_exp_f32 v33, v33
  v_mfma_f32_16x16x32_bf16 v[148:151], v[64:67], v[212:215], 0
  v_exp_f32 v34, v34
  v_mfma_f32_16x16x32_bf16 v[152:155], v[68:71], v[212:215], 0
  v_exp_f32 v35, v35
  v_mfma_f32_16x16x32_bf16 v[156:159], v[216:219], v[212:215], 0
  v_mov_b32 v210, 0
  v_mov_b32 v211, 0
  v_cvt_pk_bf16_f32 v208, v32, v33
  v_cvt_pk_bf16_f32 v209, v34, v35
  ds_read_b128 v[64:67], v4 offset:16384
  ds_read_b128 v[68:71], v4 offset:17408
  s_waitcnt vmcnt(0)
  s_barrier
  s_cmp_lg_u32 s22, 0
  s_cbranch_scc1 Lq98
  s_lshl_b32 s39, s24, 18
  s_lshl_b32 s40, s36, 17
  s_add_u32 s39, s39, s40
  s_lshl_b32 s40, s25, 7
  s_add_u32 s39, s39, s40
  s_lshl_b32 s40, s37, 6
  s_add_u32 s40, s39, s40
  s_add_u32 s41, s40, 32768
  s_add_u32 s42, s40, 65536
  s_add_u32 s43, s40, 98304
  v_and_b32 v8, 15, v1
  v_lshlrev_b32 v8, 11, v8
  v_bfe_u32 v9, v1, 4, 1
  v_lshl_add_u32 v8, v9, 5, v8
  v_lshrrev_b32 v9, 5, v1
  v_lshl_add_u32 v8, v9, 4, v8
  buffer_load_dwordx4 v[232:235], v8, s[64:67], s40 offen
  buffer_load_dwordx4 v[236:239], v8, s[64:67], s41 offen
  buffer_load_dwordx4 v[240:243], v8, s[64:67], s42 offen
  buffer_load_dwordx4 v[244:247], v8, s[64:67], s43 offen
Lq98:
  s_waitcnt lgkmcnt(4)
  v_mfma_f32_16x16x32_bf16 v[32:35], v[56:59], v[24:27], 0
  v_exp_f32 v40, v40
  v_mfma_f32_16x16x32_bf16 v[36:39], v[60:63], v[24:27], 0
  v_exp_f32 v41, v41
  v_mfma_f32_16x16x32_bf16 v[112:115], v[72:75], v[208:211], 0
  v_exp_f32 v42, v42
  v_mfma_f32_16x16x32_bf16 v[116:119], v[76:79], v[208:211], 0
  v_exp_f32 v43, v43
  v_mfma_f32_16x16x32_bf16 v[120:123], v[216:219], v[208:211], 0
  v_exp_f32 v44, v44
  v_cvt_pk_bf16_f32 v212, v40, v41
  v_exp_f32 v45, v45
  v_exp_f32 v46, v46
  v_cvt_pk_bf16_f32 v213, v42, v43
  v_exp_f32 v47, v47
  v_cvt_pk_bf16_f32 v214, v44, v45
  v_cvt_pk_bf16_f32 v215, v46, v47
  v_mfma_f32_16x16x32_bf16 v[40:43], v[56:59], v[28:31], 0
  v_exp_f32 v32, v32
  v_mfma_f32_16x16x32_bf16 v[44:47], v[60:63], v[28:31], 0
  v_exp_f32 v33, v33
  v_mfma_f32_16x16x32_bf16 v[124:127], v[72:75], v[212:215], 0
  v_exp_f32 v34, v34
  v_mfma_f32_16x16x32_bf16 v[128:131], v[76:79], v[212:215], 0
  v_exp_f32 v35, v35
  v_mfma_f32_16x16x32_bf16 v[132:135], v[216:219], v[212:215], 0
  v_exp_f32 v36, v36
  v_cvt_pk_bf16_f32 v208, v32, v33
  v_exp_f32 v37, v37
  v_exp_f32 v38, v38
  v_cvt_pk_bf16_f32 v209, v34, v35
  v_exp_f32 v39, v39
  v_cvt_pk_bf16_f32 v210, v36, v37
  v_cvt_pk_bf16_f32 v211, v38, v39
  s_waitcnt lgkmcnt(2)
  v_mfma_f32_16x16x32_bf16 v[32:35], v[48:51], v[16:19], 0
  v_exp_f32 v40, v40
  v_mfma_f32_16x16x32_bf16 v[36:39], v[52:55], v[16:19], 0
  v_exp_f32 v41, v41
  v_mfma_f32_16x16x32_bf16 v[136:139], v[72:75], v[208:211], v[136:139]
  v_exp_f32 v42, v42
  v_mfma_f32_16x16x32_bf16 v[140:143], v[76:79], v[208:211], v[140:143]
  v_exp_f32 v43, v43
  v_mfma_f32_16x16x32_bf16 v[144:147], v[216:219], v[208:211], v[144:147]
  v_exp_f32 v44, v44
  v_cvt_pk_bf16_f32 v212, v40, v41
  v_exp_f32 v45, v45
  v_exp_f32 v46, v46
  v_cvt_pk_bf16_f32 v213, v42, v43
  v_exp_f32 v47, v47
  v_cvt_pk_bf16_f32 v214, v44, v45
  v_cvt_pk_bf16_f32 v215, v46, v47
  v_mfma_f32_16x16x32_bf16 v[40:43], v[48:51], v[20:23], 0
  v_exp_f32 v32, v32
  v_mfma_f32_16x16x32_bf16 v[44:47], v[52:55], v[20:23], 0
  v_exp_f32 v33, v33
  v_mfma_f32_16x16x32_bf16 v[148:151], v[72:75], v[212:215], v[148:151]
  v_exp_f32 v34, v34
  v_mfma_f32_16x16x32_bf16 v[152:155], v[76:79], v[212:215], v[152:155]
  v_exp_f32 v35, v35
  v_mfma_f32_16x16x32_bf16 v[156:159], v[216:219], v[212:215], v[156:159]
  v_exp_f32 v36, v36
  v_cvt_pk_bf16_f32 v208, v32, v33
  v_exp_f32 v37, v37
  v_exp_f32 v38, v38
  v_cvt_pk_bf16_f32 v209, v34, v35
  v_exp_f32 v39, v39
  v_cvt_pk_bf16_f32 v210, v36, v37
  v_cvt_pk_bf16_f32 v211, v38, v39
  s_waitcnt lgkmcnt(0)
  v_mfma_f32_16x16x32_bf16 v[32:35], v[48:51], v[24:27], 0
  v_exp_f32 v40, v40
  v_mfma_f32_16x16x32_bf16 v[36:39], v[52:55], v[24:27], 0
  v_exp_f32 v41, v41
  v_mfma_f32_16x16x32_bf16 v[112:115], v[64:67], v[208:211], v[112:115]
  v_exp_f32 v42, v42
  v_mfma_f32_16x16x32_bf16 v[116:119], v[68:71], v[208:211], v[116:119]
  v_exp_f32 v43, v43
  v_mfma_f32_16x16x32_bf16 v[120:123], v[216:219], v[208:211], v[120:123]
  v_exp_f32 v44, v44
  v_cvt_pk_bf16_f32 v212, v40, v41
  v_exp_f32 v45, v45
  v_exp_f32 v46, v46
  v_cvt_pk_bf16_f32 v213, v42, v43
  v_exp_f32 v47, v47
  v_cvt_pk_bf16_f32 v214, v44, v45
  v_cvt_pk_bf16_f32 v215, v46, v47
  v_mfma_f32_16x16x32_bf16 v[40:43], v[48:51], v[28:31], 0
  v_exp_f32 v32, v32
  v_mfma_f32_16x16x32_bf16 v[44:47], v[52:55], v[28:31], 0
  v_exp_f32 v33, v33
  v_mfma_f32_16x16x32_bf16 v[124:127], v[64:67], v[212:215], v[124:127]
  v_exp_f32 v34, v34
  v_mfma_f32_16x16x32_bf16 v[128:131], v[68:71], v[212:215], v[128:131]
  v_exp_f32 v35, v35
  v_mfma_f32_16x16x32_bf16 v[132:135], v[216:219], v[212:215], v[132:135]
  v_exp_f32 v36, v36
  v_cvt_pk_bf16_f32 v208, v32, v33
  v_exp_f32 v37, v37
  v_exp_f32 v38, v38
  v_cvt_pk_bf16_f32 v209, v34, v35
  v_exp_f32 v39, v39
  v_cvt_pk_bf16_f32 v210, v36, v37
  v_cvt_pk_bf16_f32 v211, v38, v39
  v_exp_f32 v40, v40
  v_exp_f32 v41, v41
  v_mfma_f32_16x16x32_bf16 v[136:139], v[64:67], v[208:211], v[136:139]
  v_exp_f32 v42, v42
  v_mfma_f32_16x16x32_bf16 v[140:143], v[68:71], v[208:211], v[140:143]
  v_exp_f32 v43, v43
  v_mfma_f32_16x16x32_bf16 v[144:147], v[216:219], v[208:211], v[144:147]
  v_exp_f32 v44, v44
  v_exp_f32 v45, v45
  v_exp_f32 v46, v46
  v_exp_f32 v47, v47
  v_cvt_pk_bf16_f32 v212, v40, v41
  v_cvt_pk_bf16_f32 v213, v42, v43
  v_cvt_pk_bf16_f32 v214, v44, v45
  v_cvt_pk_bf16_f32 v215, v46, v47
  s_nop 1
  v_mfma_f32_16x16x32_bf16 v[148:151], v[64:67], v[212:215], v[148:151]
  v_mfma_f32_16x16x32_bf16 v[152:155], v[68:71], v[212:215], v[152:155]
  v_mfma_f32_16x16x32_bf16 v[156:159], v[216:219], v[212:215], v[156:159]
  v_lshrrev_b32 v184, 4, v1
  v_bfe_u32 v185, v1, 2, 2
  v_and_b32 v186, 3, v1
  v_and_b32 v187, 1, v184
  v_lshl_add_u32 v187, v187, 2, v185
  v_lshrrev_b32 v188, 1, v184
  v_mul_u32_u24 v188, 2048, v188
  v_lshl_add_u32 v188, v187, 7, v188
  v_lshl_add_u32 v188, v186, 3, v188
  v_add_u32 v188, 65536, v188
  v_lshrrev_b32 v189, 1, v187
  s_lshl_b32 s38, s36, 13
  v_lshl_add_u32 v248, v1, 4, s38
  v_add_u32 v249, 1024, v248
  s_lshl_b32 s39, s37, 1
  s_add_u32 s39, s39, 0
  v_xor_b32 v176, s39, v189
  v_lshl_add_u32 v250, v176, 5, v188
  s_lshl_b32 s39, s37, 1
  s_add_u32 s39, s39, 1
  v_xor_b32 v176, s39, v189
  v_lshl_add_u32 v251, v176, 5, v188
  s_and_b32 s76, s25, 1
  s_lshl_b32 s76, s76, 12
  s_and_b32 s39, s25, 2
  s_lshl_b32 s39, s39, 13
  s_add_u32 s76, s76, s39
  s_lshl_b32 s39, s37, 10
  s_add_u32 s76, s76, s39
  s_lshl_b32 s39, s36, 9
  s_add_u32 s76, s76, s39
  s_add_u32 s76, s76, s72
  s_lshl_b32 s39, s37, 10
  s_add_u32 s44, s72, s39
  s_add_u32 s44, s44, s23
  s_add_u32 s45, s44, 4210688
  s_add_u32 s44, s44, 4198400
  v_add_u32 v14, s39, v13
  v_add_u32 v15, 57344, v14
  v_add_u32 v14, 53248, v14
  s_barrier
  s_cmp_eq_u32 s24, 0
  s_cbranch_scc1 Lz95
  ds_read_b128 v[48:51], v3 offset:14336
  ds_read_b128 v[52:55], v3 offset:15360
  ds_read_b128 v[64:67], v4 offset:14336
  ds_read_b128 v[68:71], v4 offset:15360
  s_waitcnt lgkmcnt(2)
  v_mfma_f32_16x16x32_bf16 v[32:35], v[48:51], v[16:19], 0
  v_mfma_f32_16x16x32_bf16 v[36:39], v[52:55], v[16:19], 0
  ds_read_b128 v[56:59], v3 offset:12288
  ds_read_b128 v[60:63], v3 offset:13312
  s_nop 6
  v_mfma_f32_16x16x32_bf16 v[40:43], v[48:51], v[20:23], 0
  v_exp_f32 v32, v32
  v_mfma_f32_16x16x32_bf16 v[44:47], v[52:55], v[20:23], 0
  v_exp_f32 v33, v33
  v_exp_f32 v34, v34
  v_exp_f32 v35, v35
  v_exp_f32 v36, v36
  v_exp_f32 v37, v37
  v_exp_f32 v38, v38
  v_exp_f32 v39, v39
  v_cvt_pk_bf16_f32 v208, v32, v33
  v_cvt_pk_bf16_f32 v209, v34, v35
  v_cvt_pk_bf16_f32 v210, v36, v37
  v_cvt_pk_bf16_f32 v211, v38, v39
  ds_read_b128 v[72:75], v4 offset:12288
  ds_read_b128 v[76:79], v4 offset:13312
  s_waitcnt lgkmcnt(4)
  v_mfma_f32_16x16x32_bf16 v[32:35], v[48:51], v[24:27], 0
  v_exp_f32 v40, v40
  v_mfma_f32_16x16x32_bf16 v[36:39], v[52:55], v[24:27], 0
  v_exp_f32 v41, v41
  v_mfma_f32_16x16x32_bf16 v[112:115], v[64:67], v[208:211], v[112:115]
  v_exp_f32 v42, v42
  v_mfma_f32_16x16x32_bf16 v[116:119], v[68:71], v[208:211], v[116:119]
  v_exp_f32 v43, v43
  v_mfma_f32_16x16x32_bf16 v[120:123], v[216:219], v[208:211], v[120:123]
  v_exp_f32 v44, v44
  v_cvt_pk_bf16_f32 v212, v40, v41
  v_exp_f32 v45, v45
  v_exp_f32 v46, v46
  v_cvt_pk_bf16_f32 v213, v42, v43
  v_exp_f32 v47, v47
  v_cvt_pk_bf16_f32 v214, v44, v45
  v_cvt_pk_bf16_f32 v215, v46, v47
  v_mfma_f32_16x16x32_bf16 v[40:43], v[48:51], v[28:31], 0
  v_exp_f32 v32, v32
  v_mfma_f32_16x16x32_bf16 v[44:47], v[52:55], v[28:31], 0
  v_exp_f32 v33, v33
  v_mfma_f32_16x16x32_bf16 v[124:127], v[64:67], v[212:215], v[124:127]
  v_exp_f32 v34, v34
  v_mfma_f32_16x16x32_bf16 v[128:131], v[68:71], v[212:215], v[128:131]
  v_exp_f32 v35, v35
  v_mfma_f32_16x16x32_bf16 v[132:135], v[216:219], v[212:215], v[132:135]
  v_exp_f32 v36, v36
  v_cvt_pk_bf16_f32 v208, v32, v33
  v_exp_f32 v37, v37
  v_exp_f32 v38, v38
  v_cvt_pk_bf16_f32 v209, v34, v35
  v_exp_f32 v39, v39
  v_cvt_pk_bf16_f32 v210, v36, v37
  v_cvt_pk_bf16_f32 v211, v38, v39
  s_waitcnt lgkmcnt(2)
  v_mfma_f32_16x16x32_bf16 v[32:35], v[56:59], v[16:19], 0
  v_exp_f32 v40, v40
  v_mfma_f32_16x16x32_bf16 v[36:39], v[60:63], v[16:19], 0
  v_exp_f32 v41, v41
  v_mfma_f32_16x16x32_bf16 v[136:139], v[64:67], v[208:211], v[136:139]
  v_exp_f32 v42, v42
  v_mfma_f32_16x16x32_bf16 v[140:143], v[68:71], v[208:211], v[140:143]
  v_exp_f32 v43, v43
  v_mfma_f32_16x16x32_bf16 v[144:147], v[216:219], v[208:211], v[144:147]
  v_exp_f32 v44, v44
  v_cvt_pk_bf16_f32 v212, v40, v41
  v_exp_f32 v45, v45
  v_exp_f32 v46, v46
  v_cvt_pk_bf16_f32 v213, v42, v43
  v_exp_f32 v47, v47
  v_cvt_pk_bf16_f32 v214, v44, v45
  v_cvt_pk_bf16_f32 v215, v46, v47
  s_barrier
  ds_read_b128 v[48:51], v3 offset:10240
  ds_read_b128 v[52:55], v3 offset:11264
  v_mfma_f32_16x16x32_bf16 v[40:43], v[56:59], v[20:23], 0
  v_exp_f32 v32, v32
  v_mfma_f32_16x16x32_bf16 v[44:47], v[60:63], v[20:23], 0
  v_exp_f32 v33, v33
  v_mfma_f32_16x16x32_bf16 v[148:151], v[64:67], v[212:215], v[148:151]
  v_exp_f32 v34, v34
  v_mfma_f32_16x16x32_bf16 v[152:155], v[68:71], v[212:215], v[152:155]
  v_exp_f32 v35, v35
  v_mfma_f32_16x16x32_bf16 v[156:159], v[216:219], v[212:215], v[156:159]
  v_exp_f32 v36, v36
  v_cvt_pk_bf16_f32 v208, v32, v33
  v_exp_f32 v37, v37
  v_exp_f32 v38, v38
  v_cvt_pk_bf16_f32 v209, v34, v35
  v_exp_f32 v39, v39
  v_cvt_pk_bf16_f32 v210, v36, v37
  v_cvt_pk_bf16_f32 v211, v38, v39
  ds_read_b128 v[64:67], v4 offset:10240
  ds_read_b128 v[68:71], v4 offset:11264
  s_waitcnt lgkmcnt(4)
  v_mfma_f32_16x16x32_bf16 v[32:35], v[56:59], v[24:27], 0
  v_exp_f32 v40, v40
  v_mfma_f32_16x16x32_bf16 v[36:39], v[60:63], v[24:27], 0
  v_exp_f32 v41, v41
  v_mfma_f32_16x16x32_bf16 v[112:115], v[72:75], v[208:211], v[112:115]
  v_exp_f32 v42, v42
  v_mfma_f32_16x16x32_bf16 v[116:119], v[76:79], v[208:211], v[116:119]
  v_exp_f32 v43, v43
  v_mfma_f32_16x16x32_bf16 v[120:123], v[216:219], v[208:211], v[120:123]
  v_exp_f32 v44, v44
  v_cvt_pk_bf16_f32 v212, v40, v41
  v_exp_f32 v45, v45
  v_exp_f32 v46, v46
  v_cvt_pk_bf16_f32 v213, v42, v43
  v_exp_f32 v47, v47
  v_cvt_pk_bf16_f32 v214, v44, v45
  v_cvt_pk_bf16_f32 v215, v46, v47
  v_mfma_f32_16x16x32_bf16 v[40:43], v[56:59], v[28:31], 0
  v_exp_f32 v32, v32
  v_mfma_f32_16x16x32_bf16 v[44:47], v[60:63], v[28:31], 0
  v_exp_f32 v33, v33
  v_mfma_f32_16x16x32_bf16 v[124:127], v[72:75], v[212:215], v[124:127]
  v_exp_f32 v34, v34
  v_mfma_f32_16x16x32_bf16 v[128:131], v[76:79], v[212:215], v[128:131]
  v_exp_f32 v35, v35
  v_mfma_f32_16x16x32_bf16 v[132:135], v[216:219], v[212:215], v[132:135]
  v_exp_f32 v36, v36
  v_cvt_pk_bf16_f32 v208, v32, v33
  v_exp_f32 v37, v37
  v_exp_f32 v38, v38
  v_cvt_pk_bf16_f32 v209, v34, v35
  v_exp_f32 v39, v39
  v_cvt_pk_bf16_f32 v210, v36, v37
  v_cvt_pk_bf16_f32 v211, v38, v39
  s_waitcnt lgkmcnt(2)
  v_mfma_f32_16x16x32_bf16 v[32:35], v[48:51], v[16:19], 0
  v_exp_f32 v40, v40
  v_mfma_f32_16x16x32_bf16 v[36:39], v[52:55], v[16:19], 0
  v_exp_f32 v41, v41
  v_mfma_f32_16x16x32_bf16 v[136:139], v[72:75], v[208:211], v[136:139]
  v_exp_f32 v42, v42
  v_mfma_f32_16x16x32_bf16 v[140:143], v[76:79], v[208:211], v[140:143]
  v_exp_f32 v43, v43
  v_mfma_f32_16x16x32_bf16 v[144:147], v[216:219], v[208:211], v[144:147]
  v_exp_f32 v44, v44
  v_cvt_pk_bf16_f32 v212, v40, v41
  v_exp_f32 v45, v45
  v_exp_f32 v46, v46
  v_cvt_pk_bf16_f32 v213, v42, v43
  v_exp_f32 v47, v47
  v_cvt_pk_bf16_f32 v214, v44, v45
  v_cvt_pk_bf16_f32 v215, v46, v47
  ds_read_b128 v[56:59], v3 offset:8192
  ds_read_b128 v[60:63], v3 offset:9216
  v_mfma_f32_16x16x32_bf16 v[40:43], v[48:51], v[20:23], 0
  v_exp_f32 v32, v32
  v_mfma_f32_16x16x32_bf16 v[44:47], v[52:55], v[20:23], 0
  v_exp_f32 v33, v33
  v_mfma_f32_16x16x32_bf16 v[148:151], v[72:75], v[212:215], v[148:151]
  v_exp_f32 v34, v34
  v_mfma_f32_16x16x32_bf16 v[152:155], v[76:79], v[212:215], v[152:155]
  v_exp_f32 v35, v35
  v_mfma_f32_16x16x32_bf16 v[156:159], v[216:219], v[212:215], v[156:159]
  v_exp_f32 v36, v36
  v_cvt_pk_bf16_f32 v208, v32, v33
  v_exp_f32 v37, v37
  v_exp_f32 v38, v38
  v_cvt_pk_bf16_f32 v209, v34, v35
  v_exp_f32 v39, v39
  v_cvt_pk_bf16_f32 v210, v36, v37
  v_cvt_pk_bf16_f32 v211, v38, v39
  ds_read_b128 v[72:75], v4 offset:8192
  ds_read_b128 v[76:79], v4 offset:9216
  s_waitcnt lgkmcnt(4)
  v_mfma_f32_16x16x32_bf16 v[32:35], v[48:51], v[24:27], 0
  v_exp_f32 v40, v40
  v_mfma_f32_16x16x32_bf16 v[36:39], v[52:55], v[24:27], 0
  v_exp_f32 v41, v41
  v_mfma_f32_16x16x32_bf16 v[112:115], v[64:67], v[208:211], v[112:115]
  v_exp_f32 v42, v42
  v_mfma_f32_16x16x32_bf16 v[116:119], v[68:71], v[208:211], v[116:119]
  v_exp_f32 v43, v43
  v_mfma_f32_16x16x32_bf16 v[120:123], v[216:219], v[208:211], v[120:123]
  v_exp_f32 v44, v44
  v_cvt_pk_bf16_f32 v212, v40, v41
  v_exp_f32 v45, v45
  v_exp_f32 v46, v46
  v_cvt_pk_bf16_f32 v213, v42, v43
  v_exp_f32 v47, v47
  v_cvt_pk_bf16_f32 v214, v44, v45
  v_cvt_pk_bf16_f32 v215, v46, v47
  v_mfma_f32_16x16x32_bf16 v[40:43], v[48:51], v[28:31], 0
  v_exp_f32 v32, v32
  v_mfma_f32_16x16x32_bf16 v[44:47], v[52:55], v[28:31], 0
  v_exp_f32 v33, v33
  v_mfma_f32_16x16x32_bf16 v[124:127], v[64:67], v[212:215], v[124:127]
  v_exp_f32 v34, v34
  v_mfma_f32_16x16x32_bf16 v[128:131], v[68:71], v[212:215], v[128:131]
  v_exp_f32 v35, v35
  v_mfma_f32_16x16x32_bf16 v[132:135], v[216:219], v[212:215], v[132:135]
  v_exp_f32 v36, v36
  v_cvt_pk_bf16_f32 v208, v32, v33
  v_exp_f32 v37, v37
  v_exp_f32 v38, v38
  v_cvt_pk_bf16_f32 v209, v34, v35
  v_exp_f32 v39, v39
  v_cvt_pk_bf16_f32 v210, v36, v37
  v_cvt_pk_bf16_f32 v211, v38, v39
  s_waitcnt lgkmcnt(2)
  v_mfma_f32_16x16x32_bf16 v[32:35], v[56:59], v[16:19], 0
  v_exp_f32 v40, v40
  v_mfma_f32_16x16x32_bf16 v[36:39], v[60:63], v[16:19], 0
  v_exp_f32 v41, v41
  v_mfma_f32_16x16x32_bf16 v[136:139], v[64:67], v[208:211], v[136:139]
  v_exp_f32 v42, v42
  v_mfma_f32_16x16x32_bf16 v[140:143], v[68:71], v[208:211], v[140:143]
  v_exp_f32 v43, v43
  v_mfma_f32_16x16x32_bf16 v[144:147], v[216:219], v[208:211], v[144:147]
  v_exp_f32 v44, v44
  v_cvt_pk_bf16_f32 v212, v40, v41
  v_exp_f32 v45, v45
  v_exp_f32 v46, v46
  v_cvt_pk_bf16_f32 v213, v42, v43
  v_exp_f32 v47, v47
  v_cvt_pk_bf16_f32 v214, v44, v45
  v_cvt_pk_bf16_f32 v215, v46, v47
  s_barrier
  ds_read_b128 v[48:51], v3 offset:6144
  ds_read_b128 v[52:55], v3 offset:7168
  v_mfma_f32_16x16x32_bf16 v[40:43], v[56:59], v[20:23], 0
  v_exp_f32 v32, v32
  v_mfma_f32_16x16x32_bf16 v[44:47], v[60:63], v[20:23], 0
  v_exp_f32 v33, v33
  v_mfma_f32_16x16x32_bf16 v[148:151], v[64:67], v[212:215], v[148:151]
  v_exp_f32 v34, v34
  v_mfma_f32_16x16x32_bf16 v[152:155], v[68:71], v[212:215], v[152:155]
  v_exp_f32 v35, v35
  v_mfma_f32_16x16x32_bf16 v[156:159], v[216:219], v[212:215], v[156:159]
  v_exp_f32 v36, v36
  v_cvt_pk_bf16_f32 v208, v32, v33
  v_exp_f32 v37, v37
  v_exp_f32 v38, v38
  v_cvt_pk_bf16_f32 v209, v34, v35
  v_exp_f32 v39, v39
  v_cvt_pk_bf16_f32 v210, v36, v37
  v_cvt_pk_bf16_f32 v211, v38, v39
  ds_read_b128 v[64:67], v4 offset:6144
  ds_read_b128 v[68:71], v4 offset:7168
  s_waitcnt lgkmcnt(4)
  v_mfma_f32_16x16x32_bf16 v[32:35], v[56:59], v[24:27], 0
  v_exp_f32 v40, v40
  v_mfma_f32_16x16x32_bf16 v[36:39], v[60:63], v[24:27], 0
  v_exp_f32 v41, v41
  v_mfma_f32_16x16x32_bf16 v[112:115], v[72:75], v[208:211], v[112:115]
  v_exp_f32 v42, v42
  v_mfma_f32_16x16x32_bf16 v[116:119], v[76:79], v[208:211], v[116:119]
  v_exp_f32 v43, v43
  v_mfma_f32_16x16x32_bf16 v[120:123], v[216:219], v[208:211], v[120:123]
  v_exp_f32 v44, v44
  v_cvt_pk_bf16_f32 v212, v40, v41
  v_exp_f32 v45, v45
  v_exp_f32 v46, v46
  v_cvt_pk_bf16_f32 v213, v42, v43
  v_exp_f32 v47, v47
  v_cvt_pk_bf16_f32 v214, v44, v45
  v_cvt_pk_bf16_f32 v215, v46, v47
  v_mfma_f32_16x16x32_bf16 v[40:43], v[56:59], v[28:31], 0
  v_exp_f32 v32, v32
  v_mfma_f32_16x16x32_bf16 v[44:47], v[60:63], v[28:31], 0
  v_exp_f32 v33, v33
  v_mfma_f32_16x16x32_bf16 v[124:127], v[72:75], v[212:215], v[124:127]
  v_exp_f32 v34, v34
  v_mfma_f32_16x16x32_bf16 v[128:131], v[76:79], v[212:215], v[128:131]
  v_exp_f32 v35, v35
  v_mfma_f32_16x16x32_bf16 v[132:135], v[216:219], v[212:215], v[132:135]
  v_exp_f32 v36, v36
  v_cvt_pk_bf16_f32 v208, v32, v33
  v_exp_f32 v37, v37
  v_exp_f32 v38, v38
  v_cvt_pk_bf16_f32 v209, v34, v35
  v_exp_f32 v39, v39
  v_cvt_pk_bf16_f32 v210, v36, v37
  v_cvt_pk_bf16_f32 v211, v38, v39
  s_waitcnt lgkmcnt(2)
  v_mfma_f32_16x16x32_bf16 v[32:35], v[48:51], v[16:19], 0
  v_exp_f32 v40, v40
  v_mfma_f32_16x16x32_bf16 v[36:39], v[52:55], v[16:19], 0
  v_exp_f32 v41, v41
  v_mfma_f32_16x16x32_bf16 v[136:139], v[72:75], v[208:211], v[136:139]
  v_exp_f32 v42, v42
  v_mfma_f32_16x16x32_bf16 v[140:143], v[76:79], v[208:211], v[140:143]
  v_exp_f32 v43, v43
  v_mfma_f32_16x16x32_bf16 v[144:147], v[216:219], v[208:211], v[144:147]
  v_exp_f32 v44, v44
  v_cvt_pk_bf16_f32 v212, v40, v41
  v_exp_f32 v45, v45
  v_exp_f32 v46, v46
  v_cvt_pk_bf16_f32 v213, v42, v43
  v_exp_f32 v47, v47
  v_cvt_pk_bf16_f32 v214, v44, v45
  v_cvt_pk_bf16_f32 v215, v46, v47
  s_cmp_eq_u32 s24, 1
  s_cbranch_scc1 Lstub99
  ds_read_b128 v[56:59], v3 offset:4096
  ds_read_b128 v[60:63], v3 offset:5120
  v_mfma_f32_16x16x32_bf16 v[40:43], v[48:51], v[20:23], 0
  v_exp_f32 v32, v32
  v_mfma_f32_16x16x32_bf16 v[44:47], v[52:55], v[20:23], 0
  v_exp_f32 v33, v33
  v_mfma_f32_16x16x32_bf16 v[148:151], v[72:75], v[212:215], v[148:151]
  v_exp_f32 v34, v34
  v_mfma_f32_16x16x32_bf16 v[152:155], v[76:79], v[212:215], v[152:155]
  v_exp_f32 v35, v35
  v_mfma_f32_16x16x32_bf16 v[156:159], v[216:219], v[212:215], v[156:159]
  v_exp_f32 v36, v36
  v_cvt_pk_bf16_f32 v208, v32, v33
  v_exp_f32 v37, v37
  v_exp_f32 v38, v38
  v_cvt_pk_bf16_f32 v209, v34, v35
  v_exp_f32 v39, v39
  v_cvt_pk_bf16_f32 v210, v36, v37
  v_cvt_pk_bf16_f32 v211, v38, v39
  ds_read_b128 v[72:75], v4 offset:4096
  ds_read_b128 v[76:79], v4 offset:5120
  s_waitcnt lgkmcnt(4)
  v_mfma_f32_16x16x32_bf16 v[32:35], v[48:51], v[24:27], 0
  v_exp_f32 v40, v40
  v_mfma_f32_16x16x32_bf16 v[36:39], v[52:55], v[24:27], 0
  v_exp_f32 v41, v41
  v_mfma_f32_16x16x32_bf16 v[112:115], v[64:67], v[208:211], v[112:115]
  v_exp_f32 v42, v42
  v_mfma_f32_16x16x32_bf16 v[116:119], v[68:71], v[208:211], v[116:119]
  v_exp_f32 v43, v43
  v_mfma_f32_16x16x32_bf16 v[120:123], v[216:219], v[208:211], v[120:123]
  v_exp_f32 v44, v44
  v_cvt_pk_bf16_f32 v212, v40, v41
  v_exp_f32 v45, v45
  v_exp_f32 v46, v46
  v_cvt_pk_bf16_f32 v213, v42, v43
  v_exp_f32 v47, v47
  v_cvt_pk_bf16_f32 v214, v44, v45
  v_cvt_pk_bf16_f32 v215, v46, v47
  v_mfma_f32_16x16x32_bf16 v[40:43], v[48:51], v[28:31], 0
  v_exp_f32 v32, v32
  v_mfma_f32_16x16x32_bf16 v[44:47], v[52:55], v[28:31], 0
  v_exp_f32 v33, v33
  v_mfma_f32_16x16x32_bf16 v[124:127], v[64:67], v[212:215], v[124:127]
  v_exp_f32 v34, v34
  v_mfma_f32_16x16x32_bf16 v[128:131], v[68:71], v[212:215], v[128:131]
  v_exp_f32 v35, v35
  v_mfma_f32_16x16x32_bf16 v[132:135], v[216:219], v[212:215], v[132:135]
  v_exp_f32 v36, v36
  v_cvt_pk_bf16_f32 v208, v32, v33
  v_exp_f32 v37, v37
  v_exp_f32 v38, v38
  v_cvt_pk_bf16_f32 v209, v34, v35
  v_exp_f32 v39, v39
  v_cvt_pk_bf16_f32 v210, v36, v37
  v_cvt_pk_bf16_f32 v211, v38, v39
  s_waitcnt lgkmcnt(2)
  v_mfma_f32_16x16x32_bf16 v[32:35], v[56:59], v[16:19], 0
  v_exp_f32 v40, v40
  v_mfma_f32_16x16x32_bf16 v[36:39], v[60:63], v[16:19], 0
  v_exp_f32 v41, v41
  v_mfma_f32_16x16x32_bf16 v[136:139], v[64:67], v[208:211], v[136:139]
  v_exp_f32 v42, v42
  v_mfma_f32_16x16x32_bf16 v[140:143], v[68:71], v[208:211], v[140:143]
  v_exp_f32 v43, v43
  v_mfma_f32_16x16x32_bf16 v[144:147], v[216:219], v[208:211], v[144:147]
  v_exp_f32 v44, v44
  v_cvt_pk_bf16_f32 v212, v40, v41
  v_exp_f32 v45, v45
  v_exp_f32 v46, v46
  v_cvt_pk_bf16_f32 v213, v42, v43
  v_exp_f32 v47, v47
  v_cvt_pk_bf16_f32 v214, v44, v45
  v_cvt_pk_bf16_f32 v215, v46, v47
  ds_read_b128 v[48:51], v3 offset:2048
  ds_read_b128 v[52:55], v3 offset:3072
  v_mfma_f32_16x16x32_bf16 v[40:43], v[56:59], v[20:23], 0
  v_exp_f32 v32, v32
  v_mfma_f32_16x16x32_bf16 v[44:47], v[60:63], v[20:23], 0
  v_exp_f32 v33, v33
  v_mfma_f32_16x16x32_bf16 v[148:151], v[64:67], v[212:215], v[148:151]
  v_exp_f32 v34, v34
  v_mfma_f32_16x16x32_bf16 v[152:155], v[68:71], v[212:215], v[152:155]
  v_exp_f32 v35, v35
  v_mfma_f32_16x16x32_bf16 v[156:159], v[216:219], v[212:215], v[156:159]
  v_exp_f32 v36, v36
  v_cvt_pk_bf16_f32 v208, v32, v33
  v_exp_f32 v37, v37
  v_exp_f32 v38, v38
  v_cvt_pk_bf16_f32 v209, v34, v35
  v_exp_f32 v39, v39
  v_cvt_pk_bf16_f32 v210, v36, v37
  v_cvt_pk_bf16_f32 v211, v38, v39
  ds_read_b128 v[64:67], v4 offset:2048
  ds_read_b128 v[68:71], v4 offset:3072
  s_waitcnt lgkmcnt(4)
  v_mfma_f32_16x16x32_bf16 v[32:35], v[56:59], v[24:27], v[200:203]
  v_exp_f32 v40, v40
  v_mfma_f32_16x16x32_bf16 v[36:39], v[60:63], v[24:27], 0
  v_exp_f32 v41, v41
  v_mfma_f32_16x16x32_bf16 v[112:115], v[72:75], v[208:211], v[112:115]
  v_exp_f32 v42, v42
  v_mfma_f32_16x16x32_bf16 v[116:119], v[76:79], v[208:211], v[116:119]
  v_exp_f32 v43, v43
  v_mfma_f32_16x16x32_bf16 v[120:123], v[216:219], v[208:211], v[120:123]
  v_exp_f32 v44, v44
  v_cvt_pk_bf16_f32 v212, v40, v41
  v_exp_f32 v45, v45
  v_exp_f32 v46, v46
  v_cvt_pk_bf16_f32 v213, v42, v43
  v_exp_f32 v47, v47
  v_cvt_pk_bf16_f32 v214, v44, v45
  v_cvt_pk_bf16_f32 v215, v46, v47
  v_exp_f32 v32, v32
  v_mfma_f32_16x16x32_bf16 v[44:47], v[60:63], v[28:31], v[200:203]
  v_exp_f32 v33, v33
  v_mfma_f32_16x16x32_bf16 v[124:127], v[72:75], v[212:215], v[124:127]
  v_exp_f32 v34, v34
  v_mfma_f32_16x16x32_bf16 v[128:131], v[76:79], v[212:215], v[128:131]
  v_exp_f32 v35, v35
  v_mfma_f32_16x16x32_bf16 v[132:135], v[216:219], v[212:215], v[132:135]
  v_exp_f32 v36, v36
  v_exp_f32 v37, v37
  v_exp_f32 v38, v38
  v_exp_f32 v39, v39
  v_cvt_pk_bf16_f32 v208, v32, v33
  v_cvt_pk_bf16_f32 v209, v34, v35
  v_cvt_pk_bf16_f32 v210, v36, v37
  v_cvt_pk_bf16_f32 v211, v38, v39
  s_waitcnt lgkmcnt(2)
  v_mfma_f32_16x16x32_bf16 v[32:35], v[48:51], v[16:19], v[200:203]
  v_exp_f32 v44, v44
  v_mfma_f32_16x16x32_bf16 v[36:39], v[52:55], v[16:19], 0
  v_exp_f32 v45, v45
  v_mfma_f32_16x16x32_bf16 v[136:139], v[72:75], v[208:211], v[136:139]
  v_exp_f32 v46, v46
  v_mfma_f32_16x16x32_bf16 v[140:143], v[76:79], v[208:211], v[140:143]
  v_exp_f32 v47, v47
  v_mfma_f32_16x16x32_bf16 v[144:147], v[216:219], v[208:211], v[144:147]
  v_mov_b32 v212, 0
  v_mov_b32 v213, 0
  v_cvt_pk_bf16_f32 v214, v44, v45
  v_cvt_pk_bf16_f32 v215, v46, v47
  v_exp_f32 v32, v32
  v_mfma_f32_16x16x32_bf16 v[44:47], v[52:55], v[20:23], v[200:203]
  v_exp_f32 v33, v33
  v_mfma_f32_16x16x32_bf16 v[148:151], v[72:75], v[212:215], v[148:151]
  v_exp_f32 v34, v34
  v_mfma_f32_16x16x32_bf16 v[152:155], v[76:79], v[212:215], v[152:155]
  v_exp_f32 v35, v35
  v_mfma_f32_16x16x32_bf16 v[156:159], v[216:219], v[212:215], v[156:159]
  v_exp_f32 v36, v36
  v_exp_f32 v37, v37
  v_exp_f32 v38, v38
  v_exp_f32 v39, v39
  v_cvt_pk_bf16_f32 v208, v32, v33
  v_cvt_pk_bf16_f32 v209, v34, v35
  v_cvt_pk_bf16_f32 v210, v36, v37
  v_cvt_pk_bf16_f32 v211, v38, v39
  v_exp_f32 v44, v44
  v_exp_f32 v45, v45
  s_waitcnt lgkmcnt(0)
  v_mfma_f32_16x16x32_bf16 v[112:115], v[64:67], v[208:211], v[112:115]
  v_exp_f32 v46, v46
  v_mfma_f32_16x16x32_bf16 v[116:119], v[68:71], v[208:211], v[116:119]
  v_exp_f32 v47, v47
  v_mfma_f32_16x16x32_bf16 v[120:123], v[216:219], v[208:211], v[120:123]
  v_mov_b32 v212, 0
  v_mov_b32 v213, 0
  v_cvt_pk_bf16_f32 v214, v44, v45
  v_cvt_pk_bf16_f32 v215, v46, v47
  s_nop 1
  v_mfma_f32_16x16x32_bf16 v[124:127], v[64:67], v[212:215], v[124:127]
  v_mfma_f32_16x16x32_bf16 v[128:131], v[68:71], v[212:215], v[128:131]
  v_mfma_f32_16x16x32_bf16 v[132:135], v[216:219], v[212:215], v[132:135]
  s_branch Lfin94
Lz95:
  s_barrier
  s_barrier
  s_branch Lfin94
Lstub97:
  s_waitcnt lgkmcnt(0)
  s_nop 0
  v_mfma_f32_16x16x32_bf16 v[148:151], v[72:75], v[212:215], v[148:151]
  v_mfma_f32_16x16x32_bf16 v[152:155], v[76:79], v[212:215], v[152:155]
  v_mfma_f32_16x16x32_bf16 v[156:159], v[216:219], v[212:215], v[156:159]
  s_nop 6
  s_branch Lfin94
Lstub99:
  s_waitcnt lgkmcnt(0)
  s_nop 0
  v_mfma_f32_16x16x32_bf16 v[148:151], v[72:75], v[212:215], v[148:151]
  v_mfma_f32_16x16x32_bf16 v[152:155], v[76:79], v[212:215], v[152:155]
  v_mfma_f32_16x16x32_bf16 v[156:159], v[216:219], v[212:215], v[156:159]
  s_nop 6
  s_branch Lfin94
Lfb100:
  s_lshl_b32 s61, s36, 6
  s_sub_u32 s61, 96, s61
  s_mov_b64 s[68:69], 0
  s_waitcnt vmcnt(0) lgkmcnt(0)
  v_mov_b32 v220, v12
  v_mov_b32 v221, v12
  v_mov_b32 v222, v12
  v_mov_b32 v223, v12
  s_lshl_b32 s59, s24, 3
  s_sub_i32 s59, 16, s59
  s_max_i32 s59, s59, 0
Lfl101:
  s_lshl_b32 s60, s59, 10
  v_add_u32 v5, s60, v3
  ds_read_b128 v[48:51], v5
  s_lshl_b32 s60, s36, 1
  s_sub_i32 s60, s60, s59
  s_lshl_b32 s60, s60, 4
  s_add_i32 s60, s60, 256
  v_add_u32 v6, s60, v10
  v_add_u32 v11, s61, v6
  s_waitcnt lgkmcnt(0)
  v_mfma_f32_16x16x32_bf16 v[64:67], v[48:51], v[16:19], 0
  v_mfma_f32_16x16x32_bf16 v[68:71], v[48:51], v[20:23], 0
  v_mfma_f32_16x16x32_bf16 v[72:75], v[48:51], v[24:27], 0
  v_mfma_f32_16x16x32_bf16 v[76:79], v[48:51], v[28:31], 0
  s_nop 7
  v_add_u32 v7, 0, v6
  v_cmp_gt_u32 vcc, 0x100, v7
  s_nop 1
  v_cndmask_b32 v8, v12, v64, vcc
  v_max_f32 v220, v220, v8
  v_add_u32 v7, -1, v6
  v_cmp_gt_u32 vcc, 0x100, v7
  s_nop 1
  v_cndmask_b32 v8, v12, v65, vcc
  v_max_f32 v220, v220, v8
  v_add_u32 v7, -2, v6
  v_cmp_gt_u32 vcc, 0x100, v7
  s_nop 1
  v_cndmask_b32 v8, v12, v66, vcc
  v_max_f32 v220, v220, v8
  v_add_u32 v7, -3, v6
  v_cmp_gt_u32 vcc, 0x100, v7
  s_nop 1
  v_cndmask_b32 v8, v12, v67, vcc
  v_max_f32 v220, v220, v8
  v_add_u32 v7, 16, v6
  v_cmp_gt_u32 vcc, 0x100, v7
  s_nop 1
  v_cndmask_b32 v8, v12, v68, vcc
  v_max_f32 v221, v221, v8
  v_add_u32 v7, 15, v6
  v_cmp_gt_u32 vcc, 0x100, v7
  s_nop 1
  v_cndmask_b32 v8, v12, v69, vcc
  v_max_f32 v221, v221, v8
  v_add_u32 v7, 14, v6
  v_cmp_gt_u32 vcc, 0x100, v7
  s_nop 1
  v_cndmask_b32 v8, v12, v70, vcc
  v_max_f32 v221, v221, v8
  v_add_u32 v7, 13, v6
  v_cmp_gt_u32 vcc, 0x100, v7
  s_nop 1
  v_cndmask_b32 v8, v12, v71, vcc
  v_max_f32 v221, v221, v8
  v_add_u32 v7, 0, v11
  v_cmp_gt_u32 vcc, 0x100, v7
  s_nop 1
  v_cndmask_b32 v8, v12, v72, vcc
  v_max_f32 v222, v222, v8
  v_add_u32 v7, -1, v11
  v_cmp_gt_u32 vcc, 0x100, v7
  s_nop 1
  v_cndmask_b32 v8, v12, v73, vcc
  v_max_f32 v222, v222, v8
  v_add_u32 v7, -2, v11
  v_cmp_gt_u32 vcc, 0x100, v7
  s_nop 1
  v_cndmask_b32 v8, v12, v74, vcc
  v_max_f32 v222, v222, v8
  v_add_u32 v7, -3, v11
  v_cmp_gt_u32 vcc, 0x100, v7
  s_nop 1
  v_cndmask_b32 v8, v12, v75, vcc
  v_max_f32 v222, v222, v8
  v_add_u32 v7, 16, v11
  v_cmp_gt_u32 vcc, 0x100, v7
  s_nop 1
  v_cndmask_b32 v8, v12, v76, vcc
  v_max_f32 v223, v223, v8
  v_add_u32 v7, 15, v11
  v_cmp_gt_u32 vcc, 0x100, v7
  s_nop 1
  v_cndmask_b32 v8, v12, v77, vcc
  v_max_f32 v223, v223, v8
  v_add_u32 v7, 14, v11
  v_cmp_gt_u32 vcc, 0x100, v7
  s_nop 1
  v_cndmask_b32 v8, v12, v78, vcc
  v_max_f32 v223, v223, v8
  v_add_u32 v7, 13, v11
  v_cmp_gt_u32 vcc, 0x100, v7
  s_nop 1
  v_cndmask_b32 v8, v12, v79, vcc
  v_max_f32 v223, v223, v8
  s_add_u32 s59, s59, 1
  s_cmp_lt_u32 s59, 24
  s_cbranch_scc1 Lfl101
  v_mov_b32 v7, v220
  s_nop 1
  v_permlane32_swap_b32 v220, v7
  s_nop 0
  v_max_f32 v220, v220, v7
  v_mov_b32 v7, v220
  s_nop 1
  v_permlane16_swap_b32 v220, v7
  s_nop 0
  v_max_f32 v220, v220, v7
  v_mov_b32 v7, v221
  s_nop 1
  v_permlane32_swap_b32 v221, v7
  s_nop 0
  v_max_f32 v221, v221, v7
  v_mov_b32 v7, v221
  s_nop 1
  v_permlane16_swap_b32 v221, v7
  s_nop 0
  v_max_f32 v221, v221, v7
  v_mov_b32 v7, v222
  s_nop 1
  v_permlane32_swap_b32 v222, v7
  s_nop 0
  v_max_f32 v222, v222, v7
  v_mov_b32 v7, v222
  s_nop 1
  v_permlane16_swap_b32 v222, v7
  s_nop 0
  v_max_f32 v222, v222, v7
  v_mov_b32 v7, v223
  s_nop 1
  v_permlane32_swap_b32 v223, v7
  s_nop 0
  v_max_f32 v223, v223, v7
  v_mov_b32 v7, v223
  s_nop 1
  v_permlane16_swap_b32 v223, v7
  s_nop 0
  v_max_f32 v223, v223, v7
  v_mov_b32 v112, 0
  v_mov_b32 v113, 0
  v_mov_b32 v114, 0
  v_mov_b32 v115, 0
  v_mov_b32 v116, 0
  v_mov_b32 v117, 0
  v_mov_b32 v118, 0
  v_mov_b32 v119, 0
  v_mov_b32 v120, 0
  v_mov_b32 v121, 0
  v_mov_b32 v122, 0
  v_mov_b32 v123, 0
  v_mov_b32 v124, 0
  v_mov_b32 v125, 0
  v_mov_b32 v126, 0
  v_mov_b32 v127, 0
  v_mov_b32 v128, 0
  v_mov_b32 v129, 0
  v_mov_b32 v130, 0
  v_mov_b32 v131, 0
  v_mov_b32 v132, 0
  v_mov_b32 v133, 0
  v_mov_b32 v134, 0
  v_mov_b32 v135, 0
  v_mov_b32 v136, 0
  v_mov_b32 v137, 0
  v_mov_b32 v138, 0
  v_mov_b32 v139, 0
  v_mov_b32 v140, 0
  v_mov_b32 v141, 0
  v_mov_b32 v142, 0
  v_mov_b32 v143, 0
  v_mov_b32 v144, 0
  v_mov_b32 v145, 0
  v_mov_b32 v146, 0
  v_mov_b32 v147, 0
  v_mov_b32 v148, 0
  v_mov_b32 v149, 0
  v_mov_b32 v150, 0
  v_mov_b32 v151, 0
  v_mov_b32 v152, 0
  v_mov_b32 v153, 0
  v_mov_b32 v154, 0
  v_mov_b32 v155, 0
  v_mov_b32 v156, 0
  v_mov_b32 v157, 0
  v_mov_b32 v158, 0
  v_mov_b32 v159, 0
  s_lshl_b32 s59, s24, 3
  s_sub_i32 s59, 16, s59
  s_max_i32 s59, s59, 0
Lf2102:
  s_lshl_b32 s60, s59, 10
  v_add_u32 v5, s60, v3
  v_add_u32 v9, s60, v4
  ds_read_b128 v[48:51], v5
  ds_read_b128 v[52:55], v5 offset:1024
  ds_read_b128 v[64:67], v9
  ds_read_b128 v[68:71], v9 offset:1024
  s_lshl_b32 s60, s36, 1
  s_sub_i32 s60, s60, s59
  s_lshl_b32 s60, s60, 4
  s_add_i32 s60, s60, 240
  v_add_u32 v6, s60, v10
  v_add_u32 v11, s61, v6
  s_waitcnt lgkmcnt(0)
  v_mfma_f32_16x16x32_bf16 v[32:35], v[48:51], v[16:19], 0
  v_mfma_f32_16x16x32_bf16 v[36:39], v[52:55], v[16:19], 0
  s_nop 7
  v_add_u32 v7, 16, v6
  v_cmp_gt_u32 vcc, 0x100, v7
  v_sub_f32 v32, v32, v220
  s_nop 0
  v_cndmask_b32 v32, v12, v32, vcc
  v_exp_f32 v32, v32
  v_add_u32 v7, 15, v6
  v_cmp_gt_u32 vcc, 0x100, v7
  v_sub_f32 v33, v33, v220
  s_nop 0
  v_cndmask_b32 v33, v12, v33, vcc
  v_exp_f32 v33, v33
  v_add_u32 v7, 14, v6
  v_cmp_gt_u32 vcc, 0x100, v7
  v_sub_f32 v34, v34, v220
  s_nop 0
  v_cndmask_b32 v34, v12, v34, vcc
  v_exp_f32 v34, v34
  v_add_u32 v7, 13, v6
  v_cmp_gt_u32 vcc, 0x100, v7
  v_sub_f32 v35, v35, v220
  s_nop 0
  v_cndmask_b32 v35, v12, v35, vcc
  v_exp_f32 v35, v35
  v_add_u32 v7, 0, v6
  v_cmp_gt_u32 vcc, 0x100, v7
  v_sub_f32 v36, v36, v220
  s_nop 0
  v_cndmask_b32 v36, v12, v36, vcc
  v_exp_f32 v36, v36
  v_add_u32 v7, -1, v6
  v_cmp_gt_u32 vcc, 0x100, v7
  v_sub_f32 v37, v37, v220
  s_nop 0
  v_cndmask_b32 v37, v12, v37, vcc
  v_exp_f32 v37, v37
  v_add_u32 v7, -2, v6
  v_cmp_gt_u32 vcc, 0x100, v7
  v_sub_f32 v38, v38, v220
  s_nop 0
  v_cndmask_b32 v38, v12, v38, vcc
  v_exp_f32 v38, v38
  v_add_u32 v7, -3, v6
  v_cmp_gt_u32 vcc, 0x100, v7
  v_sub_f32 v39, v39, v220
  s_nop 0
  v_cndmask_b32 v39, v12, v39, vcc
  v_exp_f32 v39, v39
  s_nop 0
  v_cvt_pk_bf16_f32 v208, v32, v33
  v_cvt_pk_bf16_f32 v209, v34, v35
  v_cvt_pk_bf16_f32 v210, v36, v37
  v_cvt_pk_bf16_f32 v211, v38, v39
  s_nop 1
  v_mfma_f32_16x16x32_bf16 v[112:115], v[64:67], v[208:211], v[112:115]
  v_mfma_f32_16x16x32_bf16 v[116:119], v[68:71], v[208:211], v[116:119]
  v_mfma_f32_16x16x32_bf16 v[120:123], v[216:219], v[208:211], v[120:123]
  v_mfma_f32_16x16x32_bf16 v[32:35], v[48:51], v[20:23], 0
  v_mfma_f32_16x16x32_bf16 v[36:39], v[52:55], v[20:23], 0
  s_nop 7
  v_add_u32 v7, 32, v6
  v_cmp_gt_u32 vcc, 0x100, v7
  v_sub_f32 v32, v32, v221
  s_nop 0
  v_cndmask_b32 v32, v12, v32, vcc
  v_exp_f32 v32, v32
  v_add_u32 v7, 31, v6
  v_cmp_gt_u32 vcc, 0x100, v7
  v_sub_f32 v33, v33, v221
  s_nop 0
  v_cndmask_b32 v33, v12, v33, vcc
  v_exp_f32 v33, v33
  v_add_u32 v7, 30, v6
  v_cmp_gt_u32 vcc, 0x100, v7
  v_sub_f32 v34, v34, v221
  s_nop 0
  v_cndmask_b32 v34, v12, v34, vcc
  v_exp_f32 v34, v34
  v_add_u32 v7, 29, v6
  v_cmp_gt_u32 vcc, 0x100, v7
  v_sub_f32 v35, v35, v221
  s_nop 0
  v_cndmask_b32 v35, v12, v35, vcc
  v_exp_f32 v35, v35
  v_add_u32 v7, 16, v6
  v_cmp_gt_u32 vcc, 0x100, v7
  v_sub_f32 v36, v36, v221
  s_nop 0
  v_cndmask_b32 v36, v12, v36, vcc
  v_exp_f32 v36, v36
  v_add_u32 v7, 15, v6
  v_cmp_gt_u32 vcc, 0x100, v7
  v_sub_f32 v37, v37, v221
  s_nop 0
  v_cndmask_b32 v37, v12, v37, vcc
  v_exp_f32 v37, v37
  v_add_u32 v7, 14, v6
  v_cmp_gt_u32 vcc, 0x100, v7
  v_sub_f32 v38, v38, v221
  s_nop 0
  v_cndmask_b32 v38, v12, v38, vcc
  v_exp_f32 v38, v38
  v_add_u32 v7, 13, v6
  v_cmp_gt_u32 vcc, 0x100, v7
  v_sub_f32 v39, v39, v221
  s_nop 0
  v_cndmask_b32 v39, v12, v39, vcc
  v_exp_f32 v39, v39
  s_nop 0
  v_cvt_pk_bf16_f32 v208, v32, v33
  v_cvt_pk_bf16_f32 v209, v34, v35
  v_cvt_pk_bf16_f32 v210, v36, v37
  v_cvt_pk_bf16_f32 v211, v38, v39
  s_nop 1
  v_mfma_f32_16x16x32_bf16 v[124:127], v[64:67], v[208:211], v[124:127]
  v_mfma_f32_16x16x32_bf16 v[128:131], v[68:71], v[208:211], v[128:131]
  v_mfma_f32_16x16x32_bf16 v[132:135], v[216:219], v[208:211], v[132:135]
  v_mfma_f32_16x16x32_bf16 v[32:35], v[48:51], v[24:27], 0
  v_mfma_f32_16x16x32_bf16 v[36:39], v[52:55], v[24:27], 0
  s_nop 7
  v_add_u32 v7, 16, v11
  v_cmp_gt_u32 vcc, 0x100, v7
  v_sub_f32 v32, v32, v222
  s_nop 0
  v_cndmask_b32 v32, v12, v32, vcc
  v_exp_f32 v32, v32
  v_add_u32 v7, 15, v11
  v_cmp_gt_u32 vcc, 0x100, v7
  v_sub_f32 v33, v33, v222
  s_nop 0
  v_cndmask_b32 v33, v12, v33, vcc
  v_exp_f32 v33, v33
  v_add_u32 v7, 14, v11
  v_cmp_gt_u32 vcc, 0x100, v7
  v_sub_f32 v34, v34, v222
  s_nop 0
  v_cndmask_b32 v34, v12, v34, vcc
  v_exp_f32 v34, v34
  v_add_u32 v7, 13, v11
  v_cmp_gt_u32 vcc, 0x100, v7
  v_sub_f32 v35, v35, v222
  s_nop 0
  v_cndmask_b32 v35, v12, v35, vcc
  v_exp_f32 v35, v35
  v_add_u32 v7, 0, v11
  v_cmp_gt_u32 vcc, 0x100, v7
  v_sub_f32 v36, v36, v222
  s_nop 0
  v_cndmask_b32 v36, v12, v36, vcc
  v_exp_f32 v36, v36
  v_add_u32 v7, -1, v11
  v_cmp_gt_u32 vcc, 0x100, v7
  v_sub_f32 v37, v37, v222
  s_nop 0
  v_cndmask_b32 v37, v12, v37, vcc
  v_exp_f32 v37, v37
  v_add_u32 v7, -2, v11
  v_cmp_gt_u32 vcc, 0x100, v7
  v_sub_f32 v38, v38, v222
  s_nop 0
  v_cndmask_b32 v38, v12, v38, vcc
  v_exp_f32 v38, v38
  v_add_u32 v7, -3, v11
  v_cmp_gt_u32 vcc, 0x100, v7
  v_sub_f32 v39, v39, v222
  s_nop 0
  v_cndmask_b32 v39, v12, v39, vcc
  v_exp_f32 v39, v39
  s_nop 0
  v_cvt_pk_bf16_f32 v208, v32, v33
  v_cvt_pk_bf16_f32 v209, v34, v35
  v_cvt_pk_bf16_f32 v210, v36, v37
  v_cvt_pk_bf16_f32 v211, v38, v39
  s_nop 1
  v_mfma_f32_16x16x32_bf16 v[136:139], v[64:67], v[208:211], v[136:139]
  v_mfma_f32_16x16x32_bf16 v[140:143], v[68:71], v[208:211], v[140:143]
  v_mfma_f32_16x16x32_bf16 v[144:147], v[216:219], v[208:211], v[144:147]
  v_mfma_f32_16x16x32_bf16 v[32:35], v[48:51], v[28:31], 0
  v_mfma_f32_16x16x32_bf16 v[36:39], v[52:55], v[28:31], 0
  s_nop 7
  v_add_u32 v7, 32, v11
  v_cmp_gt_u32 vcc, 0x100, v7
  v_sub_f32 v32, v32, v223
  s_nop 0
  v_cndmask_b32 v32, v12, v32, vcc
  v_exp_f32 v32, v32
  v_add_u32 v7, 31, v11
  v_cmp_gt_u32 vcc, 0x100, v7
  v_sub_f32 v33, v33, v223
  s_nop 0
  v_cndmask_b32 v33, v12, v33, vcc
  v_exp_f32 v33, v33
  v_add_u32 v7, 30, v11
  v_cmp_gt_u32 vcc, 0x100, v7
  v_sub_f32 v34, v34, v223
  s_nop 0
  v_cndmask_b32 v34, v12, v34, vcc
  v_exp_f32 v34, v34
  v_add_u32 v7, 29, v11
  v_cmp_gt_u32 vcc, 0x100, v7
  v_sub_f32 v35, v35, v223
  s_nop 0
  v_cndmask_b32 v35, v12, v35, vcc
  v_exp_f32 v35, v35
  v_add_u32 v7, 16, v11
  v_cmp_gt_u32 vcc, 0x100, v7
  v_sub_f32 v36, v36, v223
  s_nop 0
  v_cndmask_b32 v36, v12, v36, vcc
  v_exp_f32 v36, v36
  v_add_u32 v7, 15, v11
  v_cmp_gt_u32 vcc, 0x100, v7
  v_sub_f32 v37, v37, v223
  s_nop 0
  v_cndmask_b32 v37, v12, v37, vcc
  v_exp_f32 v37, v37
  v_add_u32 v7, 14, v11
  v_cmp_gt_u32 vcc, 0x100, v7
  v_sub_f32 v38, v38, v223
  s_nop 0
  v_cndmask_b32 v38, v12, v38, vcc
  v_exp_f32 v38, v38
  v_add_u32 v7, 13, v11
  v_cmp_gt_u32 vcc, 0x100, v7
  v_sub_f32 v39, v39, v223
  s_nop 0
  v_cndmask_b32 v39, v12, v39, vcc
  v_exp_f32 v39, v39
  s_nop 0
  v_cvt_pk_bf16_f32 v208, v32, v33
  v_cvt_pk_bf16_f32 v209, v34, v35
  v_cvt_pk_bf16_f32 v210, v36, v37
  v_cvt_pk_bf16_f32 v211, v38, v39
  s_nop 1
  v_mfma_f32_16x16x32_bf16 v[148:151], v[64:67], v[208:211], v[148:151]
  v_mfma_f32_16x16x32_bf16 v[152:155], v[68:71], v[208:211], v[152:155]
  v_mfma_f32_16x16x32_bf16 v[156:159], v[216:219], v[208:211], v[156:159]
  s_add_u32 s59, s59, 2
  s_cmp_lt_u32 s59, 24
  s_cbranch_scc1 Lf2102
  s_nop 7
  s_branch Lok103
Lfin94:
Lok103:
  v_rcp_f32 v156, v156
  s_nop 0
  v_pk_mul_f32 v[148:149], v[148:149], v[156:157] op_sel_hi:[1,0]
  v_pk_mul_f32 v[150:151], v[150:151], v[156:157] op_sel_hi:[1,0]
  v_pk_mul_f32 v[152:153], v[152:153], v[156:157] op_sel_hi:[1,0]
  v_pk_mul_f32 v[154:155], v[154:155], v[156:157] op_sel_hi:[1,0]
  v_cvt_pk_bf16_f32 v148, v148, v149
  v_cvt_pk_bf16_f32 v149, v150, v151
  v_cvt_pk_bf16_f32 v150, v152, v153
  v_cvt_pk_bf16_f32 v151, v154, v155
  buffer_store_dwordx4 v[148:151], v13, s[28:31], s45 offen offset:2048 sc1
  v_rcp_f32 v144, v144
  s_nop 0
  v_pk_mul_f32 v[136:137], v[136:137], v[144:145] op_sel_hi:[1,0]
  v_pk_mul_f32 v[138:139], v[138:139], v[144:145] op_sel_hi:[1,0]
  v_pk_mul_f32 v[140:141], v[140:141], v[144:145] op_sel_hi:[1,0]
  v_pk_mul_f32 v[142:143], v[142:143], v[144:145] op_sel_hi:[1,0]
  v_cvt_pk_bf16_f32 v136, v136, v137
  v_cvt_pk_bf16_f32 v137, v138, v139
  v_cvt_pk_bf16_f32 v138, v140, v141
  v_cvt_pk_bf16_f32 v139, v142, v143
  buffer_store_dwordx4 v[136:139], v13, s[28:31], s45 offen offset:0 sc1
  v_rcp_f32 v120, v120
  s_nop 0
  v_pk_mul_f32 v[112:113], v[112:113], v[120:121] op_sel_hi:[1,0]
  v_pk_mul_f32 v[114:115], v[114:115], v[120:121] op_sel_hi:[1,0]
  v_pk_mul_f32 v[116:117], v[116:117], v[120:121] op_sel_hi:[1,0]
  v_pk_mul_f32 v[118:119], v[118:119], v[120:121] op_sel_hi:[1,0]
  v_cvt_pk_bf16_f32 v112, v112, v113
  v_cvt_pk_bf16_f32 v113, v114, v115
  v_cvt_pk_bf16_f32 v114, v116, v117
  v_cvt_pk_bf16_f32 v115, v118, v119
  buffer_store_dwordx4 v[112:115], v13, s[28:31], s44 offen offset:0 sc1
  v_rcp_f32 v132, v132
  s_nop 0
  v_pk_mul_f32 v[124:125], v[124:125], v[132:133] op_sel_hi:[1,0]
  v_pk_mul_f32 v[126:127], v[126:127], v[132:133] op_sel_hi:[1,0]
  v_pk_mul_f32 v[128:129], v[128:129], v[132:133] op_sel_hi:[1,0]
  v_pk_mul_f32 v[130:131], v[130:131], v[132:133] op_sel_hi:[1,0]
  v_cvt_pk_bf16_f32 v124, v124, v125
  v_cvt_pk_bf16_f32 v125, v126, v127
  v_cvt_pk_bf16_f32 v126, v128, v129
  v_cvt_pk_bf16_f32 v127, v130, v131
  buffer_store_dwordx4 v[124:127], v13, s[28:31], s44 offen offset:2048 sc1
  s_mov_b32 s59, 0x21800000
  s_mov_b32 s60, 0x5d800000
  v_min3_f32 v5, v122, v134, v146
  v_max3_f32 v6, v122, v134, v146
  v_min_f32 v5, v5, v158
  v_max_f32 v6, v6, v158
  v_cmp_nle_f32 s[62:63], s59, v5
  v_cmp_nge_f32 vcc, s60, v6
  s_nop 0
  s_or_b64 s[62:63], s[62:63], vcc
  s_and_b64 s[62:63], s[62:63], s[68:69]
  s_cbranch_scc1 Lfb100
  s_barrier
  ds_write_b128 v14, v[112:115] offset:0
  ds_write_b128 v14, v[124:127] offset:2048
  ds_write_b128 v15, v[136:139] offset:0
  ds_write_b128 v15, v[148:151] offset:2048
  s_cmp_lg_u32 s22, 0
  s_cbranch_scc1 Lsw104
  s_waitcnt vmcnt(4)
  v_permlane16_swap_b32 v232, v234
  v_permlane16_swap_b32 v233, v235
  v_permlane16_swap_b32 v236, v238
  v_permlane16_swap_b32 v237, v239
  v_permlane16_swap_b32 v240, v242
  v_permlane16_swap_b32 v241, v243
  v_permlane16_swap_b32 v244, v246
  v_permlane16_swap_b32 v245, v247
Lsw104:
  v_lshrrev_b32 v184, 4, v1
  v_bfe_u32 v185, v1, 2, 2
  v_and_b32 v186, 3, v1
  v_and_b32 v187, 1, v184
  v_lshl_add_u32 v187, v187, 2, v185
  v_lshrrev_b32 v188, 1, v184
  v_mul_u32_u24 v188, 1024, v188
  v_lshl_add_u32 v188, v187, 7, v188
  v_lshl_add_u32 v188, v186, 3, v188
  v_add_u32 v188, 98304, v188
  v_lshrrev_b32 v189, 1, v187
  s_lshl_b32 s38, s36, 13
  v_lshl_add_u32 v2, v1, 4, s38
  v_add_u32 v3, 1024, v2
  v_add_u32 v2, 49152, v2
  s_lshl_b32 s39, s37, 1
  s_add_u32 s39, s39, 0
  v_xor_b32 v176, s39, v189
  v_lshl_add_u32 v4, v176, 5, v188
  s_lshl_b32 s39, s37, 1
  s_add_u32 s39, s39, 1
  v_xor_b32 v176, s39, v189
  v_lshl_add_u32 v5, v176, 5, v188
  v_lshlrev_b32 v16, 16, v232
  v_and_b32 v17, 0xffff0000, v232
  v_lshlrev_b32 v18, 16, v233
  v_and_b32 v19, 0xffff0000, v233
  v_lshlrev_b32 v32, 16, v234
  v_and_b32 v33, 0xffff0000, v234
  v_lshlrev_b32 v34, 16, v235
  v_and_b32 v35, 0xffff0000, v235
  v_lshlrev_b32 v20, 16, v236
  v_and_b32 v21, 0xffff0000, v236
  v_lshlrev_b32 v22, 16, v237
  v_and_b32 v23, 0xffff0000, v237
  v_lshlrev_b32 v36, 16, v238
  v_and_b32 v37, 0xffff0000, v238
  v_lshlrev_b32 v38, 16, v239
  v_and_b32 v39, 0xffff0000, v239
  v_lshlrev_b32 v24, 16, v240
  v_and_b32 v25, 0xffff0000, v240
  v_lshlrev_b32 v26, 16, v241
  v_and_b32 v27, 0xffff0000, v241
  v_lshlrev_b32 v40, 16, v242
  v_and_b32 v41, 0xffff0000, v242
  v_lshlrev_b32 v42, 16, v243
  v_and_b32 v43, 0xffff0000, v243
  v_lshlrev_b32 v28, 16, v244
  v_and_b32 v29, 0xffff0000, v244
  v_lshlrev_b32 v30, 16, v245
  v_and_b32 v31, 0xffff0000, v245
  v_lshlrev_b32 v44, 16, v246
  v_and_b32 v45, 0xffff0000, v246
  v_lshlrev_b32 v46, 16, v247
  v_and_b32 v47, 0xffff0000, v247
  s_mov_b32 s44, 0
  s_mov_b32 s45, 5
  s_mov_b32 s46, 4294918144
  s_mov_b32 s47, 8192
  s_mov_b32 s48, 0
  s_mov_b32 s80, 16384
  s_mov_b32 s81, 4294918144
  s_mov_b32 s82, 8192
  s_mov_b32 s83, 4294885376
  s_waitcnt vmcnt(0) lgkmcnt(0)
  s_barrier
  ds_read_b128 v[48:51], v2 offset:0
  ds_read_b128 v[52:55], v2 offset:2048
  ds_read_b128 v[56:59], v2 offset:4096
  ds_read_b128 v[60:63], v2 offset:6144
  ds_read_b64_tr_b16 v[112:113], v4 offset:0
  ds_read_b64_tr_b16 v[114:115], v4 offset:2048
  ds_read_b64_tr_b16 v[116:117], v5 offset:0
  ds_read_b64_tr_b16 v[118:119], v5 offset:2048
  ds_read_b128 v[64:67], v2 offset:1024
  ds_read_b128 v[68:71], v2 offset:3072
  ds_read_b128 v[72:75], v2 offset:5120
  ds_read_b128 v[76:79], v2 offset:7168
  ds_read_b64_tr_b16 v[120:121], v4 offset:4096
  ds_read_b64_tr_b16 v[122:123], v4 offset:6144
  ds_read_b64_tr_b16 v[124:125], v5 offset:4096
  ds_read_b64_tr_b16 v[126:127], v5 offset:6144
  v_add_u32 v2, s46, v2
  v_add_u32 v4, s47, v4
  v_add_u32 v5, s47, v5
  s_add_u32 s44, s44, 1
  s_cmp_eq_u32 s44, 4
  s_cselect_b32 s44, 0, s44
  s_cselect_b32 s46, s81, s80
  s_add_u32 s45, s45, 1
  s_cmp_eq_u32 s45, 11
  s_cselect_b32 s45, 0, s45
  s_cselect_b32 s47, s83, s82
  v_lshrrev_b32 v184, 4, v1
  v_bfe_u32 v185, v1, 2, 2
  v_and_b32 v186, 3, v1
  v_and_b32 v187, 1, v184
  v_lshl_add_u32 v187, v187, 2, v185
  v_lshrrev_b32 v188, 1, v184
  v_mul_u32_u24 v188, 3072, v188
  v_lshl_add_u32 v188, v187, 7, v188
  v_lshl_add_u32 v188, v186, 3, v188
  v_add_u32 v188, 49152, v188
  v_lshrrev_b32 v189, 1, v187
  s_lshl_b32 s38, s36, 13
  v_lshl_add_u32 v6, v1, 4, s38
  v_add_u32 v7, 1024, v6
  v_lshl_add_u32 v177, v184, 2, v185
  v_lshlrev_b32 v177, 6, v177
  v_lshl_add_u32 v177, v186, 3, v177
  v_add_u32 v177, 52224, v177
  v_and_b32 v178, 1, v184
  s_and_b32 s40, s25, 1
  s_lshl_b32 s40, s40, 1
  s_lshl_b32 s39, s37, 3
  s_add_u32 s39, s39, 0
  s_sub_i32 s39, s39, s40
  s_add_i32 s41, s39, 14
  s_cmp_lt_i32 s39, 0
  s_cselect_b32 s39, s41, s39
  s_cmp_lt_u32 s39, 12
  s_cselect_b64 s[42:43], -1, 0
  s_and_b32 s41, s39, 3
  s_lshr_b32 s39, s39, 2
  s_lshl_b32 s39, s39, 10
  v_cndmask_b32 v176, v178, v189, s[42:43]
  v_cndmask_b32 v179, v177, v188, s[42:43]
  v_xor_b32 v176, s41, v176
  v_lshl_add_u32 v176, v176, 5, v179
  v_add_u32 v224, s39, v176
  s_lshl_b32 s39, s37, 3
  s_add_u32 s39, s39, 1
  s_sub_i32 s39, s39, s40
  s_add_i32 s41, s39, 14
  s_cmp_lt_i32 s39, 0
  s_cselect_b32 s39, s41, s39
  s_cmp_lt_u32 s39, 12
  s_cselect_b64 s[42:43], -1, 0
  s_and_b32 s41, s39, 3
  s_lshr_b32 s39, s39, 2
  s_lshl_b32 s39, s39, 10
  v_cndmask_b32 v176, v178, v189, s[42:43]
  v_cndmask_b32 v179, v177, v188, s[42:43]
  v_xor_b32 v176, s41, v176
  v_lshl_add_u32 v176, v176, 5, v179
  v_add_u32 v225, s39, v176
  s_lshl_b32 s39, s37, 3
  s_add_u32 s39, s39, 2
  s_sub_i32 s39, s39, s40
  s_add_i32 s41, s39, 14
  s_cmp_lt_i32 s39, 0
  s_cselect_b32 s39, s41, s39
  s_cmp_lt_u32 s39, 12
  s_cselect_b64 s[42:43], -1, 0
  s_and_b32 s41, s39, 3
  s_lshr_b32 s39, s39, 2
  s_lshl_b32 s39, s39, 10
  v_cndmask_b32 v176, v178, v189, s[42:43]
  v_cndmask_b32 v179, v177, v188, s[42:43]
  v_xor_b32 v176, s41, v176
  v_lshl_add_u32 v176, v176, 5, v179
  v_add_u32 v226, s39, v176
  s_lshl_b32 s39, s37, 3
  s_add_u32 s39, s39, 3
  s_sub_i32 s39, s39, s40
  s_add_i32 s41, s39, 14
  s_cmp_lt_i32 s39, 0
  s_cselect_b32 s39, s41, s39
  s_cmp_lt_u32 s39, 12
  s_cselect_b64 s[42:43], -1, 0
  s_and_b32 s41, s39, 3
  s_lshr_b32 s39, s39, 2
  s_lshl_b32 s39, s39, 10
  v_cndmask_b32 v176, v178, v189, s[42:43]
  v_cndmask_b32 v179, v177, v188, s[42:43]
  v_xor_b32 v176, s41, v176
  v_lshl_add_u32 v176, v176, 5, v179
  v_add_u32 v227, s39, v176
  s_lshl_b32 s39, s37, 3
  s_add_u32 s39, s39, 4
  s_sub_i32 s39, s39, s40
  s_add_i32 s41, s39, 14
  s_cmp_lt_i32 s39, 0
  s_cselect_b32 s39, s41, s39
  s_cmp_lt_u32 s39, 12
  s_cselect_b64 s[42:43], -1, 0
  s_and_b32 s41, s39, 3
  s_lshr_b32 s39, s39, 2
  s_lshl_b32 s39, s39, 10
  v_cndmask_b32 v176, v178, v189, s[42:43]
  v_cndmask_b32 v179, v177, v188, s[42:43]
  v_xor_b32 v176, s41, v176
  v_lshl_add_u32 v176, v176, 5, v179
  v_add_u32 v228, s39, v176
  s_lshl_b32 s39, s37, 3
  s_add_u32 s39, s39, 5
  s_sub_i32 s39, s39, s40
  s_add_i32 s41, s39, 14
  s_cmp_lt_i32 s39, 0
  s_cselect_b32 s39, s41, s39
  s_cmp_lt_u32 s39, 12
  s_cselect_b64 s[42:43], -1, 0
  s_and_b32 s41, s39, 3
  s_lshr_b32 s39, s39, 2
  s_lshl_b32 s39, s39, 10
  v_cndmask_b32 v176, v178, v189, s[42:43]
  v_cndmask_b32 v179, v177, v188, s[42:43]
  v_xor_b32 v176, s41, v176
  v_lshl_add_u32 v176, v176, 5, v179
  v_add_u32 v229, s39, v176
  s_add_u32 s39, s37, 6
  s_sub_i32 s39, s39, s40
  s_add_i32 s41, s39, 14
  s_cmp_lt_i32 s39, 0
  s_cselect_b32 s39, s41, s39
  s_cmp_lt_u32 s39, 12
  s_cselect_b64 s[42:43], -1, 0
  s_and_b32 s41, s39, 3
  s_lshr_b32 s39, s39, 2
  s_lshl_b32 s39, s39, 10
  v_cndmask_b32 v176, v178, v189, s[42:43]
  v_cndmask_b32 v179, v177, v188, s[42:43]
  v_xor_b32 v176, s41, v176
  v_lshl_add_u32 v176, v176, 5, v179
  v_add_u32 v230, s39, v176
  s_barrier
  s_waitcnt lgkmcnt(0)
.p2align 6
Lg105:
  s_barrier
  v_mfma_f32_16x16x32_bf16 v[16:19], v[112:115], v[48:51], v[16:19]
  ds_read_b128 v[80:83], v2 offset:0
  ds_read_b128 v[84:87], v2 offset:2048
  v_mfma_f32_16x16x32_bf16 v[16:19], v[120:123], v[64:67], v[16:19]
  ds_read_b128 v[88:91], v2 offset:4096
  ds_read_b128 v[92:95], v2 offset:6144
  v_mfma_f32_16x16x32_bf16 v[20:23], v[120:123], v[68:71], v[20:23]
  ds_read_b64_tr_b16 v[128:129], v4 offset:0
  ds_read_b64_tr_b16 v[130:131], v4 offset:2048
  v_mfma_f32_16x16x32_bf16 v[20:23], v[112:115], v[52:55], v[20:23]
  ds_read_b64_tr_b16 v[132:133], v5 offset:0
  ds_read_b64_tr_b16 v[134:135], v5 offset:2048
  v_mfma_f32_16x16x32_bf16 v[24:27], v[112:115], v[56:59], v[24:27]
  ds_read_b128 v[96:99], v2 offset:1024
  ds_read_b128 v[100:103], v2 offset:3072
  v_mfma_f32_16x16x32_bf16 v[24:27], v[120:123], v[72:75], v[24:27]
  ds_read_b128 v[104:107], v2 offset:5120
  ds_read_b128 v[108:111], v2 offset:7168
  v_mfma_f32_16x16x32_bf16 v[28:31], v[120:123], v[76:79], v[28:31]
  ds_read_b64_tr_b16 v[136:137], v4 offset:4096
  ds_read_b64_tr_b16 v[138:139], v4 offset:6144
  v_mfma_f32_16x16x32_bf16 v[28:31], v[112:115], v[60:63], v[28:31]
  ds_read_b64_tr_b16 v[140:141], v5 offset:4096
  ds_read_b64_tr_b16 v[142:143], v5 offset:6144
  v_mfma_f32_16x16x32_bf16 v[44:47], v[116:119], v[60:63], v[44:47]
  v_add_u32 v2, s46, v2
  v_add_u32 v4, s47, v4
  v_add_u32 v5, s47, v5
  v_mfma_f32_16x16x32_bf16 v[44:47], v[124:127], v[76:79], v[44:47]
  s_add_u32 s44, s44, 1
  s_cmp_eq_u32 s44, 4
  v_mfma_f32_16x16x32_bf16 v[40:43], v[124:127], v[72:75], v[40:43]
  s_cselect_b32 s44, 0, s44
  s_cselect_b32 s46, s81, s80
  v_mfma_f32_16x16x32_bf16 v[40:43], v[116:119], v[56:59], v[40:43]
  s_add_u32 s45, s45, 1
  s_cmp_eq_u32 s45, 11
  v_mfma_f32_16x16x32_bf16 v[36:39], v[116:119], v[52:55], v[36:39]
  s_cselect_b32 s45, 0, s45
  s_cselect_b32 s47, s83, s82
  v_mfma_f32_16x16x32_bf16 v[36:39], v[124:127], v[68:71], v[36:39]
  v_mfma_f32_16x16x32_bf16 v[32:35], v[124:127], v[64:67], v[32:35]
  s_waitcnt lgkmcnt(0)
  v_mfma_f32_16x16x32_bf16 v[32:35], v[116:119], v[48:51], v[32:35]
  s_barrier
  v_mfma_f32_16x16x32_bf16 v[16:19], v[128:131], v[80:83], v[16:19]
  ds_read_b128 v[48:51], v2 offset:0
  ds_read_b128 v[52:55], v2 offset:2048
  v_mfma_f32_16x16x32_bf16 v[16:19], v[136:139], v[96:99], v[16:19]
  ds_read_b128 v[56:59], v2 offset:4096
  ds_read_b128 v[60:63], v2 offset:6144
  v_mfma_f32_16x16x32_bf16 v[20:23], v[136:139], v[100:103], v[20:23]
  ds_read_b64_tr_b16 v[112:113], v4 offset:0
  ds_read_b64_tr_b16 v[114:115], v4 offset:2048
  v_mfma_f32_16x16x32_bf16 v[20:23], v[128:131], v[84:87], v[20:23]
  ds_read_b64_tr_b16 v[116:117], v5 offset:0
  ds_read_b64_tr_b16 v[118:119], v5 offset:2048
  v_mfma_f32_16x16x32_bf16 v[24:27], v[128:131], v[88:91], v[24:27]
  ds_read_b128 v[64:67], v2 offset:1024
  ds_read_b128 v[68:71], v2 offset:3072
  v_mfma_f32_16x16x32_bf16 v[24:27], v[136:139], v[104:107], v[24:27]
  ds_read_b128 v[72:75], v2 offset:5120
  ds_read_b128 v[76:79], v2 offset:7168
  v_mfma_f32_16x16x32_bf16 v[28:31], v[136:139], v[108:111], v[28:31]
  ds_read_b64_tr_b16 v[120:121], v4 offset:4096
  ds_read_b64_tr_b16 v[122:123], v4 offset:6144
  v_mfma_f32_16x16x32_bf16 v[28:31], v[128:131], v[92:95], v[28:31]
  ds_read_b64_tr_b16 v[124:125], v5 offset:4096
  ds_read_b64_tr_b16 v[126:127], v5 offset:6144
  v_mfma_f32_16x16x32_bf16 v[44:47], v[132:135], v[92:95], v[44:47]
  v_add_u32 v2, s46, v2
  v_add_u32 v4, s47, v4
  v_add_u32 v5, s47, v5
  v_mfma_f32_16x16x32_bf16 v[44:47], v[140:143], v[108:111], v[44:47]
  s_add_u32 s44, s44, 1
  s_cmp_eq_u32 s44, 4
  v_mfma_f32_16x16x32_bf16 v[40:43], v[140:143], v[104:107], v[40:43]
  s_cselect_b32 s44, 0, s44
  s_cselect_b32 s46, s81, s80
  v_mfma_f32_16x16x32_bf16 v[40:43], v[132:135], v[88:91], v[40:43]
  s_add_u32 s45, s45, 1
  s_cmp_eq_u32 s45, 11
  v_mfma_f32_16x16x32_bf16 v[36:39], v[132:135], v[84:87], v[36:39]
  s_cselect_b32 s45, 0, s45
  s_cselect_b32 s47, s83, s82
  v_mfma_f32_16x16x32_bf16 v[36:39], v[140:143], v[100:103], v[36:39]
  s_add_u32 s48, s48, 1
  s_cmp_lt_u32 s48, 7
  v_mfma_f32_16x16x32_bf16 v[32:35], v[140:143], v[96:99], v[32:35]
  s_waitcnt lgkmcnt(0)
  v_mfma_f32_16x16x32_bf16 v[32:35], v[132:135], v[80:83], v[32:35]
  s_cbranch_scc1 Lg105
  s_barrier
  v_mfma_f32_16x16x32_bf16 v[16:19], v[112:115], v[48:51], v[16:19]
  ds_read_b128 v[80:83], v2 offset:0
  ds_read_b128 v[84:87], v2 offset:2048
  v_mfma_f32_16x16x32_bf16 v[16:19], v[120:123], v[64:67], v[16:19]
  ds_read_b128 v[88:91], v2 offset:4096
  ds_read_b128 v[92:95], v2 offset:6144
  v_mfma_f32_16x16x32_bf16 v[20:23], v[120:123], v[68:71], v[20:23]
  ds_read_b64_tr_b16 v[128:129], v4 offset:0
  ds_read_b64_tr_b16 v[130:131], v4 offset:2048
  v_mfma_f32_16x16x32_bf16 v[20:23], v[112:115], v[52:55], v[20:23]
  ds_read_b64_tr_b16 v[132:133], v5 offset:0
  ds_read_b64_tr_b16 v[134:135], v5 offset:2048
  v_mfma_f32_16x16x32_bf16 v[24:27], v[112:115], v[56:59], v[24:27]
  ds_read_b128 v[96:99], v2 offset:1024
  ds_read_b128 v[100:103], v2 offset:3072
  v_mfma_f32_16x16x32_bf16 v[24:27], v[120:123], v[72:75], v[24:27]
  ds_read_b128 v[104:107], v2 offset:5120
  ds_read_b128 v[108:111], v2 offset:7168
  v_mfma_f32_16x16x32_bf16 v[28:31], v[120:123], v[76:79], v[28:31]
  ds_read_b64_tr_b16 v[136:137], v4 offset:4096
  ds_read_b64_tr_b16 v[138:139], v4 offset:6144
  v_mfma_f32_16x16x32_bf16 v[28:31], v[112:115], v[60:63], v[28:31]
  ds_read_b64_tr_b16 v[140:141], v5 offset:4096
  ds_read_b64_tr_b16 v[142:143], v5 offset:6144
  v_mfma_f32_16x16x32_bf16 v[44:47], v[116:119], v[60:63], v[44:47]
  s_lshl_b32 s51, s37, 10
  s_add_u32 s51, s51, s38
  v_mfma_f32_16x16x32_bf16 v[44:47], v[124:127], v[76:79], v[44:47]
  s_add_u32 s39, s72, s51
  s_add_u32 s39, s39, s38
  v_mfma_f32_16x16x32_bf16 v[40:43], v[124:127], v[72:75], v[40:43]
  s_add_u32 s50, s39, s23
  s_add_u32 s50, s50, 8388608
  v_mfma_f32_16x16x32_bf16 v[40:43], v[116:119], v[56:59], v[40:43]
  v_lshlrev_b32 v13, 4, v1
  v_add_u32 v12, s51, v13
  v_mfma_f32_16x16x32_bf16 v[36:39], v[116:119], v[52:55], v[36:39]
  v_add_u32 v11, 4096, v12
  s_add_u32 s51, s50, 4096
  v_mfma_f32_16x16x32_bf16 v[36:39], v[124:127], v[68:71], v[36:39]
  v_mfma_f32_16x16x32_bf16 v[32:35], v[124:127], v[64:67], v[32:35]
  s_waitcnt lgkmcnt(0)
  v_mfma_f32_16x16x32_bf16 v[32:35], v[116:119], v[48:51], v[32:35]
  v_mfma_f32_16x16x32_bf16 v[28:31], v[136:139], v[108:111], v[28:31]
  v_mfma_f32_16x16x32_bf16 v[28:31], v[128:131], v[92:95], v[28:31]
  v_mfma_f32_16x16x32_bf16 v[44:47], v[132:135], v[92:95], v[44:47]
  v_mfma_f32_16x16x32_bf16 v[44:47], v[140:143], v[108:111], v[44:47]
  v_mfma_f32_16x16x32_bf16 v[24:27], v[128:131], v[88:91], v[24:27]
  v_mfma_f32_16x16x32_bf16 v[24:27], v[136:139], v[104:107], v[24:27]
  v_mfma_f32_16x16x32_bf16 v[40:43], v[140:143], v[104:107], v[40:43]
  v_mfma_f32_16x16x32_bf16 v[40:43], v[132:135], v[88:91], v[40:43]
  v_mfma_f32_16x16x32_bf16 v[20:23], v[136:139], v[100:103], v[20:23]
  v_mfma_f32_16x16x32_bf16 v[20:23], v[128:131], v[84:87], v[20:23]
  v_mfma_f32_16x16x32_bf16 v[36:39], v[132:135], v[84:87], v[36:39]
  v_cvt_pk_bf16_f32 v244, v28, v29
  v_cvt_pk_bf16_f32 v245, v30, v31
  v_mfma_f32_16x16x32_bf16 v[36:39], v[140:143], v[100:103], v[36:39]
  v_cvt_pk_bf16_f32 v246, v44, v45
  v_cvt_pk_bf16_f32 v247, v46, v47
  v_mfma_f32_16x16x32_bf16 v[16:19], v[128:131], v[80:83], v[16:19]
  buffer_store_dwordx4 v[244:247], v13, s[28:31], s51 offen offset:2048 sc1
  v_cvt_pk_bf16_f32 v240, v24, v25
  v_mfma_f32_16x16x32_bf16 v[16:19], v[136:139], v[96:99], v[16:19]
  v_cvt_pk_bf16_f32 v241, v26, v27
  v_cvt_pk_bf16_f32 v242, v40, v41
  v_mfma_f32_16x16x32_bf16 v[32:35], v[140:143], v[96:99], v[32:35]
  v_cvt_pk_bf16_f32 v243, v42, v43
  buffer_store_dwordx4 v[240:243], v13, s[28:31], s51 offen offset:0 sc1
  v_mfma_f32_16x16x32_bf16 v[32:35], v[132:135], v[80:83], v[32:35]
  v_cvt_pk_bf16_f32 v236, v20, v21
  v_cvt_pk_bf16_f32 v237, v22, v23
  v_cvt_pk_bf16_f32 v238, v36, v37
  v_cvt_pk_bf16_f32 v239, v38, v39
  buffer_store_dwordx4 v[236:239], v13, s[28:31], s50 offen offset:2048 sc1
  s_nop 2
  v_cvt_pk_bf16_f32 v232, v16, v17
  v_cvt_pk_bf16_f32 v233, v18, v19
  v_cvt_pk_bf16_f32 v234, v32, v33
  v_cvt_pk_bf16_f32 v235, v34, v35
  buffer_store_dwordx4 v[232:235], v13, s[28:31], s50 offen offset:0 sc1
  s_barrier
  ds_write_b128 v12, v[232:235] offset:0
  ds_write_b128 v12, v[236:239] offset:2048
  ds_write_b128 v11, v[240:243] offset:0
  ds_write_b128 v11, v[244:247] offset:2048
  s_mov_b32 s43, 0x3f803f80
  s_add_u32 s42, s76, s23
  s_add_u32 s42, s42, 41943040
  v_dot2_f32_bf16 v152, v232, s43, 0
  v_dot2_f32_bf16 v156, v232, v232, 0
  v_dot2_f32_bf16 v153, v236, s43, 0
  v_dot2_f32_bf16 v157, v236, v236, 0
  v_dot2_f32_bf16 v154, v240, s43, 0
  v_dot2_f32_bf16 v158, v240, v240, 0
  v_dot2_f32_bf16 v155, v244, s43, 0
  v_dot2_f32_bf16 v159, v244, v244, 0
  v_dot2_f32_bf16 v152, v233, s43, v152
  v_dot2_f32_bf16 v156, v233, v233, v156
  v_dot2_f32_bf16 v153, v237, s43, v153
  v_dot2_f32_bf16 v157, v237, v237, v157
  v_dot2_f32_bf16 v154, v241, s43, v154
  v_dot2_f32_bf16 v158, v241, v241, v158
  v_dot2_f32_bf16 v155, v245, s43, v155
  v_dot2_f32_bf16 v159, v245, v245, v159
  v_dot2_f32_bf16 v152, v234, s43, v152
  v_dot2_f32_bf16 v156, v234, v234, v156
  v_dot2_f32_bf16 v153, v238, s43, v153
  v_dot2_f32_bf16 v157, v238, v238, v157
  v_dot2_f32_bf16 v154, v242, s43, v154
  v_dot2_f32_bf16 v158, v242, v242, v158
  v_dot2_f32_bf16 v155, v246, s43, v155
  v_dot2_f32_bf16 v159, v246, v246, v159
  v_dot2_f32_bf16 v152, v235, s43, v152
  v_dot2_f32_bf16 v156, v235, v235, v156
  v_dot2_f32_bf16 v153, v239, s43, v153
  v_dot2_f32_bf16 v157, v239, v239, v157
  v_dot2_f32_bf16 v154, v243, s43, v154
  v_dot2_f32_bf16 v158, v243, v243, v158
  v_dot2_f32_bf16 v155, v247, s43, v155
  v_dot2_f32_bf16 v159, v247, v247, v159
  v_lshlrev_b32 v14, 3, v1
  s_nop 2
  v_permlane32_swap_b32 v152, v154
  v_permlane32_swap_b32 v153, v155
  v_permlane32_swap_b32 v156, v158
  v_permlane32_swap_b32 v157, v159
  v_add_f32 v152, v152, v154
  v_add_f32 v153, v153, v155
  v_add_f32 v156, v156, v158
  v_add_f32 v157, v157, v159
  v_permlane16_swap_b32 v152, v153
  s_nop 0
  v_permlane16_swap_b32 v156, v157
  v_add_f32 v152, v152, v153
  v_add_f32 v153, v156, v157
  buffer_store_dwordx2 v[152:153], v14, s[28:31], s42 offen sc1
  s_mov_b32 s44, 1
  s_mov_b32 s45, 1
  s_mov_b32 s46, 16384
  s_mov_b32 s47, 28672
  s_mov_b32 s48, 0
  s_mov_b32 s80, 16384
  s_mov_b32 s81, 4294934528
  s_mov_b32 s82, 28672
  s_mov_b32 s83, 4294909952
  s_waitcnt vmcnt(1) lgkmcnt(0)
  s_barrier
  ds_read_b64_tr_b16 v[192:193], v224 offset:0
  ds_read_b128 v[128:131], v6 offset:0
  ds_read_b64_tr_b16 v[194:195], v224 offset:7168
  ds_read_b128 v[144:147], v6 offset:1024
  ds_read_b64_tr_b16 v[196:197], v224 offset:14336
  ds_read_b64_tr_b16 v[198:199], v224 offset:21504
  ds_read_b128 v[132:135], v6 offset:2048
  ds_read_b128 v[148:151], v6 offset:3072
  ds_read_b64_tr_b16 v[200:201], v225 offset:0
  ds_read_b128 v[136:139], v6 offset:4096
  ds_read_b64_tr_b16 v[202:203], v225 offset:7168
  ds_read_b128 v[152:155], v6 offset:5120
  ds_read_b128 v[140:143], v6 offset:6144
  ds_read_b64_tr_b16 v[204:205], v225 offset:14336
  ds_read_b128 v[156:159], v6 offset:7168
  ds_read_b64_tr_b16 v[206:207], v225 offset:21504
  s_waitcnt lgkmcnt(10)
  v_mfma_f32_16x16x32_bf16 v[16:19], v[192:195], v[128:131], 0
  ds_read_b64_tr_b16 v[208:209], v226 offset:0
  v_mfma_f32_16x16x32_bf16 v[16:19], v[196:199], v[144:147], v[16:19]
  ds_read_b64_tr_b16 v[210:211], v226 offset:7168
  s_waitcnt lgkmcnt(10)
  v_mfma_f32_16x16x32_bf16 v[20:23], v[196:199], v[148:151], 0
  ds_read_b64_tr_b16 v[212:213], v226 offset:14336
  v_mfma_f32_16x16x32_bf16 v[20:23], v[192:195], v[132:135], v[20:23]
  ds_read_b64_tr_b16 v[214:215], v226 offset:21504
  s_waitcnt lgkmcnt(8)
  v_mfma_f32_16x16x32_bf16 v[24:27], v[192:195], v[136:139], 0
  v_add_u32 v224, s47, v224
  v_mfma_f32_16x16x32_bf16 v[24:27], v[196:199], v[152:155], v[24:27]
  v_add_u32 v6, s46, v6
  s_waitcnt lgkmcnt(5)
  v_mfma_f32_16x16x32_bf16 v[28:31], v[196:199], v[156:159], 0
  v_add_u32 v225, s47, v225
  v_mfma_f32_16x16x32_bf16 v[28:31], v[192:195], v[140:143], v[28:31]
  v_add_u32 v226, s47, v226
  s_waitcnt lgkmcnt(4)
  v_mfma_f32_16x16x32_bf16 v[44:47], v[200:203], v[140:143], 0
  ds_read_b64_tr_b16 v[192:193], v227 offset:0
  v_mfma_f32_16x16x32_bf16 v[44:47], v[204:207], v[156:159], v[44:47]
  ds_read_b64_tr_b16 v[194:195], v227 offset:7168
  v_mfma_f32_16x16x32_bf16 v[40:43], v[204:207], v[152:155], 0
  ds_read_b64_tr_b16 v[196:197], v227 offset:14336
  v_mfma_f32_16x16x32_bf16 v[40:43], v[200:203], v[136:139], v[40:43]
  ds_read_b64_tr_b16 v[198:199], v227 offset:21504
  v_mfma_f32_16x16x32_bf16 v[36:39], v[200:203], v[132:135], 0
  v_add_u32 v227, s47, v227
  v_mfma_f32_16x16x32_bf16 v[36:39], v[204:207], v[148:151], v[36:39]
  v_mfma_f32_16x16x32_bf16 v[32:35], v[204:207], v[144:147], 0
  v_mfma_f32_16x16x32_bf16 v[32:35], v[200:203], v[128:131], v[32:35]
  s_waitcnt lgkmcnt(4)
  v_mfma_f32_16x16x32_bf16 v[48:51], v[208:211], v[128:131], 0
  ds_read_b64_tr_b16 v[200:201], v228 offset:0
  v_mfma_f32_16x16x32_bf16 v[48:51], v[212:215], v[144:147], v[48:51]
  ds_read_b64_tr_b16 v[202:203], v228 offset:7168
  v_mfma_f32_16x16x32_bf16 v[52:55], v[212:215], v[148:151], 0
  ds_read_b64_tr_b16 v[204:205], v228 offset:14336
  v_mfma_f32_16x16x32_bf16 v[52:55], v[208:211], v[132:135], v[52:55]
  ds_read_b64_tr_b16 v[206:207], v228 offset:21504
  v_mfma_f32_16x16x32_bf16 v[56:59], v[208:211], v[136:139], 0
  v_add_u32 v228, s47, v228
  v_mfma_f32_16x16x32_bf16 v[56:59], v[212:215], v[152:155], v[56:59]
  v_mfma_f32_16x16x32_bf16 v[60:63], v[212:215], v[156:159], 0
  v_mfma_f32_16x16x32_bf16 v[60:63], v[208:211], v[140:143], v[60:63]
  s_waitcnt lgkmcnt(4)
  v_mfma_f32_16x16x32_bf16 v[76:79], v[192:195], v[140:143], 0
  ds_read_b64_tr_b16 v[208:209], v229 offset:0
  v_mfma_f32_16x16x32_bf16 v[76:79], v[196:199], v[156:159], v[76:79]
  ds_read_b64_tr_b16 v[210:211], v229 offset:7168
  v_mfma_f32_16x16x32_bf16 v[72:75], v[196:199], v[152:155], 0
  ds_read_b64_tr_b16 v[212:213], v229 offset:14336
  v_mfma_f32_16x16x32_bf16 v[72:75], v[192:195], v[136:139], v[72:75]
  ds_read_b64_tr_b16 v[214:215], v229 offset:21504
  v_mfma_f32_16x16x32_bf16 v[68:71], v[192:195], v[132:135], 0
  v_add_u32 v229, s47, v229
  v_mfma_f32_16x16x32_bf16 v[68:71], v[196:199], v[148:151], v[68:71]
  v_mfma_f32_16x16x32_bf16 v[64:67], v[196:199], v[144:147], 0
  v_mfma_f32_16x16x32_bf16 v[64:67], v[192:195], v[128:131], v[64:67]
  s_waitcnt lgkmcnt(4)
  v_mfma_f32_16x16x32_bf16 v[80:83], v[200:203], v[128:131], 0
  ds_read_b64_tr_b16 v[216:217], v230 offset:0
  v_mfma_f32_16x16x32_bf16 v[80:83], v[204:207], v[144:147], v[80:83]
  ds_read_b64_tr_b16 v[218:219], v230 offset:7168
  v_mfma_f32_16x16x32_bf16 v[84:87], v[204:207], v[148:151], 0
  ds_read_b64_tr_b16 v[220:221], v230 offset:14336
  v_mfma_f32_16x16x32_bf16 v[84:87], v[200:203], v[132:135], v[84:87]
  ds_read_b64_tr_b16 v[222:223], v230 offset:21504
  v_mfma_f32_16x16x32_bf16 v[88:91], v[200:203], v[136:139], 0
  v_add_u32 v230, s47, v230
  v_mfma_f32_16x16x32_bf16 v[88:91], v[204:207], v[152:155], v[88:91]
  s_add_u32 s44, s44, 1
  s_cmp_eq_u32 s44, 3
  v_mfma_f32_16x16x32_bf16 v[92:95], v[204:207], v[156:159], 0
  s_cselect_b32 s44, 0, s44
  s_cselect_b32 s46, s81, s80
  v_mfma_f32_16x16x32_bf16 v[92:95], v[200:203], v[140:143], v[92:95]
  s_cselect_b32 s47, s83, s82
  s_waitcnt lgkmcnt(4)
  v_mfma_f32_16x16x32_bf16 v[108:111], v[208:211], v[140:143], 0
  v_mfma_f32_16x16x32_bf16 v[108:111], v[212:215], v[156:159], v[108:111]
  v_mfma_f32_16x16x32_bf16 v[104:107], v[212:215], v[152:155], 0
  s_waitcnt lgkmcnt(0)
  v_mfma_f32_16x16x32_bf16 v[104:107], v[208:211], v[136:139], v[104:107]
  s_waitcnt vmcnt(0)
  s_barrier
  v_mfma_f32_16x16x32_bf16 v[100:103], v[208:211], v[132:135], 0
  v_mfma_f32_16x16x32_bf16 v[100:103], v[212:215], v[148:151], v[100:103]
  v_mfma_f32_16x16x32_bf16 v[96:99], v[212:215], v[144:147], 0
  v_mfma_f32_16x16x32_bf16 v[96:99], v[208:211], v[128:131], v[96:99]
  v_mfma_f32_16x16x32_bf16 v[112:115], v[216:219], v[128:131], 0
  v_mfma_f32_16x16x32_bf16 v[112:115], v[220:223], v[144:147], v[112:115]
  v_mfma_f32_16x16x32_bf16 v[116:119], v[220:223], v[148:151], 0
  v_mfma_f32_16x16x32_bf16 v[116:119], v[216:219], v[132:135], v[116:119]
  v_mfma_f32_16x16x32_bf16 v[120:123], v[216:219], v[136:139], 0
  v_mfma_f32_16x16x32_bf16 v[120:123], v[220:223], v[152:155], v[120:123]
  v_mfma_f32_16x16x32_bf16 v[124:127], v[220:223], v[156:159], 0
  v_mfma_f32_16x16x32_bf16 v[124:127], v[216:219], v[140:143], v[124:127]
  s_cmp_lg_u32 s22, 0
  s_cbranch_scc1 Lq107
  s_add_u32 s40, s25, 1
  s_and_b32 s40, s40, 7
  s_add_u32 s40, s40, 8
  s_sub_u32 s41, s25, 9
  s_and_b32 s41, s41, 7
  s_cmp_lt_u32 s25, 8
  s_cselect_b32 s40, s40, s41
  s_lshr_b32 s73, s24, 2
  s_lshl_b32 s73, s73, 1
  s_lshr_b32 s39, s40, 3
  s_add_u32 s73, s73, s39
  s_lshr_b32 s73, s71, s73
  s_and_b32 s73, s73, 1
  s_lshl_b32 s73, s73, 13
  s_and_b32 s39, s24, 7
  s_lshl_b32 s39, s39, 19
  s_add_u32 s73, s73, s39
  s_lshl_b32 s39, s40, 15
  s_add_u32 s73, s73, s39
  s_lshr_b32 s74, s72, 13
  s_lshr_b32 s39, s24, 2
  s_xor_b32 s74, s74, s39
  s_and_b32 s39, s24, 7
  s_mul_i32 s39, s39, 112
  s_mul_i32 s40, s25, 7
  s_add_u32 s39, s39, s40
  s_and_b32 s40, s25, 1
  s_lshl_b32 s41, s37, 2
  s_add_u32 s41, s41, 0
  s_sub_u32 s42, s41, s40
  s_add_u32 s41, s41, s39
  s_and_b32 s43, s41, 1
  s_lshl_b32 s43, s43, 10
  s_lshr_b32 s41, s41, 1
  s_lshl_b32 s84, s41, 15
  s_add_u32 s84, s84, s43
  s_lshr_b32 s41, s41, 6
  s_xor_b32 s41, s41, s74
  s_and_b32 s41, s41, 1
  s_lshl_b32 s41, s41, 13
  s_add_u32 s84, s84, s41
  s_lshl_b32 s41, s36, 14
  s_add_u32 s84, s84, s41
  s_add_u32 s84, s84, 25165824
  s_and_b32 s43, s42, 1
  s_lshl_b32 s43, s43, 10
  s_and_b32 s42, s42, 6
  s_lshl_b32 s42, s42, 13
  s_add_u32 s42, s42, s43
  s_add_u32 s88, s42, s38
  s_lshl_b32 s41, s37, 2
  s_add_u32 s41, s41, 1
  s_sub_u32 s42, s41, s40
  s_add_u32 s41, s41, s39
  s_and_b32 s43, s41, 1
  s_lshl_b32 s43, s43, 10
  s_lshr_b32 s41, s41, 1
  s_lshl_b32 s85, s41, 15
  s_add_u32 s85, s85, s43
  s_lshr_b32 s41, s41, 6
  s_xor_b32 s41, s41, s74
  s_and_b32 s41, s41, 1
  s_lshl_b32 s41, s41, 13
  s_add_u32 s85, s85, s41
  s_lshl_b32 s41, s36, 14
  s_add_u32 s85, s85, s41
  s_add_u32 s85, s85, 25165824
  s_and_b32 s43, s42, 1
  s_lshl_b32 s43, s43, 10
  s_and_b32 s42, s42, 6
  s_lshl_b32 s42, s42, 13
  s_add_u32 s42, s42, s43
  s_add_u32 s89, s42, s38
  s_lshl_b32 s41, s37, 2
  s_add_u32 s41, s41, 2
  s_sub_u32 s42, s41, s40
  s_add_u32 s41, s41, s39
  s_and_b32 s43, s41, 1
  s_lshl_b32 s43, s43, 10
  s_lshr_b32 s41, s41, 1
  s_lshl_b32 s86, s41, 15
  s_add_u32 s86, s86, s43
  s_lshr_b32 s41, s41, 6
  s_xor_b32 s41, s41, s74
  s_and_b32 s41, s41, 1
  s_lshl_b32 s41, s41, 13
  s_add_u32 s86, s86, s41
  s_lshl_b32 s41, s36, 14
  s_add_u32 s86, s86, s41
  s_add_u32 s86, s86, 25165824
  s_and_b32 s43, s42, 1
  s_lshl_b32 s43, s43, 10
  s_and_b32 s42, s42, 6
  s_lshl_b32 s42, s42, 13
  s_add_u32 s42, s42, s43
  s_add_u32 s90, s42, s38
  s_mov_b32 s41, 3
  s_sub_u32 s42, s41, s40
  s_add_u32 s41, s41, s39
  s_and_b32 s43, s41, 1
  s_lshl_b32 s43, s43, 10
  s_lshr_b32 s41, s41, 1
  s_lshl_b32 s87, s41, 15
  s_add_u32 s87, s87, s43
  s_lshr_b32 s41, s41, 6
  s_xor_b32 s41, s41, s74
  s_and_b32 s41, s41, 1
  s_lshl_b32 s41, s41, 13
  s_add_u32 s87, s87, s41
  s_lshl_b32 s41, s36, 14
  s_add_u32 s87, s87, s41
  s_add_u32 s87, s87, 25165824
  s_and_b32 s43, s42, 1
  s_lshl_b32 s43, s43, 10
  s_and_b32 s42, s42, 6
  s_lshl_b32 s42, s42, 13
  s_add_u32 s42, s42, s43
  s_add_u32 s91, s42, s38
Lq107:
  v_and_b32 v13, 15, v1
  v_lshrrev_b32 v15, 4, v1
  s_lshl_b32 s39, s36, 8
  s_add_u32 s39, s39, 155648
  v_lshl_add_u32 v14, v13, 2, s39
  s_lshl_b32 s39, s37, 9
  s_add_u32 s39, s39, 155648
  v_lshl_add_u32 v12, v15, 4, s39
  s_lshl_b32 s39, s37, 6
  s_add_u32 s39, s39, 155648
  v_lshl_add_u32 v11, v15, 4, s39
  v_lshlrev_b32 v13, 4, v1
  s_add_u32 s40, s84, s23
  v_add_u32 v2, s88, v13
  s_add_u32 s41, s85, s23
  v_add_u32 v3, s89, v13
  s_add_u32 s42, s86, s23
  v_add_u32 v4, s90, v13
  s_add_u32 s43, s87, s23
  v_add_u32 v5, s91, v13
  v_add_u32 v15, 4096, v13
  s_lshl_b32 s39, s37, 3
  v_add_u32 v8, s39, v5
  s_lshl_b32 s39, s37, 12
  v_add_u32 v5, s39, v5
  v_add_u32 v7, s39, v13
  s_or_b32 s49, s22, s26
  s_cmp_eq_u32 s49, 0
  s_cselect_b32 s49, 4, -1
  s_barrier
  ds_read_b64_tr_b16 v[192:193], v224 offset:0
  ds_read_b128 v[128:131], v6 offset:0
  ds_read_b64_tr_b16 v[194:195], v224 offset:7168
  ds_read_b128 v[144:147], v6 offset:1024
  ds_read_b64_tr_b16 v[196:197], v224 offset:14336
  ds_read_b64_tr_b16 v[198:199], v224 offset:21504
  ds_read_b128 v[132:135], v6 offset:2048
  ds_read_b128 v[148:151], v6 offset:3072
  ds_read_b64_tr_b16 v[200:201], v225 offset:0
  ds_read_b128 v[136:139], v6 offset:4096
  ds_read_b64_tr_b16 v[202:203], v225 offset:7168
  ds_read_b128 v[152:155], v6 offset:5120
.p2align 6
Lg106:
  s_waitcnt lgkmcnt(6)
  v_mfma_f32_16x16x32_bf16 v[16:19], v[192:195], v[128:131], v[16:19]
  ds_read_b128 v[140:143], v6 offset:6144
  v_mfma_f32_16x16x32_bf16 v[16:19], v[196:199], v[144:147], v[16:19]
  ds_read_b64_tr_b16 v[204:205], v225 offset:14336
  s_waitcnt lgkmcnt(6)
  v_mfma_f32_16x16x32_bf16 v[20:23], v[196:199], v[148:151], v[20:23]
  ds_read_b128 v[156:159], v6 offset:7168
  v_mfma_f32_16x16x32_bf16 v[20:23], v[192:195], v[132:135], v[20:23]
  ds_read_b64_tr_b16 v[206:207], v225 offset:21504
  s_waitcnt lgkmcnt(4)
  v_mfma_f32_16x16x32_bf16 v[24:27], v[192:195], v[136:139], v[24:27]
  ds_read_b64_tr_b16 v[208:209], v226 offset:0
  v_mfma_f32_16x16x32_bf16 v[24:27], v[196:199], v[152:155], v[24:27]
  ds_read_b64_tr_b16 v[210:211], v226 offset:7168
  s_waitcnt lgkmcnt(3)
  v_mfma_f32_16x16x32_bf16 v[28:31], v[196:199], v[156:159], v[28:31]
  ds_read_b64_tr_b16 v[212:213], v226 offset:14336
  v_mfma_f32_16x16x32_bf16 v[28:31], v[192:195], v[140:143], v[28:31]
  ds_read_b64_tr_b16 v[214:215], v226 offset:21504
  s_waitcnt lgkmcnt(4)
  v_mfma_f32_16x16x32_bf16 v[44:47], v[200:203], v[140:143], v[44:47]
  ds_read_b64_tr_b16 v[192:193], v227 offset:0
  v_mfma_f32_16x16x32_bf16 v[44:47], v[204:207], v[156:159], v[44:47]
  ds_read_b64_tr_b16 v[194:195], v227 offset:7168
  v_mfma_f32_16x16x32_bf16 v[40:43], v[204:207], v[152:155], v[40:43]
  ds_read_b64_tr_b16 v[196:197], v227 offset:14336
  v_mfma_f32_16x16x32_bf16 v[40:43], v[200:203], v[136:139], v[40:43]
  ds_read_b64_tr_b16 v[198:199], v227 offset:21504
  v_mfma_f32_16x16x32_bf16 v[36:39], v[200:203], v[132:135], v[36:39]
  v_add_u32 v224, s47, v224
  v_mfma_f32_16x16x32_bf16 v[36:39], v[204:207], v[148:151], v[36:39]
  v_add_u32 v6, s46, v6
  v_mfma_f32_16x16x32_bf16 v[32:35], v[204:207], v[144:147], v[32:35]
  v_add_u32 v225, s47, v225
  v_mfma_f32_16x16x32_bf16 v[32:35], v[200:203], v[128:131], v[32:35]
  v_add_u32 v226, s47, v226
  s_waitcnt lgkmcnt(4)
  v_mfma_f32_16x16x32_bf16 v[48:51], v[208:211], v[128:131], v[48:51]
  ds_read_b64_tr_b16 v[200:201], v228 offset:0
  v_mfma_f32_16x16x32_bf16 v[48:51], v[212:215], v[144:147], v[48:51]
  ds_read_b64_tr_b16 v[202:203], v228 offset:7168
  v_mfma_f32_16x16x32_bf16 v[52:55], v[212:215], v[148:151], v[52:55]
  ds_read_b64_tr_b16 v[204:205], v228 offset:14336
  v_mfma_f32_16x16x32_bf16 v[52:55], v[208:211], v[132:135], v[52:55]
  ds_read_b64_tr_b16 v[206:207], v228 offset:21504
  v_mfma_f32_16x16x32_bf16 v[56:59], v[208:211], v[136:139], v[56:59]
  v_add_u32 v227, s47, v227
  v_mfma_f32_16x16x32_bf16 v[56:59], v[212:215], v[152:155], v[56:59]
  v_add_u32 v228, s47, v228
  v_mfma_f32_16x16x32_bf16 v[60:63], v[212:215], v[156:159], v[60:63]
  v_mfma_f32_16x16x32_bf16 v[60:63], v[208:211], v[140:143], v[60:63]
  s_waitcnt lgkmcnt(4)
  v_mfma_f32_16x16x32_bf16 v[76:79], v[192:195], v[140:143], v[76:79]
  ds_read_b64_tr_b16 v[208:209], v229 offset:0
  v_mfma_f32_16x16x32_bf16 v[76:79], v[196:199], v[156:159], v[76:79]
  ds_read_b64_tr_b16 v[210:211], v229 offset:7168
  v_mfma_f32_16x16x32_bf16 v[72:75], v[196:199], v[152:155], v[72:75]
  ds_read_b64_tr_b16 v[212:213], v229 offset:14336
  v_mfma_f32_16x16x32_bf16 v[72:75], v[192:195], v[136:139], v[72:75]
  ds_read_b64_tr_b16 v[214:215], v229 offset:21504
  v_mfma_f32_16x16x32_bf16 v[68:71], v[192:195], v[132:135], v[68:71]
  v_add_u32 v229, s47, v229
  v_mfma_f32_16x16x32_bf16 v[68:71], v[196:199], v[148:151], v[68:71]
  v_mfma_f32_16x16x32_bf16 v[64:67], v[196:199], v[144:147], v[64:67]
  v_mfma_f32_16x16x32_bf16 v[64:67], v[192:195], v[128:131], v[64:67]
  s_waitcnt lgkmcnt(4)
  v_mfma_f32_16x16x32_bf16 v[80:83], v[200:203], v[128:131], v[80:83]
  ds_read_b64_tr_b16 v[216:217], v230 offset:0
  v_mfma_f32_16x16x32_bf16 v[80:83], v[204:207], v[144:147], v[80:83]
  ds_read_b64_tr_b16 v[218:219], v230 offset:7168
  v_mfma_f32_16x16x32_bf16 v[84:87], v[204:207], v[148:151], v[84:87]
  ds_read_b64_tr_b16 v[220:221], v230 offset:14336
  v_mfma_f32_16x16x32_bf16 v[84:87], v[200:203], v[132:135], v[84:87]
  ds_read_b64_tr_b16 v[222:223], v230 offset:21504
  v_mfma_f32_16x16x32_bf16 v[88:91], v[200:203], v[136:139], v[88:91]
  v_add_u32 v230, s47, v230
  v_mfma_f32_16x16x32_bf16 v[88:91], v[204:207], v[152:155], v[88:91]
  s_add_u32 s44, s44, 1
  s_cmp_eq_u32 s44, 3
  v_mfma_f32_16x16x32_bf16 v[92:95], v[204:207], v[156:159], v[92:95]
  s_cselect_b32 s44, 0, s44
  s_cselect_b32 s46, s81, s80
  v_mfma_f32_16x16x32_bf16 v[92:95], v[200:203], v[140:143], v[92:95]
  s_cselect_b32 s47, s83, s82
  s_cmp_eq_u32 s48, s49
  s_waitcnt lgkmcnt(4)
  v_mfma_f32_16x16x32_bf16 v[108:111], v[208:211], v[140:143], v[108:111]
  v_mfma_f32_16x16x32_bf16 v[108:111], v[212:215], v[156:159], v[108:111]
  v_mfma_f32_16x16x32_bf16 v[104:107], v[212:215], v[152:155], v[104:107]
  s_waitcnt lgkmcnt(0)
  v_mfma_f32_16x16x32_bf16 v[104:107], v[208:211], v[136:139], v[104:107]
  s_barrier
  v_mfma_f32_16x16x32_bf16 v[100:103], v[208:211], v[132:135], v[100:103]
  s_cbranch_scc1 Lrare108
Lback109:
  ds_read_b64_tr_b16 v[192:193], v224 offset:0
  v_mfma_f32_16x16x32_bf16 v[100:103], v[212:215], v[148:151], v[100:103]
  ds_read_b128 v[160:163], v6 offset:0
  v_mfma_f32_16x16x32_bf16 v[96:99], v[212:215], v[144:147], v[96:99]
  ds_read_b64_tr_b16 v[194:195], v224 offset:7168
  v_mfma_f32_16x16x32_bf16 v[96:99], v[208:211], v[128:131], v[96:99]
  ds_read_b128 v[176:179], v6 offset:1024
  v_mfma_f32_16x16x32_bf16 v[112:115], v[216:219], v[128:131], v[112:115]
  ds_read_b64_tr_b16 v[196:197], v224 offset:14336
  v_mfma_f32_16x16x32_bf16 v[112:115], v[220:223], v[144:147], v[112:115]
  ds_read_b64_tr_b16 v[198:199], v224 offset:21504
  v_mfma_f32_16x16x32_bf16 v[116:119], v[220:223], v[148:151], v[116:119]
  ds_read_b128 v[164:167], v6 offset:2048
  v_mfma_f32_16x16x32_bf16 v[116:119], v[216:219], v[132:135], v[116:119]
  ds_read_b128 v[180:183], v6 offset:3072
  v_mfma_f32_16x16x32_bf16 v[120:123], v[216:219], v[136:139], v[120:123]
  ds_read_b64_tr_b16 v[200:201], v225 offset:0
  v_mfma_f32_16x16x32_bf16 v[120:123], v[220:223], v[152:155], v[120:123]
  ds_read_b128 v[168:171], v6 offset:4096
  v_mfma_f32_16x16x32_bf16 v[124:127], v[220:223], v[156:159], v[124:127]
  ds_read_b64_tr_b16 v[202:203], v225 offset:7168
  v_mfma_f32_16x16x32_bf16 v[124:127], v[216:219], v[140:143], v[124:127]
  ds_read_b128 v[184:187], v6 offset:5120
  s_waitcnt lgkmcnt(6)
  v_mfma_f32_16x16x32_bf16 v[16:19], v[192:195], v[160:163], v[16:19]
  ds_read_b128 v[172:175], v6 offset:6144
  v_mfma_f32_16x16x32_bf16 v[16:19], v[196:199], v[176:179], v[16:19]
  ds_read_b64_tr_b16 v[204:205], v225 offset:14336
  s_waitcnt lgkmcnt(6)
  v_mfma_f32_16x16x32_bf16 v[20:23], v[196:199], v[180:183], v[20:23]
  ds_read_b128 v[188:191], v6 offset:7168
  v_mfma_f32_16x16x32_bf16 v[20:23], v[192:195], v[164:167], v[20:23]
  ds_read_b64_tr_b16 v[206:207], v225 offset:21504
  s_waitcnt lgkmcnt(4)
  v_mfma_f32_16x16x32_bf16 v[24:27], v[192:195], v[168:171], v[24:27]
  ds_read_b64_tr_b16 v[208:209], v226 offset:0
  v_mfma_f32_16x16x32_bf16 v[24:27], v[196:199], v[184:187], v[24:27]
  ds_read_b64_tr_b16 v[210:211], v226 offset:7168
  s_waitcnt lgkmcnt(3)
  v_mfma_f32_16x16x32_bf16 v[28:31], v[196:199], v[188:191], v[28:31]
  ds_read_b64_tr_b16 v[212:213], v226 offset:14336
  v_mfma_f32_16x16x32_bf16 v[28:31], v[192:195], v[172:175], v[28:31]
  ds_read_b64_tr_b16 v[214:215], v226 offset:21504
  s_waitcnt lgkmcnt(4)
  v_mfma_f32_16x16x32_bf16 v[44:47], v[200:203], v[172:175], v[44:47]
  ds_read_b64_tr_b16 v[192:193], v227 offset:0
  v_mfma_f32_16x16x32_bf16 v[44:47], v[204:207], v[188:191], v[44:47]
  ds_read_b64_tr_b16 v[194:195], v227 offset:7168
  v_mfma_f32_16x16x32_bf16 v[40:43], v[204:207], v[184:187], v[40:43]
  ds_read_b64_tr_b16 v[196:197], v227 offset:14336
  v_mfma_f32_16x16x32_bf16 v[40:43], v[200:203], v[168:171], v[40:43]
  ds_read_b64_tr_b16 v[198:199], v227 offset:21504
  v_mfma_f32_16x16x32_bf16 v[36:39], v[200:203], v[164:167], v[36:39]
  v_add_u32 v224, s47, v224
  v_mfma_f32_16x16x32_bf16 v[36:39], v[204:207], v[180:183], v[36:39]
  v_add_u32 v6, s46, v6
  v_mfma_f32_16x16x32_bf16 v[32:35], v[204:207], v[176:179], v[32:35]
  v_add_u32 v225, s47, v225
  v_mfma_f32_16x16x32_bf16 v[32:35], v[200:203], v[160:163], v[32:35]
  v_add_u32 v226, s47, v226
  s_waitcnt lgkmcnt(4)
  v_mfma_f32_16x16x32_bf16 v[48:51], v[208:211], v[160:163], v[48:51]
  ds_read_b64_tr_b16 v[200:201], v228 offset:0
  v_mfma_f32_16x16x32_bf16 v[48:51], v[212:215], v[176:179], v[48:51]
  ds_read_b64_tr_b16 v[202:203], v228 offset:7168
  v_mfma_f32_16x16x32_bf16 v[52:55], v[212:215], v[180:183], v[52:55]
  ds_read_b64_tr_b16 v[204:205], v228 offset:14336
  v_mfma_f32_16x16x32_bf16 v[52:55], v[208:211], v[164:167], v[52:55]
  ds_read_b64_tr_b16 v[206:207], v228 offset:21504
  v_mfma_f32_16x16x32_bf16 v[56:59], v[208:211], v[168:171], v[56:59]
  v_add_u32 v227, s47, v227
  v_mfma_f32_16x16x32_bf16 v[56:59], v[212:215], v[184:187], v[56:59]
  v_add_u32 v228, s47, v228
  v_mfma_f32_16x16x32_bf16 v[60:63], v[212:215], v[188:191], v[60:63]
  v_mfma_f32_16x16x32_bf16 v[60:63], v[208:211], v[172:175], v[60:63]
  s_waitcnt lgkmcnt(4)
  v_mfma_f32_16x16x32_bf16 v[76:79], v[192:195], v[172:175], v[76:79]
  ds_read_b64_tr_b16 v[208:209], v229 offset:0
  v_mfma_f32_16x16x32_bf16 v[76:79], v[196:199], v[188:191], v[76:79]
  ds_read_b64_tr_b16 v[210:211], v229 offset:7168
  v_mfma_f32_16x16x32_bf16 v[72:75], v[196:199], v[184:187], v[72:75]
  ds_read_b64_tr_b16 v[212:213], v229 offset:14336
  v_mfma_f32_16x16x32_bf16 v[72:75], v[192:195], v[168:171], v[72:75]
  ds_read_b64_tr_b16 v[214:215], v229 offset:21504
  v_mfma_f32_16x16x32_bf16 v[68:71], v[192:195], v[164:167], v[68:71]
  v_add_u32 v229, s47, v229
  v_mfma_f32_16x16x32_bf16 v[68:71], v[196:199], v[180:183], v[68:71]
  v_mfma_f32_16x16x32_bf16 v[64:67], v[196:199], v[176:179], v[64:67]
  v_mfma_f32_16x16x32_bf16 v[64:67], v[192:195], v[160:163], v[64:67]
  s_waitcnt lgkmcnt(4)
  v_mfma_f32_16x16x32_bf16 v[80:83], v[200:203], v[160:163], v[80:83]
  ds_read_b64_tr_b16 v[216:217], v230 offset:0
  v_mfma_f32_16x16x32_bf16 v[80:83], v[204:207], v[176:179], v[80:83]
  ds_read_b64_tr_b16 v[218:219], v230 offset:7168
  v_mfma_f32_16x16x32_bf16 v[84:87], v[204:207], v[180:183], v[84:87]
  ds_read_b64_tr_b16 v[220:221], v230 offset:14336
  v_mfma_f32_16x16x32_bf16 v[84:87], v[200:203], v[164:167], v[84:87]
  ds_read_b64_tr_b16 v[222:223], v230 offset:21504
  v_mfma_f32_16x16x32_bf16 v[88:91], v[200:203], v[168:171], v[88:91]
  v_add_u32 v230, s47, v230
  v_mfma_f32_16x16x32_bf16 v[88:91], v[204:207], v[184:187], v[88:91]
  s_add_u32 s44, s44, 1
  s_cmp_eq_u32 s44, 3
  v_mfma_f32_16x16x32_bf16 v[92:95], v[204:207], v[188:191], v[92:95]
  s_cselect_b32 s44, 0, s44
  s_cselect_b32 s46, s81, s80
  v_mfma_f32_16x16x32_bf16 v[92:95], v[200:203], v[172:175], v[92:95]
  s_cselect_b32 s47, s83, s82
  s_waitcnt lgkmcnt(4)
  v_mfma_f32_16x16x32_bf16 v[108:111], v[208:211], v[172:175], v[108:111]
  v_mfma_f32_16x16x32_bf16 v[108:111], v[212:215], v[188:191], v[108:111]
  v_mfma_f32_16x16x32_bf16 v[104:107], v[212:215], v[184:187], v[104:107]
  s_waitcnt lgkmcnt(0)
  v_mfma_f32_16x16x32_bf16 v[104:107], v[208:211], v[168:171], v[104:107]
  s_barrier
  v_mfma_f32_16x16x32_bf16 v[100:103], v[208:211], v[164:167], v[100:103]
  ds_read_b64_tr_b16 v[192:193], v224 offset:0
  v_mfma_f32_16x16x32_bf16 v[100:103], v[212:215], v[180:183], v[100:103]
  ds_read_b128 v[128:131], v6 offset:0
  v_mfma_f32_16x16x32_bf16 v[96:99], v[212:215], v[176:179], v[96:99]
  ds_read_b64_tr_b16 v[194:195], v224 offset:7168
  v_mfma_f32_16x16x32_bf16 v[96:99], v[208:211], v[160:163], v[96:99]
  ds_read_b128 v[144:147], v6 offset:1024
  v_mfma_f32_16x16x32_bf16 v[112:115], v[216:219], v[160:163], v[112:115]
  ds_read_b64_tr_b16 v[196:197], v224 offset:14336
  s_add_u32 s48, s48, 2
  v_mfma_f32_16x16x32_bf16 v[112:115], v[220:223], v[176:179], v[112:115]
  ds_read_b64_tr_b16 v[198:199], v224 offset:21504
  v_mfma_f32_16x16x32_bf16 v[116:119], v[220:223], v[180:183], v[116:119]
  ds_read_b128 v[132:135], v6 offset:2048
  s_cmp_lt_u32 s48, 14
  v_mfma_f32_16x16x32_bf16 v[116:119], v[216:219], v[164:167], v[116:119]
  ds_read_b128 v[148:151], v6 offset:3072
  v_mfma_f32_16x16x32_bf16 v[120:123], v[216:219], v[168:171], v[120:123]
  ds_read_b64_tr_b16 v[200:201], v225 offset:0
  v_mfma_f32_16x16x32_bf16 v[120:123], v[220:223], v[184:187], v[120:123]
  ds_read_b128 v[136:139], v6 offset:4096
  v_mfma_f32_16x16x32_bf16 v[124:127], v[220:223], v[188:191], v[124:127]
  ds_read_b64_tr_b16 v[202:203], v225 offset:7168
  v_mfma_f32_16x16x32_bf16 v[124:127], v[216:219], v[172:175], v[124:127]
  ds_read_b128 v[152:155], v6 offset:5120
  s_cbranch_scc1 Lg106
  s_waitcnt lgkmcnt(6)
  v_mfma_f32_16x16x32_bf16 v[16:19], v[192:195], v[128:131], v[16:19]
  ds_read_b128 v[140:143], v6 offset:6144
  v_mfma_f32_16x16x32_bf16 v[16:19], v[196:199], v[144:147], v[16:19]
  ds_read_b64_tr_b16 v[204:205], v225 offset:14336
  s_waitcnt lgkmcnt(6)
  v_mfma_f32_16x16x32_bf16 v[20:23], v[196:199], v[148:151], v[20:23]
  ds_read_b128 v[156:159], v6 offset:7168
  v_mfma_f32_16x16x32_bf16 v[20:23], v[192:195], v[132:135], v[20:23]
  ds_read_b64_tr_b16 v[206:207], v225 offset:21504
  s_waitcnt lgkmcnt(4)
  v_mfma_f32_16x16x32_bf16 v[24:27], v[192:195], v[136:139], v[24:27]
  ds_read_b64_tr_b16 v[208:209], v226 offset:0
  v_mfma_f32_16x16x32_bf16 v[24:27], v[196:199], v[152:155], v[24:27]
  ds_read_b64_tr_b16 v[210:211], v226 offset:7168
  s_waitcnt lgkmcnt(3)
  v_mfma_f32_16x16x32_bf16 v[28:31], v[196:199], v[156:159], v[28:31]
  ds_read_b64_tr_b16 v[212:213], v226 offset:14336
  v_mfma_f32_16x16x32_bf16 v[28:31], v[192:195], v[140:143], v[28:31]
  ds_read_b64_tr_b16 v[214:215], v226 offset:21504
  s_waitcnt lgkmcnt(4)
  v_mfma_f32_16x16x32_bf16 v[44:47], v[200:203], v[140:143], v[44:47]
  ds_read_b64_tr_b16 v[192:193], v227 offset:0
  v_mfma_f32_16x16x32_bf16 v[44:47], v[204:207], v[156:159], v[44:47]
  ds_read_b64_tr_b16 v[194:195], v227 offset:7168
  v_mfma_f32_16x16x32_bf16 v[40:43], v[204:207], v[152:155], v[40:43]
  ds_read_b64_tr_b16 v[196:197], v227 offset:14336
  v_mfma_f32_16x16x32_bf16 v[40:43], v[200:203], v[136:139], v[40:43]
  ds_read_b64_tr_b16 v[198:199], v227 offset:21504
  v_mfma_f32_16x16x32_bf16 v[36:39], v[200:203], v[132:135], v[36:39]
  v_add_u32 v224, s47, v224
  v_mfma_f32_16x16x32_bf16 v[36:39], v[204:207], v[148:151], v[36:39]
  v_add_u32 v6, s46, v6
  v_mfma_f32_16x16x32_bf16 v[32:35], v[204:207], v[144:147], v[32:35]
  v_add_u32 v225, s47, v225
  v_mfma_f32_16x16x32_bf16 v[32:35], v[200:203], v[128:131], v[32:35]
  s_waitcnt lgkmcnt(4)
  v_mfma_f32_16x16x32_bf16 v[48:51], v[208:211], v[128:131], v[48:51]
  ds_read_b64_tr_b16 v[200:201], v228 offset:0
  v_mfma_f32_16x16x32_bf16 v[48:51], v[212:215], v[144:147], v[48:51]
  ds_read_b64_tr_b16 v[202:203], v228 offset:7168
  v_mfma_f32_16x16x32_bf16 v[52:55], v[212:215], v[148:151], v[52:55]
  ds_read_b64_tr_b16 v[204:205], v228 offset:14336
  v_mfma_f32_16x16x32_bf16 v[52:55], v[208:211], v[132:135], v[52:55]
  ds_read_b64_tr_b16 v[206:207], v228 offset:21504
  v_mfma_f32_16x16x32_bf16 v[56:59], v[208:211], v[136:139], v[56:59]
  v_mfma_f32_16x16x32_bf16 v[56:59], v[212:215], v[152:155], v[56:59]
  v_mfma_f32_16x16x32_bf16 v[60:63], v[212:215], v[156:159], v[60:63]
  v_mfma_f32_16x16x32_bf16 v[60:63], v[208:211], v[140:143], v[60:63]
  s_waitcnt lgkmcnt(4)
  v_mfma_f32_16x16x32_bf16 v[76:79], v[192:195], v[140:143], v[76:79]
  ds_read_b64_tr_b16 v[208:209], v229 offset:0
  v_mfma_f32_16x16x32_bf16 v[76:79], v[196:199], v[156:159], v[76:79]
  ds_read_b64_tr_b16 v[210:211], v229 offset:7168
  v_mfma_f32_16x16x32_bf16 v[72:75], v[196:199], v[152:155], v[72:75]
  ds_read_b64_tr_b16 v[212:213], v229 offset:14336
  v_mfma_f32_16x16x32_bf16 v[72:75], v[192:195], v[136:139], v[72:75]
  ds_read_b64_tr_b16 v[214:215], v229 offset:21504
  v_mfma_f32_16x16x32_bf16 v[68:71], v[192:195], v[132:135], v[68:71]
  v_mfma_f32_16x16x32_bf16 v[68:71], v[196:199], v[148:151], v[68:71]
  v_mfma_f32_16x16x32_bf16 v[64:67], v[196:199], v[144:147], v[64:67]
  v_mfma_f32_16x16x32_bf16 v[64:67], v[192:195], v[128:131], v[64:67]
  s_waitcnt lgkmcnt(4)
  v_mfma_f32_16x16x32_bf16 v[80:83], v[200:203], v[128:131], v[80:83]
  ds_read_b64_tr_b16 v[216:217], v230 offset:0
  v_mfma_f32_16x16x32_bf16 v[80:83], v[204:207], v[144:147], v[80:83]
  ds_read_b64_tr_b16 v[218:219], v230 offset:7168
  v_mfma_f32_16x16x32_bf16 v[84:87], v[204:207], v[148:151], v[84:87]
  ds_read_b64_tr_b16 v[220:221], v230 offset:14336
  v_mfma_f32_16x16x32_bf16 v[84:87], v[200:203], v[132:135], v[84:87]
  ds_read_b64_tr_b16 v[222:223], v230 offset:21504
  v_mfma_f32_16x16x32_bf16 v[88:91], v[200:203], v[136:139], v[88:91]
  v_mfma_f32_16x16x32_bf16 v[88:91], v[204:207], v[152:155], v[88:91]
  v_mfma_f32_16x16x32_bf16 v[92:95], v[204:207], v[156:159], v[92:95]
  v_mfma_f32_16x16x32_bf16 v[92:95], v[200:203], v[140:143], v[92:95]
  s_waitcnt lgkmcnt(4)
  v_mfma_f32_16x16x32_bf16 v[108:111], v[208:211], v[140:143], v[108:111]
  v_mfma_f32_16x16x32_bf16 v[108:111], v[212:215], v[156:159], v[108:111]
  v_mfma_f32_16x16x32_bf16 v[104:107], v[212:215], v[152:155], v[104:107]
  s_waitcnt lgkmcnt(0)
  v_mfma_f32_16x16x32_bf16 v[104:107], v[208:211], v[136:139], v[104:107]
  s_barrier
  v_mfma_f32_16x16x32_bf16 v[100:103], v[208:211], v[132:135], v[100:103]
  ds_read2_b32 v[160:161], v14 offset0:0 offset1:128
  ds_read2_b32 v[164:165], v14 offset0:16 offset1:144
  v_mfma_f32_16x16x32_bf16 v[100:103], v[212:215], v[148:151], v[100:103]
  ds_read2_b32 v[168:169], v14 offset0:32 offset1:160
  ds_read2_b32 v[172:173], v14 offset0:48 offset1:176
  v_mfma_f32_16x16x32_bf16 v[96:99], v[212:215], v[144:147], v[96:99]
  ds_read_b128 v[176:179], v12 offset:2048
  ds_read_b128 v[180:183], v12 offset:2112
  v_mfma_f32_16x16x32_bf16 v[96:99], v[208:211], v[128:131], v[96:99]
  ds_read_b128 v[184:187], v12 offset:2176
  ds_read_b128 v[188:191], v12 offset:2240
  v_mfma_f32_16x16x32_bf16 v[112:115], v[216:219], v[128:131], v[112:115]
  ds_read_b128 v[192:195], v12 offset:2304
  ds_read_b128 v[196:199], v12 offset:2368
  v_mfma_f32_16x16x32_bf16 v[112:115], v[220:223], v[144:147], v[112:115]
  ds_read_b128 v[200:203], v11 offset:2432
  s_waitcnt lgkmcnt(7)
  v_mfma_f32_16x16x32_bf16 v[116:119], v[220:223], v[148:151], v[116:119]
  v_mul_f32 v162, 0xbfb8aa3b, v161
  v_rcp_f32 v163, v161
  v_mfma_f32_16x16x32_bf16 v[116:119], v[216:219], v[132:135], v[116:119]
  v_mul_f32 v166, 0xbfb8aa3b, v165
  v_rcp_f32 v167, v165
  v_mfma_f32_16x16x32_bf16 v[120:123], v[216:219], v[136:139], v[120:123]
  v_mul_f32 v170, 0xbfb8aa3b, v169
  v_rcp_f32 v171, v169
  v_mfma_f32_16x16x32_bf16 v[120:123], v[220:223], v[152:155], v[120:123]
  v_mul_f32 v174, 0xbfb8aa3b, v173
  v_rcp_f32 v175, v173
  v_mfma_f32_16x16x32_bf16 v[124:127], v[220:223], v[156:159], v[124:127]
  v_mfma_f32_16x16x32_bf16 v[124:127], v[216:219], v[140:143], v[124:127]
  s_waitcnt lgkmcnt(0)
  v_pk_fma_f32 v[16:17], v[176:177], v[160:161], v[16:17] op_sel_hi:[1,0,1]
  v_pk_fma_f32 v[18:19], v[178:179], v[160:161], v[18:19] op_sel_hi:[1,0,1]
  v_pk_fma_f32 v[32:33], v[180:181], v[160:161], v[32:33] op_sel_hi:[1,0,1]
  v_pk_fma_f32 v[34:35], v[182:183], v[160:161], v[34:35] op_sel_hi:[1,0,1]
  v_pk_mul_f32 v[128:129], v[16:17], v[162:163] op_sel_hi:[1,0]
  v_pk_mul_f32 v[130:131], v[18:19], v[162:163] op_sel_hi:[1,0]
  v_pk_mul_f32 v[132:133], v[32:33], v[162:163] op_sel_hi:[1,0]
  v_pk_mul_f32 v[134:135], v[34:35], v[162:163] op_sel_hi:[1,0]
  v_exp_f32 v128, v128
  v_pk_fma_f32 v[20:21], v[176:177], v[164:165], v[20:21] op_sel_hi:[1,0,1]
  v_exp_f32 v129, v129
  v_pk_fma_f32 v[22:23], v[178:179], v[164:165], v[22:23] op_sel_hi:[1,0,1]
  v_exp_f32 v130, v130
  v_pk_fma_f32 v[36:37], v[180:181], v[164:165], v[36:37] op_sel_hi:[1,0,1]
  v_exp_f32 v131, v131
  v_pk_fma_f32 v[38:39], v[182:183], v[164:165], v[38:39] op_sel_hi:[1,0,1]
  v_exp_f32 v132, v132
  v_pk_mul_f32 v[136:137], v[20:21], v[166:167] op_sel_hi:[1,0]
  v_exp_f32 v133, v133
  v_pk_mul_f32 v[138:139], v[22:23], v[166:167] op_sel_hi:[1,0]
  v_exp_f32 v134, v134
  v_pk_mul_f32 v[140:141], v[36:37], v[166:167] op_sel_hi:[1,0]
  v_exp_f32 v135, v135
  v_pk_mul_f32 v[142:143], v[38:39], v[166:167] op_sel_hi:[1,0]
  v_exp_f32 v136, v136
  v_pk_fma_f32 v[128:129], v[128:129], v[162:163], v[162:163] op_sel:[0,1,1] op_sel_hi:[1,1,1]
  v_exp_f32 v137, v137
  v_pk_fma_f32 v[130:131], v[130:131], v[162:163], v[162:163] op_sel:[0,1,1] op_sel_hi:[1,1,1]
  v_exp_f32 v138, v138
  v_pk_fma_f32 v[132:133], v[132:133], v[162:163], v[162:163] op_sel:[0,1,1] op_sel_hi:[1,1,1]
  v_exp_f32 v139, v139
  v_pk_fma_f32 v[134:135], v[134:135], v[162:163], v[162:163] op_sel:[0,1,1] op_sel_hi:[1,1,1]
  v_exp_f32 v140, v140
  v_exp_f32 v141, v141
  v_exp_f32 v142, v142
  v_exp_f32 v143, v143
  v_rcp_f32 v128, v128
  v_pk_fma_f32 v[24:25], v[176:177], v[168:169], v[24:25] op_sel_hi:[1,0,1]
  v_rcp_f32 v129, v129
  v_pk_fma_f32 v[26:27], v[178:179], v[168:169], v[26:27] op_sel_hi:[1,0,1]
  v_rcp_f32 v130, v130
  v_pk_fma_f32 v[40:41], v[180:181], v[168:169], v[40:41] op_sel_hi:[1,0,1]
  v_rcp_f32 v131, v131
  v_pk_fma_f32 v[42:43], v[182:183], v[168:169], v[42:43] op_sel_hi:[1,0,1]
  v_rcp_f32 v132, v132
  v_pk_mul_f32 v[144:145], v[24:25], v[170:171] op_sel_hi:[1,0]
  v_rcp_f32 v133, v133
  v_pk_mul_f32 v[146:147], v[26:27], v[170:171] op_sel_hi:[1,0]
  v_rcp_f32 v134, v134
  v_pk_mul_f32 v[148:149], v[40:41], v[170:171] op_sel_hi:[1,0]
  v_rcp_f32 v135, v135
  v_pk_mul_f32 v[150:151], v[42:43], v[170:171] op_sel_hi:[1,0]
  v_exp_f32 v144, v144
  v_pk_fma_f32 v[136:137], v[136:137], v[166:167], v[166:167] op_sel:[0,1,1] op_sel_hi:[1,1,1]
  v_pk_fma_f32 v[138:139], v[138:139], v[166:167], v[166:167] op_sel:[0,1,1] op_sel_hi:[1,1,1]
  v_exp_f32 v145, v145
  v_pk_fma_f32 v[140:141], v[140:141], v[166:167], v[166:167] op_sel:[0,1,1] op_sel_hi:[1,1,1]
  v_pk_fma_f32 v[142:143], v[142:143], v[166:167], v[166:167] op_sel:[0,1,1] op_sel_hi:[1,1,1]
  v_exp_f32 v146, v146
  v_pk_mul_f32 v[16:17], v[16:17], v[128:129]
  v_pk_mul_f32 v[18:19], v[18:19], v[130:131]
  v_exp_f32 v147, v147
  v_pk_mul_f32 v[32:33], v[32:33], v[132:133]
  v_pk_mul_f32 v[34:35], v[34:35], v[134:135]
  v_exp_f32 v148, v148
  v_cvt_pk_bf16_f32 v16, v16, v17
  v_cvt_pk_bf16_f32 v17, v18, v19
  v_exp_f32 v149, v149
  v_cvt_pk_bf16_f32 v18, v32, v33
  v_exp_f32 v150, v150
  v_cvt_pk_bf16_f32 v19, v34, v35
  v_exp_f32 v151, v151
  buffer_store_dwordx4 v[16:19], v13, s[28:31], s40 offen offset:0 sc1
  ds_write_b128 v2, v[16:19] offset:0
  v_rcp_f32 v136, v136
  v_pk_fma_f32 v[28:29], v[176:177], v[172:173], v[28:29] op_sel_hi:[1,0,1]
  v_rcp_f32 v137, v137
  v_pk_fma_f32 v[30:31], v[178:179], v[172:173], v[30:31] op_sel_hi:[1,0,1]
  v_rcp_f32 v138, v138
  v_pk_fma_f32 v[44:45], v[180:181], v[172:173], v[44:45] op_sel_hi:[1,0,1]
  v_rcp_f32 v139, v139
  v_pk_fma_f32 v[46:47], v[182:183], v[172:173], v[46:47] op_sel_hi:[1,0,1]
  v_rcp_f32 v140, v140
  v_pk_mul_f32 v[128:129], v[28:29], v[174:175] op_sel_hi:[1,0]
  v_rcp_f32 v141, v141
  v_pk_mul_f32 v[130:131], v[30:31], v[174:175] op_sel_hi:[1,0]
  v_rcp_f32 v142, v142
  v_pk_mul_f32 v[132:133], v[44:45], v[174:175] op_sel_hi:[1,0]
  v_rcp_f32 v143, v143
  v_pk_mul_f32 v[134:135], v[46:47], v[174:175] op_sel_hi:[1,0]
  v_exp_f32 v128, v128
  v_pk_fma_f32 v[144:145], v[144:145], v[170:171], v[170:171] op_sel:[0,1,1] op_sel_hi:[1,1,1]
  v_pk_fma_f32 v[146:147], v[146:147], v[170:171], v[170:171] op_sel:[0,1,1] op_sel_hi:[1,1,1]
  v_exp_f32 v129, v129
  v_pk_fma_f32 v[148:149], v[148:149], v[170:171], v[170:171] op_sel:[0,1,1] op_sel_hi:[1,1,1]
  v_pk_fma_f32 v[150:151], v[150:151], v[170:171], v[170:171] op_sel:[0,1,1] op_sel_hi:[1,1,1]
  v_exp_f32 v130, v130
  v_pk_mul_f32 v[20:21], v[20:21], v[136:137]
  v_pk_mul_f32 v[22:23], v[22:23], v[138:139]
  v_exp_f32 v131, v131
  v_pk_mul_f32 v[36:37], v[36:37], v[140:141]
  v_pk_mul_f32 v[38:39], v[38:39], v[142:143]
  v_exp_f32 v132, v132
  v_cvt_pk_bf16_f32 v20, v20, v21
  v_cvt_pk_bf16_f32 v21, v22, v23
  v_exp_f32 v133, v133
  v_cvt_pk_bf16_f32 v22, v36, v37
  v_exp_f32 v134, v134
  v_cvt_pk_bf16_f32 v23, v38, v39
  v_exp_f32 v135, v135
  buffer_store_dwordx4 v[20:23], v13, s[28:31], s40 offen offset:2048 sc1
  ds_write_b128 v2, v[20:23] offset:2048
  v_rcp_f32 v144, v144
  v_pk_fma_f32 v[48:49], v[184:185], v[160:161], v[48:49] op_sel_hi:[1,0,1]
  v_rcp_f32 v145, v145
  v_pk_fma_f32 v[50:51], v[186:187], v[160:161], v[50:51] op_sel_hi:[1,0,1]
  v_rcp_f32 v146, v146
  v_pk_fma_f32 v[64:65], v[188:189], v[160:161], v[64:65] op_sel_hi:[1,0,1]
  v_rcp_f32 v147, v147
  v_pk_fma_f32 v[66:67], v[190:191], v[160:161], v[66:67] op_sel_hi:[1,0,1]
  v_rcp_f32 v148, v148
  v_pk_mul_f32 v[136:137], v[48:49], v[162:163] op_sel_hi:[1,0]
  v_rcp_f32 v149, v149
  v_pk_mul_f32 v[138:139], v[50:51], v[162:163] op_sel_hi:[1,0]
  v_rcp_f32 v150, v150
  v_pk_mul_f32 v[140:141], v[64:65], v[162:163] op_sel_hi:[1,0]
  v_rcp_f32 v151, v151
  v_pk_mul_f32 v[142:143], v[66:67], v[162:163] op_sel_hi:[1,0]
  v_exp_f32 v136, v136
  v_pk_fma_f32 v[128:129], v[128:129], v[174:175], v[174:175] op_sel:[0,1,1] op_sel_hi:[1,1,1]
  v_pk_fma_f32 v[130:131], v[130:131], v[174:175], v[174:175] op_sel:[0,1,1] op_sel_hi:[1,1,1]
  v_exp_f32 v137, v137
  v_pk_fma_f32 v[132:133], v[132:133], v[174:175], v[174:175] op_sel:[0,1,1] op_sel_hi:[1,1,1]
  v_pk_fma_f32 v[134:135], v[134:135], v[174:175], v[174:175] op_sel:[0,1,1] op_sel_hi:[1,1,1]
  v_exp_f32 v138, v138
  v_pk_mul_f32 v[24:25], v[24:25], v[144:145]
  v_pk_mul_f32 v[26:27], v[26:27], v[146:147]
  v_exp_f32 v139, v139
  v_pk_mul_f32 v[40:41], v[40:41], v[148:149]
  v_pk_mul_f32 v[42:43], v[42:43], v[150:151]
  v_exp_f32 v140, v140
  v_cvt_pk_bf16_f32 v24, v24, v25
  v_cvt_pk_bf16_f32 v25, v26, v27
  v_exp_f32 v141, v141
  v_cvt_pk_bf16_f32 v26, v40, v41
  v_exp_f32 v142, v142
  v_cvt_pk_bf16_f32 v27, v42, v43
  v_exp_f32 v143, v143
  buffer_store_dwordx4 v[24:27], v15, s[28:31], s40 offen offset:0 sc1
  ds_write_b128 v2, v[24:27] offset:4096
  v_rcp_f32 v128, v128
  v_pk_fma_f32 v[52:53], v[184:185], v[164:165], v[52:53] op_sel_hi:[1,0,1]
  v_rcp_f32 v129, v129
  v_pk_fma_f32 v[54:55], v[186:187], v[164:165], v[54:55] op_sel_hi:[1,0,1]
  v_rcp_f32 v130, v130
  v_pk_fma_f32 v[68:69], v[188:189], v[164:165], v[68:69] op_sel_hi:[1,0,1]
  v_rcp_f32 v131, v131
  v_pk_fma_f32 v[70:71], v[190:191], v[164:165], v[70:71] op_sel_hi:[1,0,1]
  v_rcp_f32 v132, v132
  v_pk_mul_f32 v[144:145], v[52:53], v[166:167] op_sel_hi:[1,0]
  v_rcp_f32 v133, v133
  v_pk_mul_f32 v[146:147], v[54:55], v[166:167] op_sel_hi:[1,0]
  v_rcp_f32 v134, v134
  v_pk_mul_f32 v[148:149], v[68:69], v[166:167] op_sel_hi:[1,0]
  v_rcp_f32 v135, v135
  v_pk_mul_f32 v[150:151], v[70:71], v[166:167] op_sel_hi:[1,0]
  v_exp_f32 v144, v144
  v_pk_fma_f32 v[136:137], v[136:137], v[162:163], v[162:163] op_sel:[0,1,1] op_sel_hi:[1,1,1]
  v_pk_fma_f32 v[138:139], v[138:139], v[162:163], v[162:163] op_sel:[0,1,1] op_sel_hi:[1,1,1]
  v_exp_f32 v145, v145
  v_pk_fma_f32 v[140:141], v[140:141], v[162:163], v[162:163] op_sel:[0,1,1] op_sel_hi:[1,1,1]
  v_pk_fma_f32 v[142:143], v[142:143], v[162:163], v[162:163] op_sel:[0,1,1] op_sel_hi:[1,1,1]
  v_exp_f32 v146, v146
  v_pk_mul_f32 v[28:29], v[28:29], v[128:129]
  v_pk_mul_f32 v[30:31], v[30:31], v[130:131]
  v_exp_f32 v147, v147
  v_pk_mul_f32 v[44:45], v[44:45], v[132:133]
  v_pk_mul_f32 v[46:47], v[46:47], v[134:135]
  v_exp_f32 v148, v148
  v_cvt_pk_bf16_f32 v28, v28, v29
  v_cvt_pk_bf16_f32 v29, v30, v31
  v_exp_f32 v149, v149
  v_cvt_pk_bf16_f32 v30, v44, v45
  v_exp_f32 v150, v150
  v_cvt_pk_bf16_f32 v31, v46, v47
  v_exp_f32 v151, v151
  buffer_store_dwordx4 v[28:31], v15, s[28:31], s40 offen offset:2048 sc1
  ds_write_b128 v2, v[28:31] offset:6144
  v_rcp_f32 v136, v136
  v_pk_fma_f32 v[56:57], v[184:185], v[168:169], v[56:57] op_sel_hi:[1,0,1]
  v_rcp_f32 v137, v137
  v_pk_fma_f32 v[58:59], v[186:187], v[168:169], v[58:59] op_sel_hi:[1,0,1]
  v_rcp_f32 v138, v138
  v_pk_fma_f32 v[72:73], v[188:189], v[168:169], v[72:73] op_sel_hi:[1,0,1]
  v_rcp_f32 v139, v139
  v_pk_fma_f32 v[74:75], v[190:191], v[168:169], v[74:75] op_sel_hi:[1,0,1]
  v_rcp_f32 v140, v140
  v_pk_mul_f32 v[128:129], v[56:57], v[170:171] op_sel_hi:[1,0]
  v_rcp_f32 v141, v141
  v_pk_mul_f32 v[130:131], v[58:59], v[170:171] op_sel_hi:[1,0]
  v_rcp_f32 v142, v142
  v_pk_mul_f32 v[132:133], v[72:73], v[170:171] op_sel_hi:[1,0]
  v_rcp_f32 v143, v143
  v_pk_mul_f32 v[134:135], v[74:75], v[170:171] op_sel_hi:[1,0]
  v_exp_f32 v128, v128
  v_pk_fma_f32 v[144:145], v[144:145], v[166:167], v[166:167] op_sel:[0,1,1] op_sel_hi:[1,1,1]
  v_pk_fma_f32 v[146:147], v[146:147], v[166:167], v[166:167] op_sel:[0,1,1] op_sel_hi:[1,1,1]
  v_exp_f32 v129, v129
  v_pk_fma_f32 v[148:149], v[148:149], v[166:167], v[166:167] op_sel:[0,1,1] op_sel_hi:[1,1,1]
  v_pk_fma_f32 v[150:151], v[150:151], v[166:167], v[166:167] op_sel:[0,1,1] op_sel_hi:[1,1,1]
  v_exp_f32 v130, v130
  v_pk_mul_f32 v[48:49], v[48:49], v[136:137]
  v_pk_mul_f32 v[50:51], v[50:51], v[138:139]
  v_exp_f32 v131, v131
  v_pk_mul_f32 v[64:65], v[64:65], v[140:141]
  v_pk_mul_f32 v[66:67], v[66:67], v[142:143]
  v_exp_f32 v132, v132
  v_cvt_pk_bf16_f32 v48, v48, v49
  v_cvt_pk_bf16_f32 v49, v50, v51
  v_exp_f32 v133, v133
  v_cvt_pk_bf16_f32 v50, v64, v65
  v_exp_f32 v134, v134
  v_cvt_pk_bf16_f32 v51, v66, v67
  v_exp_f32 v135, v135
  buffer_store_dwordx4 v[48:51], v13, s[28:31], s41 offen offset:0 sc1
  ds_write_b128 v3, v[48:51] offset:0
  v_rcp_f32 v144, v144
  v_pk_fma_f32 v[60:61], v[184:185], v[172:173], v[60:61] op_sel_hi:[1,0,1]
  v_rcp_f32 v145, v145
  v_pk_fma_f32 v[62:63], v[186:187], v[172:173], v[62:63] op_sel_hi:[1,0,1]
  v_rcp_f32 v146, v146
  v_pk_fma_f32 v[76:77], v[188:189], v[172:173], v[76:77] op_sel_hi:[1,0,1]
  v_rcp_f32 v147, v147
  v_pk_fma_f32 v[78:79], v[190:191], v[172:173], v[78:79] op_sel_hi:[1,0,1]
  v_rcp_f32 v148, v148
  v_pk_mul_f32 v[136:137], v[60:61], v[174:175] op_sel_hi:[1,0]
  v_rcp_f32 v149, v149
  v_pk_mul_f32 v[138:139], v[62:63], v[174:175] op_sel_hi:[1,0]
  v_rcp_f32 v150, v150
  v_pk_mul_f32 v[140:141], v[76:77], v[174:175] op_sel_hi:[1,0]
  v_rcp_f32 v151, v151
  v_pk_mul_f32 v[142:143], v[78:79], v[174:175] op_sel_hi:[1,0]
  v_exp_f32 v136, v136
  v_pk_fma_f32 v[128:129], v[128:129], v[170:171], v[170:171] op_sel:[0,1,1] op_sel_hi:[1,1,1]
  v_pk_fma_f32 v[130:131], v[130:131], v[170:171], v[170:171] op_sel:[0,1,1] op_sel_hi:[1,1,1]
  v_exp_f32 v137, v137
  v_pk_fma_f32 v[132:133], v[132:133], v[170:171], v[170:171] op_sel:[0,1,1] op_sel_hi:[1,1,1]
  v_pk_fma_f32 v[134:135], v[134:135], v[170:171], v[170:171] op_sel:[0,1,1] op_sel_hi:[1,1,1]
  v_exp_f32 v138, v138
  v_pk_mul_f32 v[52:53], v[52:53], v[144:145]
  v_pk_mul_f32 v[54:55], v[54:55], v[146:147]
  v_exp_f32 v139, v139
  v_pk_mul_f32 v[68:69], v[68:69], v[148:149]
  v_pk_mul_f32 v[70:71], v[70:71], v[150:151]
  v_exp_f32 v140, v140
  v_cvt_pk_bf16_f32 v52, v52, v53
  v_cvt_pk_bf16_f32 v53, v54, v55
  v_exp_f32 v141, v141
  v_cvt_pk_bf16_f32 v54, v68, v69
  v_exp_f32 v142, v142
  v_cvt_pk_bf16_f32 v55, v70, v71
  v_exp_f32 v143, v143
  buffer_store_dwordx4 v[52:55], v13, s[28:31], s41 offen offset:2048 sc1
  ds_write_b128 v3, v[52:55] offset:2048
  v_rcp_f32 v128, v128
  v_pk_fma_f32 v[112:113], v[200:201], v[160:161], v[112:113] op_sel_hi:[1,0,1]
  v_rcp_f32 v129, v129
  v_pk_fma_f32 v[114:115], v[202:203], v[160:161], v[114:115] op_sel_hi:[1,0,1]
  v_rcp_f32 v130, v130
  v_pk_fma_f32 v[116:117], v[200:201], v[164:165], v[116:117] op_sel_hi:[1,0,1]
  v_rcp_f32 v131, v131
  v_pk_fma_f32 v[118:119], v[202:203], v[164:165], v[118:119] op_sel_hi:[1,0,1]
  v_rcp_f32 v132, v132
  v_pk_mul_f32 v[144:145], v[112:113], v[162:163] op_sel_hi:[1,0]
  v_rcp_f32 v133, v133
  v_pk_mul_f32 v[146:147], v[114:115], v[162:163] op_sel_hi:[1,0]
  v_rcp_f32 v134, v134
  v_pk_mul_f32 v[148:149], v[116:117], v[166:167] op_sel_hi:[1,0]
  v_rcp_f32 v135, v135
  v_pk_mul_f32 v[150:151], v[118:119], v[166:167] op_sel_hi:[1,0]
  v_exp_f32 v144, v144
  v_pk_fma_f32 v[136:137], v[136:137], v[174:175], v[174:175] op_sel:[0,1,1] op_sel_hi:[1,1,1]
  v_pk_fma_f32 v[138:139], v[138:139], v[174:175], v[174:175] op_sel:[0,1,1] op_sel_hi:[1,1,1]
  v_exp_f32 v145, v145
  v_pk_fma_f32 v[140:141], v[140:141], v[174:175], v[174:175] op_sel:[0,1,1] op_sel_hi:[1,1,1]
  v_pk_fma_f32 v[142:143], v[142:143], v[174:175], v[174:175] op_sel:[0,1,1] op_sel_hi:[1,1,1]
  v_exp_f32 v146, v146
  v_pk_mul_f32 v[56:57], v[56:57], v[128:129]
  v_pk_mul_f32 v[58:59], v[58:59], v[130:131]
  v_exp_f32 v147, v147
  v_pk_mul_f32 v[72:73], v[72:73], v[132:133]
  v_pk_mul_f32 v[74:75], v[74:75], v[134:135]
  v_exp_f32 v148, v148
  v_cvt_pk_bf16_f32 v56, v56, v57
  v_cvt_pk_bf16_f32 v57, v58, v59
  v_exp_f32 v149, v149
  v_cvt_pk_bf16_f32 v58, v72, v73
  v_exp_f32 v150, v150
  v_cvt_pk_bf16_f32 v59, v74, v75
  v_exp_f32 v151, v151
  buffer_store_dwordx4 v[56:59], v15, s[28:31], s41 offen offset:0 sc1
  ds_write_b128 v3, v[56:59] offset:4096
  v_rcp_f32 v136, v136
  v_pk_fma_f32 v[120:121], v[200:201], v[168:169], v[120:121] op_sel_hi:[1,0,1]
  v_rcp_f32 v137, v137
  v_pk_fma_f32 v[122:123], v[202:203], v[168:169], v[122:123] op_sel_hi:[1,0,1]
  v_rcp_f32 v138, v138
  v_pk_fma_f32 v[124:125], v[200:201], v[172:173], v[124:125] op_sel_hi:[1,0,1]
  v_rcp_f32 v139, v139
  v_pk_fma_f32 v[126:127], v[202:203], v[172:173], v[126:127] op_sel_hi:[1,0,1]
  v_rcp_f32 v140, v140
  v_pk_mul_f32 v[128:129], v[120:121], v[170:171] op_sel_hi:[1,0]
  v_rcp_f32 v141, v141
  v_pk_mul_f32 v[130:131], v[122:123], v[170:171] op_sel_hi:[1,0]
  v_rcp_f32 v142, v142
  v_pk_mul_f32 v[132:133], v[124:125], v[174:175] op_sel_hi:[1,0]
  v_rcp_f32 v143, v143
  v_pk_mul_f32 v[134:135], v[126:127], v[174:175] op_sel_hi:[1,0]
  v_exp_f32 v128, v128
  v_pk_fma_f32 v[144:145], v[144:145], v[162:163], v[162:163] op_sel:[0,1,1] op_sel_hi:[1,1,1]
  v_pk_fma_f32 v[146:147], v[146:147], v[162:163], v[162:163] op_sel:[0,1,1] op_sel_hi:[1,1,1]
  v_exp_f32 v129, v129
  v_pk_fma_f32 v[148:149], v[148:149], v[166:167], v[166:167] op_sel:[0,1,1] op_sel_hi:[1,1,1]
  v_pk_fma_f32 v[150:151], v[150:151], v[166:167], v[166:167] op_sel:[0,1,1] op_sel_hi:[1,1,1]
  v_exp_f32 v130, v130
  v_pk_mul_f32 v[60:61], v[60:61], v[136:137]
  v_pk_mul_f32 v[62:63], v[62:63], v[138:139]
  v_exp_f32 v131, v131
  v_pk_mul_f32 v[76:77], v[76:77], v[140:141]
  v_pk_mul_f32 v[78:79], v[78:79], v[142:143]
  v_exp_f32 v132, v132
  v_cvt_pk_bf16_f32 v60, v60, v61
  v_cvt_pk_bf16_f32 v61, v62, v63
  v_exp_f32 v133, v133
  v_cvt_pk_bf16_f32 v62, v76, v77
  v_exp_f32 v134, v134
  v_cvt_pk_bf16_f32 v63, v78, v79
  v_exp_f32 v135, v135
  buffer_store_dwordx4 v[60:63], v15, s[28:31], s41 offen offset:2048 sc1
  ds_write_b128 v3, v[60:63] offset:6144
  v_rcp_f32 v144, v144
  v_pk_fma_f32 v[80:81], v[192:193], v[160:161], v[80:81] op_sel_hi:[1,0,1]
  v_rcp_f32 v145, v145
  v_pk_fma_f32 v[82:83], v[194:195], v[160:161], v[82:83] op_sel_hi:[1,0,1]
  v_rcp_f32 v146, v146
  v_pk_fma_f32 v[96:97], v[196:197], v[160:161], v[96:97] op_sel_hi:[1,0,1]
  v_rcp_f32 v147, v147
  v_pk_fma_f32 v[98:99], v[198:199], v[160:161], v[98:99] op_sel_hi:[1,0,1]
  v_rcp_f32 v148, v148
  v_pk_mul_f32 v[136:137], v[80:81], v[162:163] op_sel_hi:[1,0]
  v_rcp_f32 v149, v149
  v_pk_mul_f32 v[138:139], v[82:83], v[162:163] op_sel_hi:[1,0]
  v_rcp_f32 v150, v150
  v_pk_mul_f32 v[140:141], v[96:97], v[162:163] op_sel_hi:[1,0]
  v_rcp_f32 v151, v151
  v_pk_mul_f32 v[142:143], v[98:99], v[162:163] op_sel_hi:[1,0]
  v_exp_f32 v136, v136
  v_pk_fma_f32 v[128:129], v[128:129], v[170:171], v[170:171] op_sel:[0,1,1] op_sel_hi:[1,1,1]
  v_pk_fma_f32 v[130:131], v[130:131], v[170:171], v[170:171] op_sel:[0,1,1] op_sel_hi:[1,1,1]
  v_exp_f32 v137, v137
  v_pk_fma_f32 v[132:133], v[132:133], v[174:175], v[174:175] op_sel:[0,1,1] op_sel_hi:[1,1,1]
  v_pk_fma_f32 v[134:135], v[134:135], v[174:175], v[174:175] op_sel:[0,1,1] op_sel_hi:[1,1,1]
  v_exp_f32 v138, v138
  v_pk_mul_f32 v[112:113], v[112:113], v[144:145]
  v_pk_mul_f32 v[114:115], v[114:115], v[146:147]
  v_exp_f32 v139, v139
  v_pk_mul_f32 v[116:117], v[116:117], v[148:149]
  v_pk_mul_f32 v[118:119], v[118:119], v[150:151]
  v_exp_f32 v140, v140
  v_cvt_pk_bf16_f32 v112, v112, v113
  v_cvt_pk_bf16_f32 v113, v114, v115
  v_exp_f32 v141, v141
  v_cvt_pk_bf16_f32 v114, v116, v117
  v_exp_f32 v142, v142
  v_cvt_pk_bf16_f32 v115, v118, v119
  v_exp_f32 v143, v143
  ds_write_b64 v8, v[112:113] offset:0
  ds_write_b64 v8, v[114:115] offset:2048
  v_rcp_f32 v128, v128
  v_pk_fma_f32 v[84:85], v[192:193], v[164:165], v[84:85] op_sel_hi:[1,0,1]
  v_rcp_f32 v129, v129
  v_pk_fma_f32 v[86:87], v[194:195], v[164:165], v[86:87] op_sel_hi:[1,0,1]
  v_rcp_f32 v130, v130
  v_pk_fma_f32 v[100:101], v[196:197], v[164:165], v[100:101] op_sel_hi:[1,0,1]
  v_rcp_f32 v131, v131
  v_pk_fma_f32 v[102:103], v[198:199], v[164:165], v[102:103] op_sel_hi:[1,0,1]
  v_rcp_f32 v132, v132
  v_pk_mul_f32 v[144:145], v[84:85], v[166:167] op_sel_hi:[1,0]
  v_rcp_f32 v133, v133
  v_pk_mul_f32 v[146:147], v[86:87], v[166:167] op_sel_hi:[1,0]
  v_rcp_f32 v134, v134
  v_pk_mul_f32 v[148:149], v[100:101], v[166:167] op_sel_hi:[1,0]
  v_rcp_f32 v135, v135
  v_pk_mul_f32 v[150:151], v[102:103], v[166:167] op_sel_hi:[1,0]
  v_exp_f32 v144, v144
  v_pk_fma_f32 v[136:137], v[136:137], v[162:163], v[162:163] op_sel:[0,1,1] op_sel_hi:[1,1,1]
  v_pk_fma_f32 v[138:139], v[138:139], v[162:163], v[162:163] op_sel:[0,1,1] op_sel_hi:[1,1,1]
  v_exp_f32 v145, v145
  v_pk_fma_f32 v[140:141], v[140:141], v[162:163], v[162:163] op_sel:[0,1,1] op_sel_hi:[1,1,1]
  v_pk_fma_f32 v[142:143], v[142:143], v[162:163], v[162:163] op_sel:[0,1,1] op_sel_hi:[1,1,1]
  v_exp_f32 v146, v146
  v_pk_mul_f32 v[120:121], v[120:121], v[128:129]
  v_pk_mul_f32 v[122:123], v[122:123], v[130:131]
  v_exp_f32 v147, v147
  v_pk_mul_f32 v[124:125], v[124:125], v[132:133]
  v_pk_mul_f32 v[126:127], v[126:127], v[134:135]
  v_exp_f32 v148, v148
  v_cvt_pk_bf16_f32 v120, v120, v121
  v_cvt_pk_bf16_f32 v121, v122, v123
  v_exp_f32 v149, v149
  v_cvt_pk_bf16_f32 v122, v124, v125
  v_exp_f32 v150, v150
  v_cvt_pk_bf16_f32 v123, v126, v127
  v_exp_f32 v151, v151
  ds_write_b64 v8, v[120:121] offset:4096
  ds_write_b64 v8, v[122:123] offset:6144
  v_rcp_f32 v136, v136
  v_pk_fma_f32 v[88:89], v[192:193], v[168:169], v[88:89] op_sel_hi:[1,0,1]
  v_rcp_f32 v137, v137
  v_pk_fma_f32 v[90:91], v[194:195], v[168:169], v[90:91] op_sel_hi:[1,0,1]
  v_rcp_f32 v138, v138
  v_pk_fma_f32 v[104:105], v[196:197], v[168:169], v[104:105] op_sel_hi:[1,0,1]
  v_rcp_f32 v139, v139
  v_pk_fma_f32 v[106:107], v[198:199], v[168:169], v[106:107] op_sel_hi:[1,0,1]
  v_rcp_f32 v140, v140
  v_pk_mul_f32 v[128:129], v[88:89], v[170:171] op_sel_hi:[1,0]
  v_rcp_f32 v141, v141
  v_pk_mul_f32 v[130:131], v[90:91], v[170:171] op_sel_hi:[1,0]
  v_rcp_f32 v142, v142
  v_pk_mul_f32 v[132:133], v[104:105], v[170:171] op_sel_hi:[1,0]
  v_rcp_f32 v143, v143
  v_pk_mul_f32 v[134:135], v[106:107], v[170:171] op_sel_hi:[1,0]
  v_exp_f32 v128, v128
  v_pk_fma_f32 v[144:145], v[144:145], v[166:167], v[166:167] op_sel:[0,1,1] op_sel_hi:[1,1,1]
  v_pk_fma_f32 v[146:147], v[146:147], v[166:167], v[166:167] op_sel:[0,1,1] op_sel_hi:[1,1,1]
  v_exp_f32 v129, v129
  v_pk_fma_f32 v[148:149], v[148:149], v[166:167], v[166:167] op_sel:[0,1,1] op_sel_hi:[1,1,1]
  v_pk_fma_f32 v[150:151], v[150:151], v[166:167], v[166:167] op_sel:[0,1,1] op_sel_hi:[1,1,1]
  v_exp_f32 v130, v130
  v_pk_mul_f32 v[80:81], v[80:81], v[136:137]
  v_pk_mul_f32 v[82:83], v[82:83], v[138:139]
  v_exp_f32 v131, v131
  v_pk_mul_f32 v[96:97], v[96:97], v[140:141]
  v_pk_mul_f32 v[98:99], v[98:99], v[142:143]
  v_exp_f32 v132, v132
  v_cvt_pk_bf16_f32 v80, v80, v81
  v_cvt_pk_bf16_f32 v81, v82, v83
  v_exp_f32 v133, v133
  v_cvt_pk_bf16_f32 v82, v96, v97
  v_exp_f32 v134, v134
  v_cvt_pk_bf16_f32 v83, v98, v99
  v_exp_f32 v135, v135
  buffer_store_dwordx4 v[80:83], v13, s[28:31], s42 offen offset:0 sc1
  ds_write_b128 v4, v[80:83] offset:0
  s_waitcnt vmcnt(1) lgkmcnt(1)
  s_barrier
  ds_read_b128 v[224:227], v5 offset:0
  ds_read_b128 v[228:231], v5 offset:2048
  v_rcp_f32 v144, v144
  v_pk_fma_f32 v[92:93], v[192:193], v[172:173], v[92:93] op_sel_hi:[1,0,1]
  v_rcp_f32 v145, v145
  v_pk_fma_f32 v[94:95], v[194:195], v[172:173], v[94:95] op_sel_hi:[1,0,1]
  v_rcp_f32 v146, v146
  v_pk_fma_f32 v[108:109], v[196:197], v[172:173], v[108:109] op_sel_hi:[1,0,1]
  v_rcp_f32 v147, v147
  v_pk_fma_f32 v[110:111], v[198:199], v[172:173], v[110:111] op_sel_hi:[1,0,1]
  v_rcp_f32 v148, v148
  v_pk_mul_f32 v[136:137], v[92:93], v[174:175] op_sel_hi:[1,0]
  v_rcp_f32 v149, v149
  v_pk_mul_f32 v[138:139], v[94:95], v[174:175] op_sel_hi:[1,0]
  v_rcp_f32 v150, v150
  v_pk_mul_f32 v[140:141], v[108:109], v[174:175] op_sel_hi:[1,0]
  v_rcp_f32 v151, v151
  v_pk_mul_f32 v[142:143], v[110:111], v[174:175] op_sel_hi:[1,0]
  v_exp_f32 v136, v136
  v_pk_fma_f32 v[128:129], v[128:129], v[170:171], v[170:171] op_sel:[0,1,1] op_sel_hi:[1,1,1]
  v_pk_fma_f32 v[130:131], v[130:131], v[170:171], v[170:171] op_sel:[0,1,1] op_sel_hi:[1,1,1]
  v_exp_f32 v137, v137
  v_pk_fma_f32 v[132:133], v[132:133], v[170:171], v[170:171] op_sel:[0,1,1] op_sel_hi:[1,1,1]
  v_pk_fma_f32 v[134:135], v[134:135], v[170:171], v[170:171] op_sel:[0,1,1] op_sel_hi:[1,1,1]
  v_exp_f32 v138, v138
  v_pk_mul_f32 v[84:85], v[84:85], v[144:145]
  v_pk_mul_f32 v[86:87], v[86:87], v[146:147]
  v_exp_f32 v139, v139
  v_pk_mul_f32 v[100:101], v[100:101], v[148:149]
  v_pk_mul_f32 v[102:103], v[102:103], v[150:151]
  v_exp_f32 v140, v140
  v_cvt_pk_bf16_f32 v84, v84, v85
  v_cvt_pk_bf16_f32 v85, v86, v87
  v_exp_f32 v141, v141
  v_cvt_pk_bf16_f32 v86, v100, v101
  v_exp_f32 v142, v142
  v_cvt_pk_bf16_f32 v87, v102, v103
  v_exp_f32 v143, v143
  buffer_store_dwordx4 v[84:87], v13, s[28:31], s42 offen offset:2048 sc1
  ds_write_b128 v4, v[84:87] offset:2048
  s_waitcnt lgkmcnt(1)
  buffer_store_dwordx4 v[224:227], v7, s[28:31], s43 offen offset:0 sc1
  buffer_store_dwordx4 v[228:231], v7, s[28:31], s43 offen offset:2048 sc1
  v_rcp_f32 v128, v128
  v_rcp_f32 v129, v129
  v_rcp_f32 v130, v130
  v_rcp_f32 v131, v131
  v_rcp_f32 v132, v132
  v_rcp_f32 v133, v133
  v_rcp_f32 v134, v134
  v_rcp_f32 v135, v135
  v_pk_fma_f32 v[136:137], v[136:137], v[174:175], v[174:175] op_sel:[0,1,1] op_sel_hi:[1,1,1]
  v_pk_fma_f32 v[138:139], v[138:139], v[174:175], v[174:175] op_sel:[0,1,1] op_sel_hi:[1,1,1]
  v_pk_fma_f32 v[140:141], v[140:141], v[174:175], v[174:175] op_sel:[0,1,1] op_sel_hi:[1,1,1]
  v_pk_fma_f32 v[142:143], v[142:143], v[174:175], v[174:175] op_sel:[0,1,1] op_sel_hi:[1,1,1]
  v_pk_mul_f32 v[88:89], v[88:89], v[128:129]
  v_pk_mul_f32 v[90:91], v[90:91], v[130:131]
  v_pk_mul_f32 v[104:105], v[104:105], v[132:133]
  v_pk_mul_f32 v[106:107], v[106:107], v[134:135]
  v_cvt_pk_bf16_f32 v88, v88, v89
  v_cvt_pk_bf16_f32 v89, v90, v91
  v_cvt_pk_bf16_f32 v90, v104, v105
  v_cvt_pk_bf16_f32 v91, v106, v107
  buffer_store_dwordx4 v[88:91], v15, s[28:31], s42 offen offset:0 sc1
  ds_write_b128 v4, v[88:91] offset:4096
  v_rcp_f32 v136, v136
  v_rcp_f32 v137, v137
  v_rcp_f32 v138, v138
  v_rcp_f32 v139, v139
  v_rcp_f32 v140, v140
  v_rcp_f32 v141, v141
  v_rcp_f32 v142, v142
  v_rcp_f32 v143, v143
  s_nop 0
  v_pk_mul_f32 v[92:93], v[92:93], v[136:137]
  v_pk_mul_f32 v[94:95], v[94:95], v[138:139]
  v_pk_mul_f32 v[108:109], v[108:109], v[140:141]
  v_pk_mul_f32 v[110:111], v[110:111], v[142:143]
  v_cvt_pk_bf16_f32 v92, v92, v93
  v_cvt_pk_bf16_f32 v93, v94, v95
  v_cvt_pk_bf16_f32 v94, v108, v109
  v_cvt_pk_bf16_f32 v95, v110, v111
  buffer_store_dwordx4 v[92:95], v15, s[28:31], s42 offen offset:2048 sc1
  ds_write_b128 v4, v[92:95] offset:6144
  s_mov_b32 s44, 1
  s_mov_b32 s45, 1
  s_mov_b32 s46, 16384
  s_mov_b32 s47, 16384
  s_mov_b32 s48, 0
  s_mov_b32 s80, 16384
  s_mov_b32 s81, 4294918144
  s_mov_b32 s82, 16384
  s_mov_b32 s83, 4294901760
  s_waitcnt lgkmcnt(0)
  s_barrier
  ds_read_b128 v[80:83], v248 offset:0
  ds_read_b128 v[84:87], v248 offset:2048
  ds_read_b128 v[88:91], v248 offset:4096
  ds_read_b128 v[92:95], v248 offset:6144
  ds_read_b64_tr_b16 v[144:145], v250 offset:0
  ds_read_b64_tr_b16 v[146:147], v250 offset:4096
  ds_read_b64_tr_b16 v[148:149], v251 offset:0
  ds_read_b64_tr_b16 v[150:151], v251 offset:4096
  ds_read_b64_tr_b16 v[152:153], v250 offset:1024
  ds_read_b64_tr_b16 v[154:155], v250 offset:5120
  ds_read_b64_tr_b16 v[156:157], v251 offset:1024
  ds_read_b64_tr_b16 v[158:159], v251 offset:5120
  ds_read_b128 v[96:99], v248 offset:1024
  ds_read_b128 v[100:103], v248 offset:3072
  ds_read_b128 v[104:107], v248 offset:5120
  ds_read_b128 v[108:111], v248 offset:7168
  ds_read_b64_tr_b16 v[160:161], v250 offset:8192
  ds_read_b64_tr_b16 v[162:163], v250 offset:12288
  ds_read_b64_tr_b16 v[164:165], v251 offset:8192
  ds_read_b64_tr_b16 v[166:167], v251 offset:12288
  ds_read_b64_tr_b16 v[168:169], v250 offset:9216
  ds_read_b64_tr_b16 v[170:171], v250 offset:13312
  ds_read_b64_tr_b16 v[172:173], v251 offset:9216
  ds_read_b64_tr_b16 v[174:175], v251 offset:13312
  v_add_u32 v248, s46, v248
  v_add_u32 v250, s47, v250
  v_add_u32 v251, s47, v251
  s_add_u32 s44, s44, 1
  s_cmp_eq_u32 s44, 4
  s_cselect_b32 s44, 0, s44
  s_cselect_b32 s46, s81, s80
  s_add_u32 s45, s45, 1
  s_cmp_eq_u32 s45, 5
  s_cselect_b32 s45, 0, s45
  s_cselect_b32 s47, s83, s82
  v_mov_b32 v16, 0
  v_mov_b32 v17, 0
  v_mov_b32 v18, 0
  v_mov_b32 v19, 0
  v_mov_b32 v20, 0
  v_mov_b32 v21, 0
  v_mov_b32 v22, 0
  v_mov_b32 v23, 0
  v_mov_b32 v24, 0
  v_mov_b32 v25, 0
  v_mov_b32 v26, 0
  v_mov_b32 v27, 0
  v_mov_b32 v28, 0
  v_mov_b32 v29, 0
  v_mov_b32 v30, 0
  v_mov_b32 v31, 0
  v_mov_b32 v32, 0
  v_mov_b32 v33, 0
  v_mov_b32 v34, 0
  v_mov_b32 v35, 0
  v_mov_b32 v36, 0
  v_mov_b32 v37, 0
  v_mov_b32 v38, 0
  v_mov_b32 v39, 0
  v_mov_b32 v40, 0
  v_mov_b32 v41, 0
  v_mov_b32 v42, 0
  v_mov_b32 v43, 0
  v_mov_b32 v44, 0
  v_mov_b32 v45, 0
  v_mov_b32 v46, 0
  v_mov_b32 v47, 0
  v_lshlrev_b32 v48, 16, v232
  v_and_b32 v49, 0xffff0000, v232
  v_lshlrev_b32 v50, 16, v233
  v_and_b32 v51, 0xffff0000, v233
  v_lshlrev_b32 v64, 16, v234
  v_and_b32 v65, 0xffff0000, v234
  v_lshlrev_b32 v66, 16, v235
  v_and_b32 v67, 0xffff0000, v235
  v_lshlrev_b32 v52, 16, v236
  v_and_b32 v53, 0xffff0000, v236
  v_lshlrev_b32 v54, 16, v237
  v_and_b32 v55, 0xffff0000, v237
  v_lshlrev_b32 v68, 16, v238
  v_and_b32 v69, 0xffff0000, v238
  v_lshlrev_b32 v70, 16, v239
  v_and_b32 v71, 0xffff0000, v239
  v_lshlrev_b32 v56, 16, v240
  v_and_b32 v57, 0xffff0000, v240
  v_lshlrev_b32 v58, 16, v241
  v_and_b32 v59, 0xffff0000, v241
  v_lshlrev_b32 v72, 16, v242
  v_and_b32 v73, 0xffff0000, v242
  v_lshlrev_b32 v74, 16, v243
  v_and_b32 v75, 0xffff0000, v243
  v_lshlrev_b32 v60, 16, v244
  v_and_b32 v61, 0xffff0000, v244
  v_lshlrev_b32 v62, 16, v245
  v_and_b32 v63, 0xffff0000, v245
  v_lshlrev_b32 v76, 16, v246
  v_and_b32 v77, 0xffff0000, v246
  v_lshlrev_b32 v78, 16, v247
  v_and_b32 v79, 0xffff0000, v247
  s_waitcnt lgkmcnt(0)
.p2align 6
Lg111:
  s_barrier
  v_mfma_f32_16x16x32_bf16 v[16:19], v[144:147], v[80:83], v[16:19]
  ds_read_b128 v[112:115], v248 offset:0
  v_mfma_f32_16x16x32_bf16 v[16:19], v[160:163], v[96:99], v[16:19]
  ds_read_b128 v[116:119], v248 offset:2048
  v_mfma_f32_16x16x32_bf16 v[20:23], v[160:163], v[100:103], v[20:23]
  ds_read_b128 v[120:123], v248 offset:4096
  v_mfma_f32_16x16x32_bf16 v[20:23], v[144:147], v[84:87], v[20:23]
  ds_read_b128 v[124:127], v248 offset:6144
  v_mfma_f32_16x16x32_bf16 v[24:27], v[144:147], v[88:91], v[24:27]
  ds_read_b64_tr_b16 v[176:177], v250 offset:0
  v_mfma_f32_16x16x32_bf16 v[24:27], v[160:163], v[104:107], v[24:27]
  ds_read_b64_tr_b16 v[178:179], v250 offset:4096
  v_mfma_f32_16x16x32_bf16 v[28:31], v[160:163], v[108:111], v[28:31]
  ds_read_b64_tr_b16 v[180:181], v251 offset:0
  v_mfma_f32_16x16x32_bf16 v[28:31], v[144:147], v[92:95], v[28:31]
  ds_read_b64_tr_b16 v[182:183], v251 offset:4096
  v_mfma_f32_16x16x32_bf16 v[44:47], v[148:151], v[92:95], v[44:47]
  ds_read_b64_tr_b16 v[184:185], v250 offset:1024
  v_mfma_f32_16x16x32_bf16 v[44:47], v[164:167], v[108:111], v[44:47]
  ds_read_b64_tr_b16 v[186:187], v250 offset:5120
  v_mfma_f32_16x16x32_bf16 v[40:43], v[164:167], v[104:107], v[40:43]
  ds_read_b64_tr_b16 v[188:189], v251 offset:1024
  v_mfma_f32_16x16x32_bf16 v[40:43], v[148:151], v[88:91], v[40:43]
  ds_read_b64_tr_b16 v[190:191], v251 offset:5120
  v_mfma_f32_16x16x32_bf16 v[36:39], v[148:151], v[84:87], v[36:39]
  ds_read_b128 v[128:131], v248 offset:1024
  v_mfma_f32_16x16x32_bf16 v[36:39], v[164:167], v[100:103], v[36:39]
  ds_read_b128 v[132:135], v248 offset:3072
  v_mfma_f32_16x16x32_bf16 v[32:35], v[164:167], v[96:99], v[32:35]
  ds_read_b128 v[136:139], v248 offset:5120
  v_mfma_f32_16x16x32_bf16 v[32:35], v[148:151], v[80:83], v[32:35]
  ds_read_b128 v[140:143], v248 offset:7168
  v_mfma_f32_16x16x32_bf16 v[48:51], v[152:155], v[80:83], v[48:51]
  ds_read_b64_tr_b16 v[192:193], v250 offset:8192
  v_mfma_f32_16x16x32_bf16 v[48:51], v[168:171], v[96:99], v[48:51]
  ds_read_b64_tr_b16 v[194:195], v250 offset:12288
  v_mfma_f32_16x16x32_bf16 v[52:55], v[168:171], v[100:103], v[52:55]
  ds_read_b64_tr_b16 v[196:197], v251 offset:8192
  v_mfma_f32_16x16x32_bf16 v[52:55], v[152:155], v[84:87], v[52:55]
  ds_read_b64_tr_b16 v[198:199], v251 offset:12288
  v_mfma_f32_16x16x32_bf16 v[56:59], v[152:155], v[88:91], v[56:59]
  ds_read_b64_tr_b16 v[200:201], v250 offset:9216
  v_mfma_f32_16x16x32_bf16 v[56:59], v[168:171], v[104:107], v[56:59]
  ds_read_b64_tr_b16 v[202:203], v250 offset:13312
  v_mfma_f32_16x16x32_bf16 v[60:63], v[168:171], v[108:111], v[60:63]
  ds_read_b64_tr_b16 v[204:205], v251 offset:9216
  v_mfma_f32_16x16x32_bf16 v[60:63], v[152:155], v[92:95], v[60:63]
  ds_read_b64_tr_b16 v[206:207], v251 offset:13312
  v_mfma_f32_16x16x32_bf16 v[76:79], v[156:159], v[92:95], v[76:79]
  v_add_u32 v248, s46, v248
  v_add_u32 v250, s47, v250
  v_add_u32 v251, s47, v251
  v_mfma_f32_16x16x32_bf16 v[76:79], v[172:175], v[108:111], v[76:79]
  s_add_u32 s44, s44, 1
  s_cmp_eq_u32 s44, 4
  v_mfma_f32_16x16x32_bf16 v[72:75], v[172:175], v[104:107], v[72:75]
  s_cselect_b32 s44, 0, s44
  s_cselect_b32 s46, s81, s80
  v_mfma_f32_16x16x32_bf16 v[72:75], v[156:159], v[88:91], v[72:75]
  s_add_u32 s45, s45, 1
  s_cmp_eq_u32 s45, 5
  v_mfma_f32_16x16x32_bf16 v[68:71], v[156:159], v[84:87], v[68:71]
  s_cselect_b32 s45, 0, s45
  s_cselect_b32 s47, s83, s82
  v_mfma_f32_16x16x32_bf16 v[68:71], v[172:175], v[100:103], v[68:71]
  v_mfma_f32_16x16x32_bf16 v[64:67], v[172:175], v[96:99], v[64:67]
  s_waitcnt vmcnt(0) lgkmcnt(0)
  v_mfma_f32_16x16x32_bf16 v[64:67], v[156:159], v[80:83], v[64:67]
  s_barrier
  v_mfma_f32_16x16x32_bf16 v[16:19], v[176:179], v[112:115], v[16:19]
  ds_read_b128 v[80:83], v248 offset:0
  v_mfma_f32_16x16x32_bf16 v[16:19], v[192:195], v[128:131], v[16:19]
  ds_read_b128 v[84:87], v248 offset:2048
  v_mfma_f32_16x16x32_bf16 v[20:23], v[192:195], v[132:135], v[20:23]
  ds_read_b128 v[88:91], v248 offset:4096
  v_mfma_f32_16x16x32_bf16 v[20:23], v[176:179], v[116:119], v[20:23]
  ds_read_b128 v[92:95], v248 offset:6144
  v_mfma_f32_16x16x32_bf16 v[24:27], v[176:179], v[120:123], v[24:27]
  ds_read_b64_tr_b16 v[144:145], v250 offset:0
  v_mfma_f32_16x16x32_bf16 v[24:27], v[192:195], v[136:139], v[24:27]
  ds_read_b64_tr_b16 v[146:147], v250 offset:4096
  v_mfma_f32_16x16x32_bf16 v[28:31], v[192:195], v[140:143], v[28:31]
  ds_read_b64_tr_b16 v[148:149], v251 offset:0
  v_mfma_f32_16x16x32_bf16 v[28:31], v[176:179], v[124:127], v[28:31]
  ds_read_b64_tr_b16 v[150:151], v251 offset:4096
  v_mfma_f32_16x16x32_bf16 v[44:47], v[180:183], v[124:127], v[44:47]
  ds_read_b64_tr_b16 v[152:153], v250 offset:1024
  v_mfma_f32_16x16x32_bf16 v[44:47], v[196:199], v[140:143], v[44:47]
  ds_read_b64_tr_b16 v[154:155], v250 offset:5120
  v_mfma_f32_16x16x32_bf16 v[40:43], v[196:199], v[136:139], v[40:43]
  ds_read_b64_tr_b16 v[156:157], v251 offset:1024
  v_mfma_f32_16x16x32_bf16 v[40:43], v[180:183], v[120:123], v[40:43]
  ds_read_b64_tr_b16 v[158:159], v251 offset:5120
  v_mfma_f32_16x16x32_bf16 v[36:39], v[180:183], v[116:119], v[36:39]
  ds_read_b128 v[96:99], v248 offset:1024
  v_mfma_f32_16x16x32_bf16 v[36:39], v[196:199], v[132:135], v[36:39]
  ds_read_b128 v[100:103], v248 offset:3072
  v_mfma_f32_16x16x32_bf16 v[32:35], v[196:199], v[128:131], v[32:35]
  ds_read_b128 v[104:107], v248 offset:5120
  v_mfma_f32_16x16x32_bf16 v[32:35], v[180:183], v[112:115], v[32:35]
  ds_read_b128 v[108:111], v248 offset:7168
  v_mfma_f32_16x16x32_bf16 v[48:51], v[184:187], v[112:115], v[48:51]
  ds_read_b64_tr_b16 v[160:161], v250 offset:8192
  v_mfma_f32_16x16x32_bf16 v[48:51], v[200:203], v[128:131], v[48:51]
  ds_read_b64_tr_b16 v[162:163], v250 offset:12288
  v_mfma_f32_16x16x32_bf16 v[52:55], v[200:203], v[132:135], v[52:55]
  ds_read_b64_tr_b16 v[164:165], v251 offset:8192
  v_mfma_f32_16x16x32_bf16 v[52:55], v[184:187], v[116:119], v[52:55]
  ds_read_b64_tr_b16 v[166:167], v251 offset:12288
  v_mfma_f32_16x16x32_bf16 v[56:59], v[184:187], v[120:123], v[56:59]
  ds_read_b64_tr_b16 v[168:169], v250 offset:9216
  v_mfma_f32_16x16x32_bf16 v[56:59], v[200:203], v[136:139], v[56:59]
  ds_read_b64_tr_b16 v[170:171], v250 offset:13312
  v_mfma_f32_16x16x32_bf16 v[60:63], v[200:203], v[140:143], v[60:63]
  ds_read_b64_tr_b16 v[172:173], v251 offset:9216
  v_mfma_f32_16x16x32_bf16 v[60:63], v[184:187], v[124:127], v[60:63]
  ds_read_b64_tr_b16 v[174:175], v251 offset:13312
  v_mfma_f32_16x16x32_bf16 v[76:79], v[188:191], v[124:127], v[76:79]
  v_add_u32 v248, s46, v248
  v_add_u32 v250, s47, v250
  v_add_u32 v251, s47, v251
  v_mfma_f32_16x16x32_bf16 v[76:79], v[204:207], v[140:143], v[76:79]
  s_add_u32 s44, s44, 1
  s_cmp_eq_u32 s44, 4
  v_mfma_f32_16x16x32_bf16 v[72:75], v[204:207], v[136:139], v[72:75]
  s_cselect_b32 s44, 0, s44
  s_cselect_b32 s46, s81, s80
  v_mfma_f32_16x16x32_bf16 v[72:75], v[188:191], v[120:123], v[72:75]
  s_add_u32 s45, s45, 1
  s_cmp_eq_u32 s45, 5
  v_mfma_f32_16x16x32_bf16 v[68:71], v[188:191], v[116:119], v[68:71]
  s_cselect_b32 s45, 0, s45
  s_cselect_b32 s47, s83, s82
  v_mfma_f32_16x16x32_bf16 v[68:71], v[204:207], v[132:135], v[68:71]
  s_add_u32 s48, s48, 1
  s_cmp_lt_u32 s48, 13
  v_mfma_f32_16x16x32_bf16 v[64:67], v[204:207], v[128:131], v[64:67]
  s_waitcnt lgkmcnt(0)
  v_mfma_f32_16x16x32_bf16 v[64:67], v[188:191], v[112:115], v[64:67]
  s_cbranch_scc1 Lg111
  s_barrier
  v_mfma_f32_16x16x32_bf16 v[16:19], v[144:147], v[80:83], v[16:19]
  ds_read_b128 v[112:115], v248 offset:0
  ds_read_b128 v[116:119], v248 offset:2048
  v_mfma_f32_16x16x32_bf16 v[16:19], v[160:163], v[96:99], v[16:19]
  ds_read_b128 v[120:123], v248 offset:4096
  ds_read_b128 v[124:127], v248 offset:6144
  v_mfma_f32_16x16x32_bf16 v[20:23], v[160:163], v[100:103], v[20:23]
  ds_read_b64_tr_b16 v[176:177], v250 offset:0
  ds_read_b64_tr_b16 v[178:179], v250 offset:4096
  v_mfma_f32_16x16x32_bf16 v[20:23], v[144:147], v[84:87], v[20:23]
  ds_read_b64_tr_b16 v[180:181], v251 offset:0
  ds_read_b64_tr_b16 v[182:183], v251 offset:4096
  v_mfma_f32_16x16x32_bf16 v[24:27], v[144:147], v[88:91], v[24:27]
  ds_read_b64_tr_b16 v[184:185], v250 offset:1024
  ds_read_b64_tr_b16 v[186:187], v250 offset:5120
  v_mfma_f32_16x16x32_bf16 v[24:27], v[160:163], v[104:107], v[24:27]
  ds_read_b64_tr_b16 v[188:189], v251 offset:1024
  ds_read_b64_tr_b16 v[190:191], v251 offset:5120
  v_mfma_f32_16x16x32_bf16 v[28:31], v[160:163], v[108:111], v[28:31]
  ds_read_b128 v[128:131], v248 offset:1024
  ds_read_b128 v[132:135], v248 offset:3072
  v_mfma_f32_16x16x32_bf16 v[28:31], v[144:147], v[92:95], v[28:31]
  ds_read_b128 v[136:139], v248 offset:5120
  ds_read_b128 v[140:143], v248 offset:7168
  v_mfma_f32_16x16x32_bf16 v[44:47], v[148:151], v[92:95], v[44:47]
  ds_read_b64_tr_b16 v[192:193], v250 offset:8192
  ds_read_b64_tr_b16 v[194:195], v250 offset:12288
  v_mfma_f32_16x16x32_bf16 v[44:47], v[164:167], v[108:111], v[44:47]
  ds_read_b64_tr_b16 v[196:197], v251 offset:8192
  ds_read_b64_tr_b16 v[198:199], v251 offset:12288
  v_mfma_f32_16x16x32_bf16 v[40:43], v[164:167], v[104:107], v[40:43]
  ds_read_b64_tr_b16 v[200:201], v250 offset:9216
  ds_read_b64_tr_b16 v[202:203], v250 offset:13312
  v_mfma_f32_16x16x32_bf16 v[40:43], v[148:151], v[88:91], v[40:43]
  ds_read_b64_tr_b16 v[204:205], v251 offset:9216
  ds_read_b64_tr_b16 v[206:207], v251 offset:13312
  v_mfma_f32_16x16x32_bf16 v[36:39], v[148:151], v[84:87], v[36:39]
  s_lshl_b32 s39, s36, 14
  s_lshl_b32 s42, s37, 12
  v_mfma_f32_16x16x32_bf16 v[36:39], v[164:167], v[100:103], v[36:39]
  s_add_u32 s39, s39, s42
  s_add_u32 s39, s39, s23
  v_mfma_f32_16x16x32_bf16 v[32:35], v[164:167], v[96:99], v[32:35]
  s_add_u32 s39, s39, 12582912
  s_add_u32 s40, s73, s39
  v_mfma_f32_16x16x32_bf16 v[32:35], v[148:151], v[80:83], v[32:35]
  s_add_u32 s41, s72, s39
  s_mov_b32 s70, 0
  v_mfma_f32_16x16x32_bf16 v[48:51], v[152:155], v[80:83], v[48:51]
  v_lshlrev_b32 v13, 4, v1
  v_mfma_f32_16x16x32_bf16 v[48:51], v[168:171], v[96:99], v[48:51]
  v_mfma_f32_16x16x32_bf16 v[52:55], v[168:171], v[100:103], v[52:55]
  v_mfma_f32_16x16x32_bf16 v[52:55], v[152:155], v[84:87], v[52:55]
  s_waitcnt lgkmcnt(0)
  s_barrier
  v_mfma_f32_16x16x32_bf16 v[28:31], v[192:195], v[140:143], v[28:31]
  buffer_load_dwordx4 v[144:147], v13, s[28:31], s41 offen offset:0 sc1
  buffer_load_dwordx4 v[148:151], v13, s[28:31], s41 offen offset:1024 sc1
  v_mfma_f32_16x16x32_bf16 v[28:31], v[176:179], v[124:127], v[28:31]
  buffer_load_dwordx4 v[160:163], v13, s[28:31], s41 offen offset:2048 sc1
  buffer_load_dwordx4 v[164:167], v13, s[28:31], s41 offen offset:3072 sc1
  v_mfma_f32_16x16x32_bf16 v[44:47], v[180:183], v[124:127], v[44:47]
  s_lshl_b32 s51, s37, 10
  s_add_u32 s51, s51, s38
  v_mfma_f32_16x16x32_bf16 v[44:47], v[196:199], v[140:143], v[44:47]
  s_add_u32 s39, s72, s51
  s_add_u32 s39, s39, s38
  v_mfma_f32_16x16x32_bf16 v[24:27], v[176:179], v[120:123], v[24:27]
  s_add_u32 s50, s39, s23
  s_add_u32 s50, s50, 46137344
  v_mfma_f32_16x16x32_bf16 v[24:27], v[192:195], v[136:139], v[24:27]
  v_lshlrev_b32 v13, 4, v1
  v_add_u32 v12, s51, v13
  v_cvt_pk_bf16_f32 v28, v28, v29
  v_mfma_f32_16x16x32_bf16 v[40:43], v[196:199], v[136:139], v[40:43]
  v_cvt_pk_bf16_f32 v29, v30, v31
  v_cvt_pk_bf16_f32 v30, v44, v45
  v_cvt_pk_bf16_f32 v31, v46, v47
  v_mfma_f32_16x16x32_bf16 v[40:43], v[180:183], v[120:123], v[40:43]
  v_min_u32 v28, -2, v28
  v_min_u32 v29, -2, v29
  v_min_u32 v30, -2, v30
  v_mfma_f32_16x16x32_bf16 v[20:23], v[192:195], v[132:135], v[20:23]
  v_min_u32 v31, -2, v31
  buffer_store_dwordx4 v[28:31], v13, s[28:31], s40 offen offset:3072 sc1
  v_mfma_f32_16x16x32_bf16 v[20:23], v[176:179], v[116:119], v[20:23]
  v_add_u32 v11, 4096, v12
  v_cvt_pk_bf16_f32 v24, v24, v25
  v_cvt_pk_bf16_f32 v25, v26, v27
  v_mfma_f32_16x16x32_bf16 v[36:39], v[180:183], v[116:119], v[36:39]
  v_cvt_pk_bf16_f32 v26, v40, v41
  v_cvt_pk_bf16_f32 v27, v42, v43
  v_min_u32 v24, -2, v24
  v_mfma_f32_16x16x32_bf16 v[36:39], v[196:199], v[132:135], v[36:39]
  v_min_u32 v25, -2, v25
  v_min_u32 v26, -2, v26
  v_min_u32 v27, -2, v27
  v_mfma_f32_16x16x32_bf16 v[16:19], v[176:179], v[112:115], v[16:19]
  buffer_store_dwordx4 v[24:27], v13, s[28:31], s40 offen offset:2048 sc1
  s_add_u32 s51, s50, 4096
  v_mfma_f32_16x16x32_bf16 v[16:19], v[192:195], v[128:131], v[16:19]
  s_lshl_b32 s39, s36, 12
  v_cvt_pk_bf16_f32 v20, v20, v21
  v_cvt_pk_bf16_f32 v21, v22, v23
  v_mfma_f32_16x16x32_bf16 v[32:35], v[196:199], v[128:131], v[32:35]
  v_cvt_pk_bf16_f32 v22, v36, v37
  v_cvt_pk_bf16_f32 v23, v38, v39
  v_min_u32 v20, -2, v20
  v_mfma_f32_16x16x32_bf16 v[32:35], v[180:183], v[112:115], v[32:35]
  v_min_u32 v21, -2, v21
  v_min_u32 v22, -2, v22
  v_min_u32 v23, -2, v23
  v_mfma_f32_16x16x32_bf16 v[56:59], v[152:155], v[88:91], v[56:59]
  buffer_store_dwordx4 v[20:23], v13, s[28:31], s40 offen offset:1024 sc1
  v_add_u32 v12, s39, v12
  v_mfma_f32_16x16x32_bf16 v[56:59], v[168:171], v[104:107], v[56:59]
  s_mul_i32 s39, s36, -12288
  v_cvt_pk_bf16_f32 v16, v16, v17
  v_cvt_pk_bf16_f32 v17, v18, v19
  v_mfma_f32_16x16x32_bf16 v[60:63], v[168:171], v[108:111], v[60:63]
  v_cvt_pk_bf16_f32 v18, v32, v33
  v_cvt_pk_bf16_f32 v19, v34, v35
  v_min_u32 v16, -2, v16
  v_mfma_f32_16x16x32_bf16 v[60:63], v[152:155], v[92:95], v[60:63]
  v_min_u32 v17, -2, v17
  v_min_u32 v18, -2, v18
  v_min_u32 v19, -2, v19
  v_mfma_f32_16x16x32_bf16 v[76:79], v[156:159], v[92:95], v[76:79]
  buffer_store_dwordx4 v[16:19], v13, s[28:31], s40 offen offset:0 sc1
  s_add_u32 s39, s39, 4096
  v_mfma_f32_16x16x32_bf16 v[76:79], v[172:175], v[108:111], v[76:79]
  v_add_u32 v11, s39, v11
  v_lshrrev_b32 v2, 4, v1
  v_mfma_f32_16x16x32_bf16 v[72:75], v[172:175], v[104:107], v[72:75]
  v_bfe_u32 v3, v1, 2, 2
  v_cmp_eq_u32 vcc, v2, v3
  v_mfma_f32_16x16x32_bf16 v[72:75], v[156:159], v[88:91], v[72:75]
  v_and_b32 v2, 1, v1
  v_lshlrev_b32 v2, 4, v2
  v_mfma_f32_16x16x32_bf16 v[68:71], v[156:159], v[84:87], v[68:71]
  v_mov_b32 v3, 0x3f80
  v_lshlrev_b32 v2, v2, v3
  v_mfma_f32_16x16x32_bf16 v[68:71], v[172:175], v[100:103], v[68:71]
  v_cndmask_b32 v2, 0, v2, vcc
  v_and_b32 v3, 2, v1
  v_mfma_f32_16x16x32_bf16 v[64:67], v[172:175], v[96:99], v[64:67]
  v_cmp_eq_u32 vcc, 0, v3
  v_mov_b32 v210, 0
  v_mfma_f32_16x16x32_bf16 v[64:67], v[156:159], v[80:83], v[64:67]
  v_mov_b32 v211, 0
  v_cndmask_b32 v212, 0, v2, vcc
  v_mfma_f32_16x16x32_bf16 v[48:51], v[184:187], v[112:115], v[48:51]
  v_cndmask_b32 v213, v2, 0, vcc
  v_mov_b32 v214, 0
  v_mfma_f32_16x16x32_bf16 v[48:51], v[200:203], v[128:131], v[48:51]
  v_mov_b32 v215, 0
  s_lshl_b32 s39, s24, 18
  v_mfma_f32_16x16x32_bf16 v[52:55], v[200:203], v[132:135], v[52:55]
  s_lshl_b32 s52, s36, 17
  s_add_u32 s39, s39, s52
  v_mfma_f32_16x16x32_bf16 v[52:55], v[184:187], v[116:119], v[52:55]
  s_lshl_b32 s52, s25, 7
  s_add_u32 s39, s39, s52
  v_mfma_f32_16x16x32_bf16 v[56:59], v[184:187], v[120:123], v[56:59]
  s_lshl_b32 s52, s37, 6
  s_add_u32 s52, s39, s52
  v_mfma_f32_16x16x32_bf16 v[56:59], v[200:203], v[136:139], v[56:59]
  s_add_u32 s53, s52, 32768
  s_add_u32 s54, s52, 65536
  v_mfma_f32_16x16x32_bf16 v[60:63], v[200:203], v[140:143], v[60:63]
  s_add_u32 s55, s52, 98304
  v_and_b32 v4, 15, v1
  v_mfma_f32_16x16x32_bf16 v[60:63], v[184:187], v[124:127], v[60:63]
  v_lshlrev_b32 v4, 11, v4
  v_bfe_u32 v5, v1, 4, 1
  v_mfma_f32_16x16x32_bf16 v[76:79], v[188:191], v[124:127], v[76:79]
  v_lshl_add_u32 v4, v5, 5, v4
  v_lshrrev_b32 v5, 5, v1
  v_mfma_f32_16x16x32_bf16 v[76:79], v[204:207], v[140:143], v[76:79]
  v_lshl_add_u32 v4, v5, 4, v4
  v_mfma_f32_16x16x32_bf16 v[72:75], v[204:207], v[136:139], v[72:75]
  s_waitcnt vmcnt(7)
  v_max_u32 v208, v144, v145
  v_mfma_f32_16x16x32_bf16 v[72:75], v[188:191], v[120:123], v[72:75]
  v_max3_u32 v208, v208, v146, v147
  s_waitcnt vmcnt(6)
  v_mfma_f32_16x16x32_bf16 v[68:71], v[188:191], v[116:119], v[68:71]
  v_max3_u32 v208, v208, v148, v149
  v_max3_u32 v208, v208, v150, v151
  v_mfma_f32_16x16x32_bf16 v[68:71], v[204:207], v[132:135], v[68:71]
  s_waitcnt vmcnt(5)
  v_max3_u32 v208, v208, v160, v161
  v_mfma_f32_16x16x32_bf16 v[64:67], v[204:207], v[128:131], v[64:67]
  v_max3_u32 v208, v208, v162, v163
  s_waitcnt vmcnt(4)
  v_mfma_f32_16x16x32_bf16 v[64:67], v[188:191], v[112:115], v[64:67]
  v_max3_u32 v208, v208, v164, v165
  v_max3_u32 v208, v208, v166, v167
  v_cmp_eq_u32 vcc, -1, v208
  s_nop 4
  s_cbranch_vccz Lx113
Lx112:
  buffer_load_dwordx4 v[144:147], v13, s[28:31], s41 offen offset:0 sc1
  buffer_load_dwordx4 v[148:151], v13, s[28:31], s41 offen offset:1024 sc1
  buffer_load_dwordx4 v[160:163], v13, s[28:31], s41 offen offset:2048 sc1
  buffer_load_dwordx4 v[164:167], v13, s[28:31], s41 offen offset:3072 sc1
  s_add_u32 s70, s70, 1
  s_waitcnt vmcnt(3)
  v_max_u32 v208, v144, v145
  v_max3_u32 v208, v208, v146, v147
  s_waitcnt vmcnt(2)
  v_max3_u32 v208, v208, v148, v149
  v_max3_u32 v208, v208, v150, v151
  s_waitcnt vmcnt(1)
  v_max3_u32 v208, v208, v160, v161
  v_max3_u32 v208, v208, v162, v163
  s_waitcnt vmcnt(0)
  v_max3_u32 v208, v208, v164, v165
  v_max3_u32 v208, v208, v166, v167
  v_cmp_eq_u32 vcc, -1, v208
  s_cmp_gt_u32 s70, 2097152
  s_cbranch_scc1 Lx113
  s_nop 2
  s_cbranch_vccnz Lx112
Lx113:
  v_mfma_f32_16x16x32_bf16 v[60:63], v[212:215], v[164:167], v[60:63]
  v_mfma_f32_16x16x32_bf16 v[76:79], v[210:213], v[164:167], v[76:79]
  v_mfma_f32_16x16x32_bf16 v[56:59], v[212:215], v[160:163], v[56:59]
  v_mfma_f32_16x16x32_bf16 v[72:75], v[210:213], v[160:163], v[72:75]
  v_mfma_f32_16x16x32_bf16 v[52:55], v[212:215], v[148:151], v[52:55]
  v_mfma_f32_16x16x32_bf16 v[68:71], v[210:213], v[148:151], v[68:71]
  v_mfma_f32_16x16x32_bf16 v[48:51], v[212:215], v[144:147], v[48:51]
  v_mfma_f32_16x16x32_bf16 v[64:67], v[210:213], v[144:147], v[64:67]
  s_cmp_lg_u32 s22, 0
  s_cbranch_scc1 Lc_final
  v_cvt_pk_bf16_f32 v244, v60, v61
  v_cvt_pk_bf16_f32 v245, v62, v63
  v_cvt_pk_bf16_f32 v246, v76, v77
  v_cvt_pk_bf16_f32 v247, v78, v79
  buffer_store_dwordx4 v[244:247], v13, s[28:31], s51 offen offset:2048 sc1
  v_cvt_pk_bf16_f32 v240, v56, v57
  v_cvt_pk_bf16_f32 v241, v58, v59
  v_cvt_pk_bf16_f32 v242, v72, v73
  v_cvt_pk_bf16_f32 v243, v74, v75
  buffer_store_dwordx4 v[240:243], v13, s[28:31], s51 offen offset:0 sc1
  v_cvt_pk_bf16_f32 v236, v52, v53
  v_cvt_pk_bf16_f32 v237, v54, v55
  v_cvt_pk_bf16_f32 v238, v68, v69
  v_cvt_pk_bf16_f32 v239, v70, v71
  buffer_store_dwordx4 v[236:239], v13, s[28:31], s50 offen offset:2048 sc1
  v_cvt_pk_bf16_f32 v232, v48, v49
  v_cvt_pk_bf16_f32 v233, v50, v51
  v_cvt_pk_bf16_f32 v234, v64, v65
  v_cvt_pk_bf16_f32 v235, v66, v67
  buffer_store_dwordx4 v[232:235], v13, s[28:31], s50 offen offset:0 sc1
  s_barrier
  ds_write_b128 v12, v[232:235] offset:0
  ds_write_b128 v12, v[236:239] offset:2048
  ds_write_b128 v11, v[240:243] offset:0
  ds_write_b128 v11, v[244:247] offset:2048
  s_mov_b32 s43, 0x3f803f80
  s_add_u32 s42, s76, s23
  s_add_u32 s42, s42, 88082432
  v_dot2_f32_bf16 v216, v232, s43, 0
  v_dot2_f32_bf16 v220, v232, v232, 0
  v_dot2_f32_bf16 v217, v236, s43, 0
  v_dot2_f32_bf16 v221, v236, v236, 0
  v_dot2_f32_bf16 v218, v240, s43, 0
  v_dot2_f32_bf16 v222, v240, v240, 0
  v_dot2_f32_bf16 v219, v244, s43, 0
  v_dot2_f32_bf16 v223, v244, v244, 0
  v_dot2_f32_bf16 v216, v233, s43, v216
  v_dot2_f32_bf16 v220, v233, v233, v220
  v_dot2_f32_bf16 v217, v237, s43, v217
  v_dot2_f32_bf16 v221, v237, v237, v221
  v_dot2_f32_bf16 v218, v241, s43, v218
  v_dot2_f32_bf16 v222, v241, v241, v222
  v_dot2_f32_bf16 v219, v245, s43, v219
  v_dot2_f32_bf16 v223, v245, v245, v223
  v_dot2_f32_bf16 v216, v234, s43, v216
  v_dot2_f32_bf16 v220, v234, v234, v220
  v_dot2_f32_bf16 v217, v238, s43, v217
  v_dot2_f32_bf16 v221, v238, v238, v221
  v_dot2_f32_bf16 v218, v242, s43, v218
  v_dot2_f32_bf16 v222, v242, v242, v222
  v_dot2_f32_bf16 v219, v246, s43, v219
  v_dot2_f32_bf16 v223, v246, v246, v223
  v_dot2_f32_bf16 v216, v235, s43, v216
  v_dot2_f32_bf16 v220, v235, v235, v220
  v_dot2_f32_bf16 v217, v239, s43, v217
  v_dot2_f32_bf16 v221, v239, v239, v221
  v_dot2_f32_bf16 v218, v243, s43, v218
  v_dot2_f32_bf16 v222, v243, v243, v222
  v_dot2_f32_bf16 v219, v247, s43, v219
  v_dot2_f32_bf16 v223, v247, v247, v223
  v_lshlrev_b32 v14, 3, v1
  s_nop 2
  v_permlane32_swap_b32 v216, v218
  v_permlane32_swap_b32 v217, v219
  v_permlane32_swap_b32 v220, v222
  v_permlane32_swap_b32 v221, v223
  v_add_f32 v216, v216, v218
  v_add_f32 v217, v217, v219
  v_add_f32 v220, v220, v222
  v_add_f32 v221, v221, v223
  v_permlane16_swap_b32 v216, v217
  s_nop 0
  v_permlane16_swap_b32 v220, v221
  v_add_f32 v216, v216, v217
  v_add_f32 v217, v220, v221
  buffer_store_dwordx2 v[216:217], v14, s[28:31], s42 offen sc1
  s_mov_b32 s22, 1
  s_mov_b32 s23, 46137344
  v_lshrrev_b32 v184, 4, v1
  v_bfe_u32 v185, v1, 2, 2
  v_and_b32 v186, 3, v1
  v_and_b32 v187, 1, v184
  v_lshl_add_u32 v187, v187, 2, v185
  v_lshrrev_b32 v188, 1, v184
  v_mul_u32_u24 v188, 3072, v188
  v_lshl_add_u32 v188, v187, 7, v188
  v_lshl_add_u32 v188, v186, 3, v188
  v_add_u32 v188, 131072, v188
  v_lshrrev_b32 v189, 1, v187
  s_lshl_b32 s38, s36, 13
  v_lshl_add_u32 v6, v1, 4, s38
  v_add_u32 v7, 1024, v6
  s_lshl_b32 s39, s37, 1
  s_add_u32 s39, s39, 0
  v_xor_b32 v176, s39, v189
  v_lshl_add_u32 v224, v176, 5, v188
  s_lshl_b32 s39, s37, 1
  s_add_u32 s39, s39, 1
  v_xor_b32 v176, s39, v189
  v_lshl_add_u32 v225, v176, 5, v188
  s_mov_b32 s44, 1
  s_mov_b32 s45, 1
  s_mov_b32 s46, 16384
  s_mov_b32 s47, 4294942720
  s_mov_b32 s48, 0
  s_mov_b32 s80, 16384
  s_mov_b32 s81, 4294934528
  s_mov_b32 s82, 4294942720
  s_mov_b32 s83, 49152
  s_waitcnt vmcnt(1) lgkmcnt(0)
  s_branch Lc_layer
Lc_final:
  s_mov_b32 s64, s16
  s_mov_b32 s65, s17
  v_cvt_pk_bf16_f32 v244, v60, v61
  v_cvt_pk_bf16_f32 v245, v62, v63
  v_cvt_pk_bf16_f32 v246, v76, v77
  v_cvt_pk_bf16_f32 v247, v78, v79
  s_nop 1
  v_permlane16_swap_b32 v244, v246
  v_permlane16_swap_b32 v245, v247
  buffer_store_dwordx4 v[244:247], v4, s[64:67], s55 offen sc1
  v_cvt_pk_bf16_f32 v240, v56, v57
  v_cvt_pk_bf16_f32 v241, v58, v59
  v_cvt_pk_bf16_f32 v242, v72, v73
  v_cvt_pk_bf16_f32 v243, v74, v75
  s_nop 1
  v_permlane16_swap_b32 v240, v242
  v_permlane16_swap_b32 v241, v243
  buffer_store_dwordx4 v[240:243], v4, s[64:67], s54 offen sc1
  v_cvt_pk_bf16_f32 v236, v52, v53
  v_cvt_pk_bf16_f32 v237, v54, v55
  v_cvt_pk_bf16_f32 v238, v68, v69
  v_cvt_pk_bf16_f32 v239, v70, v71
  s_nop 1
  v_permlane16_swap_b32 v236, v238
  v_permlane16_swap_b32 v237, v239
  buffer_store_dwordx4 v[236:239], v4, s[64:67], s53 offen sc1
  v_cvt_pk_bf16_f32 v232, v48, v49
  v_cvt_pk_bf16_f32 v233, v50, v51
  v_cvt_pk_bf16_f32 v234, v64, v65
  v_cvt_pk_bf16_f32 v235, v66, v67
  s_nop 1
  v_permlane16_swap_b32 v232, v234
  v_permlane16_swap_b32 v233, v235
  buffer_store_dwordx4 v[232:235], v4, s[64:67], s52 offen sc1
  s_endpgm
Lrare90:
  s_lshr_b32 s39, s25, 3
  s_lshl_b32 s39, s39, 7
  v_mov_b32 v9, s39
  v_mov_b32 v10, s75
  s_mov_b64 exec, 1
  global_atomic_add v9, v10, s[18:19] offset:0 sc1
  s_mov_b64 exec, -1
  s_branch Lback91
Lrare108:
  s_lshr_b32 s39, s25, 3
  s_lshl_b32 s39, s39, 7
  v_mov_b32 v9, s39
  v_mov_b32 v10, 0x1000000
  s_mov_b64 exec, 1
  global_atomic_add v9, v10, s[18:19] offset:4 sc1
  s_mov_b64 exec, -1
  s_branch Lback109
L_end:
  s_endpgm
.section .rodata,"a"
.p2align 6
.amdhsa_kernel interleave_layers__sliding_block__dense_activation_silu__prompt_kernel
  .amdhsa_next_free_vgpr 256
  .amdhsa_next_free_sgpr 102
  .amdhsa_accum_offset 256
  .amdhsa_group_segment_fixed_size 0
  .amdhsa_kernarg_size 72
  .amdhsa_user_sgpr_count 2
  .amdhsa_user_sgpr_kernarg_segment_ptr 1
  .amdhsa_system_sgpr_workgroup_id_x 1
.end_amdhsa_kernel
```
